```python
import torch

def _softmax(x, axis=-1):
    return torch.softmax(x, dim=axis)
def _gelu(x):
    return torch.nn.functional.gelu(x, approximate="tanh")
def _silu(x):
    return torch.nn.functional.silu(x)
def _sigmoid(x):
    return torch.sigmoid(x)
def _layernorm(x, axis=-1, eps=1e-5):
    m = x.mean(dim=axis, keepdim=True)
    v = x.var(dim=axis, keepdim=True, unbiased=False)
    return (x - m) / torch.sqrt(v + eps)
def _scatter_add(tgt, idx, src, axis=0):
    return tgt.clone().index_add_(axis, idx, src)
def _segment_sum(src, seg, n):
    out = torch.zeros((n,) + src.shape[1:], dtype=src.dtype)
    return out.index_add_(0, seg, src)
def _pad(x, pw):
    flat = tuple(v for pair in reversed(pw) for v in pair)
    return torch.nn.functional.pad(x, flat)

kernel_name = 'recurrent_scan__mha_block__mixer_channel_mlp__prompt'

def setup_inputs():

    _w = (lambda a: (lambda t: t.to(torch.bfloat16) if t.is_floating_point() else t)(torch.as_tensor(a)))
    def _A_setup():
        B, S, D, H = 1, 2048, 640, 32
        return {
            "x": _w((lambda *s: torch.randn(*s, dtype=torch.bfloat16) * 0.05)(B, S, D)),
            "wqkv": _w((lambda *s: torch.randn(*s, dtype=torch.bfloat16) * 0.05)(D, 3 * D)),
            "wo": _w((lambda *s: torch.randn(*s, dtype=torch.bfloat16) * 0.05)(D, D)),
        }
    _A_in = _A_setup()

    def _B_setup():
        B, S, D, F = 1, 2048, 640, 1728
        return {
            "x": _w((lambda *s: torch.randn(*s, dtype=torch.bfloat16) * 0.05)(B, S, D)),
            "w1": _w((lambda *s: torch.randn(*s, dtype=torch.bfloat16) * 3.2)(D, F) * (D ** -0.5)),
            "b1": _w((lambda *s: torch.randn(*s, dtype=torch.bfloat16) * 1.6)(F)),
            "w2": _w((lambda *s: torch.randn(*s, dtype=torch.bfloat16) * 0.05)(F, D) * (F ** -0.5)),
            "b2": _w((lambda *s: torch.randn(*s, dtype=torch.bfloat16) * 0.05)(D)),
        }
    _B_in = _B_setup()

    return {
        "A_x": _A_in["x"],
        "A_wqkv": _A_in["wqkv"],
        "A_wo": _A_in["wo"],
        "B_x": _B_in["x"],
        "B_w1": _B_in["w1"],
        "B_b1": _B_in["b1"],
        "B_w2": _B_in["w2"],
        "B_b2": _B_in["b2"],
    }

def reference(A_x, A_wqkv, A_wo, B_x, B_w1, B_b1, B_w2, B_b2):
    def _A_ref(x, wqkv, wo):
        B, S, D = x.shape
        H = 32
        Dh = D // H
        qkv = (lambda x, *d: x.permute(*d))((x @ wqkv).reshape(B, S, 3, H, Dh), 2, 0, 3, 1, 4)
        q, k, v = qkv[0], qkv[1], qkv[2]
        scores = torch.einsum("bhqd,bhkd->bhqk", q, k) * (Dh ** -0.5)
        p = _softmax(scores, axis=-1)
        o = torch.einsum("bhqk,bhkd->bhqd", p, v)
        return (lambda x, *d: x.permute(*d))(o, 0, 2, 1, 3).reshape(B, S, D) @ wo

    def _B_ref(x, w1, b1, w2, b2):
        y = _layernorm(x, axis=-1)
        h = _gelu(torch.einsum("bsd,df->bsf", y, w1) + b1)
        return torch.einsum("bsf,fd->bsd", h, w2) + b2

    x = A_x
    xn = _layernorm(x, axis=-1)
    s = _A_ref(xn, A_wqkv, A_wo)
    g = _silu(_B_ref(xn, B_w1, B_b1, B_w2, B_b2))
    return x + s * g
```

```asm
; @launch grid=(256,1,1) block=(512,1,1) lds=163840
.amdgcn_target "amdgcn-amd-amdhsa--gfx950"
.text
.globl recurrent_scan__mha_block__mixer_channel_mlp__prompt_kernel
.p2align 8
.type recurrent_scan__mha_block__mixer_channel_mlp__prompt_kernel,@function
recurrent_scan__mha_block__mixer_channel_mlp__prompt_kernel:
L_first:
    s_load_dwordx2 s[8:9], s[0:1], 0
    s_load_dwordx2 s[24:25], s[0:1], 8
    s_load_dwordx2 s[36:37], s[0:1], 32
    s_cmp_ge_u32 s2, 256
    s_cbranch_scc1 L_end
    s_getpc_b64 s[64:65]
L_pc:
    s_lshr_b32 s58, s2, 3
    v_and_b32 v2, 0x1e0, v0
    v_add_lshl_u32 v2, v2, s58, 7
    v_min_u32 v2, L_last-L_pc-4, v2
    global_load_dword v22, v2, s[64:65]
    v_lshrrev_b32 v1, 6, v0
    v_and_b32 v0, 63, v0
    v_readfirstlane_b32 s3, v1
    s_and_b32 s6, s2, 3
    s_bfe_u32 s57, s2, 0x20003
    s_lshl2_add_u32 s6, s6, s57
    s_lshr_b32 s59, s2, 5
    s_bfe_u32 s60, s2, 0x10002
    s_lshl1_add_u32 s7, s59, s60
    s_and_b32 s4, s3, 3
    s_lshl2_add_u32 s58, s6, s4
    s_mul_i32 s51, s58, 40960
    s_mov_b32 s96, 0
    s_mov_b32 s10, 2621440
    s_mov_b32 s11, 0x00020000
    s_cmp_lt_u32 s3, 4
    s_cbranch_scc1 LA
    v_lshrrev_b32 v40, 4, v0
    v_xor_b32 v41, v40, v0
    v_and_b32 v41, 15, v41
    v_lshlrev_b32 v41, 4, v41
    v_mul_u32_u24 v40, 1280, v40
    v_add_u32 v32, v40, v41
    v_xor_b32 v33, 4160, v32
    v_xor_b32 v34, 8320, v32
    v_xor_b32 v35, 12480, v32
    s_waitcnt lgkmcnt(0)
    s_lshl_b32 s58, s4, 13
    s_add_u32 m0, s58, 49152
    s_lshl_b32 s58, s96, 8
    s_add_u32 s58, s58, s51
    buffer_load_dwordx4 v32, s[8:11], s58 offen offset:0 lds
    buffer_load_dwordx4 v33, s[8:11], s58 offen offset:1024 lds
    buffer_load_dwordx4 v34, s[8:11], s58 offen offset:2048 lds
    buffer_load_dwordx4 v35, s[8:11], s58 offen offset:3072 lds
    s_add_u32 m0, m0, 4096
    s_add_u32 s58, s58, 20480
    buffer_load_dwordx4 v32, s[8:11], s58 offen offset:0 lds
    buffer_load_dwordx4 v33, s[8:11], s58 offen offset:1024 lds
    buffer_load_dwordx4 v34, s[8:11], s58 offen offset:2048 lds
    buffer_load_dwordx4 v35, s[8:11], s58 offen offset:3072 lds
    v_lshlrev_b32 v13, 4, v0
    s_lshl_b32 s52, s4, 12
    s_add_u32 s52, s52, 65536
    s_mov_b32 s15, 0x00020000
    s_lshl_b32 s64, s7, 8
    s_cmp_eq_u32 s7, 15
    s_cselect_b32 s64, 3072, s64
    s_cselect_b32 s12, s36, s24
    s_cselect_b32 s13, s37, s25
    s_cselect_b32 s63, 0, 384
    s_add_u32 s63, s63, 3456
    s_mul_i32 s14, s63, 640
    s_lshl_b32 s43, s63, 7
    s_mul_i32 s42, s4, s63
    s_lshl_b32 s42, s42, 5
    s_add_u32 s42, s42, s64
    v_lshrrev_b32 v29, 7, v13
    v_mul_u32_u24 v28, s63, v29
    v_lshrrev_b32 v29, 2, v13
    v_xor_b32 v29, v29, v13
    v_and_b32 v29, 0x40, v29
    v_and_b32 v30, 0x30, v13
    v_add3_u32 v28, v28, v29, v30
    s_lshl_b32 s63, s63, 3
    s_sub_u32 s63, s63, 1024
    v_add_u32 v29, s63, v28
    v_add_u32 v30, s63, v29
    v_add_u32 v31, s63, v30
    s_add_u32 m0, s52, 0x00004000
    s_mul_i32 s58, s43, s96
    s_add_u32 s58, s58, s42
    buffer_load_dwordx4 v28, s[12:15], s58 offen offset:0 lds
    buffer_load_dwordx4 v29, s[12:15], s58 offen offset:1024 lds
    buffer_load_dwordx4 v30, s[12:15], s58 offen offset:2048 lds
    buffer_load_dwordx4 v31, s[12:15], s58 offen offset:3072 lds
    s_load_dwordx2 s[16:17], s[0:1], 80
    s_load_dwordx2 s[20:21], s[0:1], 40
    s_load_dwordx2 s[40:41], s[0:1], 16
    s_load_dwordx2 s[38:39], s[0:1], 48
    s_load_dwordx2 s[28:29], s[0:1], 56
    s_load_dwordx2 s[32:33], s[0:1], 64
    v_lshrrev_b32 v14, 5, v0
    v_and_b32 v15, 31, v0
    s_lshr_b32 s61, s2, 3
    s_and_b32 s58, s2, 7
    s_lshr_b32 s59, s2, 5
    s_lshl3_add_u32 s56, s58, s59
    s_lshr_b32 s60, s2, 6
    s_lshl2_add_u32 s54, s58, s60
    s_and_b32 s55, s61, 7
    s_sub_u32 s53, s61, 20
    s_lshl_b32 s47, s7, 1
    s_add_u32 s58, s7, 9
    s_cmp_lt_u32 s7, 9
    s_cselect_b32 s47, s47, s58
    s_cselect_b32 s45, 4, 3
    s_cmp_eq_u32 s7, 15
    s_cselect_b32 s47, 26, s47
    s_lshr_b32 s58, s2, 5
    s_add_u32 s58, s58, s57
    s_add_u32 s97, s58, 1
    s_and_b32 s97, s97, 3
    s_add_u32 s97, s97, 1
    s_add_u32 s98, s58, 2
    s_and_b32 s98, s98, 3
    s_add_u32 s98, s98, 1
    s_add_u32 s99, s58, 3
    s_and_b32 s99, s99, 3
    s_add_u32 s99, s99, 1
    s_add_u32 s100, s58, 4
    s_and_b32 s100, s100, 3
    s_add_u32 s100, s100, 1
    s_mov_b32 s18, 0x02000000
    s_mov_b32 s19, 0x00020000
    s_mov_b32 s22, 0x00000000
    s_mov_b32 s23, 0x00020000
    s_mov_b32 s30, 0x00000500
    s_mov_b32 s31, 0x00020000
    s_mov_b32 s34, 0x00280000
    s_mov_b32 s35, 0x00020000
    s_waitcnt lgkmcnt(0)
    s_add_u32 s68, s16, 0x01cf0000
    s_addc_u32 s69, s17, 0
    s_load_dword s5, s[68:69], 0
    v_bfe_u32 v40, v0, 2, 2
    v_lshl_add_u32 v41, v14, 3, v40
    v_lshlrev_b32 v41, 7, v41
    v_lshrrev_b32 v40, 1, v40
    v_lshl_add_u32 v41, v40, 6, v41
    v_bfe_u32 v40, v0, 4, 1
    v_lshl_add_u32 v41, v40, 5, v41
    v_and_b32 v40, 3, v0
    v_lshl_add_u32 v40, v40, 3, v41
    s_mov_b32 s26, 65536
    s_sub_u32 s27, s52, 65536
    v_add_u32 v2, s27, v40
    v_xor_b32 v3, 64, v2
    v_and_b32 v40, 15, v0
    v_xor_b32 v40, v40, v14
    v_lshlrev_b32 v40, 4, v40
    v_lshl_add_u32 v40, v15, 8, v40
    s_mul_i32 s58, s4, 8256
    v_xor_b32 v36, s58, v40
    v_mov_b32 v10, 0xbeeff558
    v_mov_b32 v41, 0x3f803f80
    v_and_b32 v40, 14, v0
    v_cmp_eq_u32 vcc, 0, v40
    s_nop 1
    v_cndmask_b32 v16, 0, v41, vcc
    v_mov_b32 v17, v16
    v_cmp_eq_u32 vcc, 4, v40
    s_nop 1
    v_cndmask_b32 v18, 0, v41, vcc
    v_mov_b32 v19, v18
    v_and_b32 v40, 1, v0
    v_mul_u32_u24 v40, 0xaaaa, v40
    v_add_u32 v11, 0x4444, v40
    v_mov_b32 v20, 0
    v_mov_b32 v21, 0
    v_mov_b32 v22, 0
    v_mov_b32 v23, 0
    v_mov_b32 v24, 0
    v_mov_b32 v25, 0
    v_mov_b32 v26, 0
    v_mov_b32 v27, 0
    s_lshl_b32 s58, s6, 2
    s_add_u32 s58, s58, s4
    s_lshr_b32 s59, s58, 1
    s_mul_i32 s48, s59, 2560
    s_and_b32 s59, s58, 1
    s_lshl_b32 s59, s59, 8
    s_add_u32 s48, s48, s59
    s_mul_i32 s49, s58, 40960
    s_add_u32 s49, s49, 0x004fb000
    s_mul_i32 s50, s58, 110592
    s_add_u32 s50, s50, 0x00800000
    s_lshl_b32 s46, s7, 2
    s_cmp_eq_u32 s7, 15
    s_cselect_b32 s46, 48, s46
    s_add_u32 s46, s46, 2
    s_setprio 0
    v_lshlrev_b32 v12, 1, v15
    v_xor_b32 v0, 1, v14
    v_add_u32 v0, s4, v0
    v_lshl_add_u32 v12, v0, 20, v12
    s_cmp_eq_u32 s7, 15
    s_cselect_b32 s22, 3456, 0
    s_movk_i32 s58, 3200
    buffer_load_short_d16_hi v0, v12, s[20:23], s58 offen offset:0
    buffer_load_short_d16_hi v1, v12, s[20:23], s58 offen offset:64
    s_lshl_b32 s58, s4, 13
    s_add_u32 m0, s58, 114688
    s_lshl_b32 s58, s97, 8
    s_add_u32 s58, s58, s51
    buffer_load_dwordx4 v32, s[8:11], s58 offen offset:0 lds
    buffer_load_dwordx4 v33, s[8:11], s58 offen offset:1024 lds
    buffer_load_dwordx4 v34, s[8:11], s58 offen offset:2048 lds
    buffer_load_dwordx4 v35, s[8:11], s58 offen offset:3072 lds
    s_add_u32 m0, m0, 4096
    s_add_u32 s58, s58, 20480
    buffer_load_dwordx4 v32, s[8:11], s58 offen offset:0 lds
    buffer_load_dwordx4 v33, s[8:11], s58 offen offset:1024 lds
    buffer_load_dwordx4 v34, s[8:11], s58 offen offset:2048 lds
    buffer_load_dwordx4 v35, s[8:11], s58 offen offset:3072 lds
    s_add_u32 m0, s52, 0x00008000
    s_mul_i32 s58, s43, s97
    s_add_u32 s58, s58, s42
    buffer_load_dwordx4 v28, s[12:15], s58 offen offset:0 lds
    buffer_load_dwordx4 v29, s[12:15], s58 offen offset:1024 lds
    buffer_load_dwordx4 v30, s[12:15], s58 offen offset:2048 lds
    buffer_load_dwordx4 v31, s[12:15], s58 offen offset:3072 lds
    s_waitcnt lgkmcnt(0)
    s_add_u32 s5, s5, 1
    s_waitcnt vmcnt(14) lgkmcnt(0)
    s_barrier
    v_add_u32 v37, 49152, v36
    ds_read_b128 v[96:99], v37
    s_lshl_b32 s58, s4, 13
    s_add_u32 m0, s58, 0
    s_lshl_b32 s58, s98, 8
    s_add_u32 s58, s58, s51
    buffer_load_dwordx4 v32, s[8:11], s58 offen offset:0 lds
    v_xor_b32 v37, 32, v37
    ds_read_b128 v[100:103], v37
    buffer_load_dwordx4 v33, s[8:11], s58 offen offset:1024 lds
    v_xor_b32 v37, 96, v37
    ds_read_b128 v[104:107], v37
    buffer_load_dwordx4 v34, s[8:11], s58 offen offset:2048 lds
    v_xor_b32 v37, 32, v37
    ds_read_b128 v[108:111], v37
    buffer_load_dwordx4 v35, s[8:11], s58 offen offset:3072 lds
    v_xor_b32 v37, 224, v37
    ds_read_b128 v[112:115], v37
    s_add_u32 m0, m0, 4096
    s_add_u32 s58, s58, 20480
    buffer_load_dwordx4 v32, s[8:11], s58 offen offset:0 lds
    v_xor_b32 v37, 32, v37
    ds_read_b128 v[116:119], v37
    buffer_load_dwordx4 v33, s[8:11], s58 offen offset:1024 lds
    v_xor_b32 v37, 96, v37
    ds_read_b128 v[120:123], v37
    buffer_load_dwordx4 v34, s[8:11], s58 offen offset:2048 lds
    v_xor_b32 v37, 32, v37
    ds_read_b128 v[124:127], v37
    buffer_load_dwordx4 v35, s[8:11], s58 offen offset:3072 lds
    s_add_u32 m0, s52, 0xffff8000
    s_mul_i32 s58, s43, s98
    s_add_u32 s58, s58, s42
    buffer_load_dwordx4 v28, s[12:15], s58 offen offset:0 lds
    buffer_load_dwordx4 v29, s[12:15], s58 offen offset:1024 lds
    buffer_load_dwordx4 v30, s[12:15], s58 offen offset:2048 lds
    buffer_load_dwordx4 v31, s[12:15], s58 offen offset:3072 lds
    s_waitcnt vmcnt(12) lgkmcnt(0)
    s_barrier
    v_add_u32 v37, 114688, v36
    ds_read_b128 v[128:131], v37
    s_lshl_b32 s58, s4, 13
    s_add_u32 m0, s58, 49152
    s_lshl_b32 s58, s99, 8
    s_add_u32 s58, s58, s51
    buffer_load_dwordx4 v32, s[8:11], s58 offen offset:0 lds
    v_xor_b32 v37, 32, v37
    ds_read_b128 v[132:135], v37
    buffer_load_dwordx4 v33, s[8:11], s58 offen offset:1024 lds
    v_xor_b32 v37, 96, v37
    ds_read_b128 v[136:139], v37
    buffer_load_dwordx4 v34, s[8:11], s58 offen offset:2048 lds
    v_xor_b32 v37, 32, v37
    ds_read_b128 v[140:143], v37
    buffer_load_dwordx4 v35, s[8:11], s58 offen offset:3072 lds
    v_xor_b32 v37, 224, v37
    ds_read_b128 v[144:147], v37
    s_add_u32 m0, m0, 4096
    s_add_u32 s58, s58, 20480
    buffer_load_dwordx4 v32, s[8:11], s58 offen offset:0 lds
    v_xor_b32 v37, 32, v37
    ds_read_b128 v[148:151], v37
    buffer_load_dwordx4 v33, s[8:11], s58 offen offset:1024 lds
    v_xor_b32 v37, 96, v37
    ds_read_b128 v[152:155], v37
    buffer_load_dwordx4 v34, s[8:11], s58 offen offset:2048 lds
    v_xor_b32 v37, 32, v37
    ds_read_b128 v[156:159], v37
    buffer_load_dwordx4 v35, s[8:11], s58 offen offset:3072 lds
    s_add_u32 m0, s52, 0x00004000
    s_mul_i32 s58, s43, s99
    s_add_u32 s58, s58, s42
    buffer_load_dwordx4 v28, s[12:15], s58 offen offset:0 lds
    buffer_load_dwordx4 v29, s[12:15], s58 offen offset:1024 lds
    buffer_load_dwordx4 v30, s[12:15], s58 offen offset:2048 lds
    buffer_load_dwordx4 v31, s[12:15], s58 offen offset:3072 lds
    s_waitcnt vmcnt(12) lgkmcnt(0)
    s_barrier
    v_add_u32 v37, 0, v36
    ds_read_b128 v[160:163], v37
    s_lshl_b32 s58, s4, 13
    s_add_u32 m0, s58, 114688
    s_lshl_b32 s58, s100, 8
    s_add_u32 s58, s58, s51
    buffer_load_dwordx4 v32, s[8:11], s58 offen offset:0 lds
    v_xor_b32 v37, 32, v37
    ds_read_b128 v[164:167], v37
    buffer_load_dwordx4 v33, s[8:11], s58 offen offset:1024 lds
    v_xor_b32 v37, 96, v37
    ds_read_b128 v[168:171], v37
    buffer_load_dwordx4 v34, s[8:11], s58 offen offset:2048 lds
    v_xor_b32 v37, 32, v37
    ds_read_b128 v[172:175], v37
    buffer_load_dwordx4 v35, s[8:11], s58 offen offset:3072 lds
    v_xor_b32 v37, 224, v37
    ds_read_b128 v[176:179], v37
    s_add_u32 m0, m0, 4096
    s_add_u32 s58, s58, 20480
    buffer_load_dwordx4 v32, s[8:11], s58 offen offset:0 lds
    v_xor_b32 v37, 32, v37
    ds_read_b128 v[180:183], v37
    buffer_load_dwordx4 v33, s[8:11], s58 offen offset:1024 lds
    v_xor_b32 v37, 96, v37
    ds_read_b128 v[184:187], v37
    buffer_load_dwordx4 v34, s[8:11], s58 offen offset:2048 lds
    v_xor_b32 v37, 32, v37
    ds_read_b128 v[188:191], v37
    buffer_load_dwordx4 v35, s[8:11], s58 offen offset:3072 lds
    s_add_u32 m0, s52, 0x00008000
    s_mul_i32 s58, s43, s100
    s_add_u32 s58, s58, s42
    buffer_load_dwordx4 v28, s[12:15], s58 offen offset:0 lds
    buffer_load_dwordx4 v29, s[12:15], s58 offen offset:1024 lds
    buffer_load_dwordx4 v30, s[12:15], s58 offen offset:2048 lds
    buffer_load_dwordx4 v31, s[12:15], s58 offen offset:3072 lds
    s_waitcnt vmcnt(12) lgkmcnt(0)
    s_barrier
    v_add_u32 v37, 49152, v36
    ds_read_b128 v[192:195], v37
    s_add_u32 s42, s42, 128
    s_add_u32 m0, s27, 0
    s_mul_i32 s58, s43, s96
    s_add_u32 s58, s58, s42
    buffer_load_dwordx4 v28, s[12:15], s58 offen offset:0 lds
    v_xor_b32 v37, 32, v37
    ds_read_b128 v[196:199], v37
    buffer_load_dwordx4 v29, s[12:15], s58 offen offset:1024 lds
    v_xor_b32 v37, 96, v37
    ds_read_b128 v[200:203], v37
    buffer_load_dwordx4 v30, s[12:15], s58 offen offset:2048 lds
    v_xor_b32 v37, 32, v37
    ds_read_b128 v[204:207], v37
    buffer_load_dwordx4 v31, s[12:15], s58 offen offset:3072 lds
    v_xor_b32 v37, 224, v37
    ds_read_b128 v[208:211], v37
    s_add_u32 m0, s27, 16384
    s_mul_i32 s58, s43, s97
    s_add_u32 s58, s58, s42
    buffer_load_dwordx4 v28, s[12:15], s58 offen offset:0 lds
    v_xor_b32 v37, 32, v37
    ds_read_b128 v[212:215], v37
    buffer_load_dwordx4 v29, s[12:15], s58 offen offset:1024 lds
    v_xor_b32 v37, 96, v37
    ds_read_b128 v[216:219], v37
    buffer_load_dwordx4 v30, s[12:15], s58 offen offset:2048 lds
    v_xor_b32 v37, 32, v37
    ds_read_b128 v[220:223], v37
    buffer_load_dwordx4 v31, s[12:15], s58 offen offset:3072 lds
    s_add_u32 m0, s27, 32768
    s_mul_i32 s58, s43, s98
    s_add_u32 s58, s58, s42
    buffer_load_dwordx4 v28, s[12:15], s58 offen offset:0 lds
    buffer_load_dwordx4 v29, s[12:15], s58 offen offset:1024 lds
    buffer_load_dwordx4 v30, s[12:15], s58 offen offset:2048 lds
    buffer_load_dwordx4 v31, s[12:15], s58 offen offset:3072 lds
    s_mov_b32 s64, s36
    s_mov_b32 s65, s37
    s_mov_b32 s66, 2211840
    s_mov_b32 s67, 0x00020000
    s_lshl4_add_u32 s58, s7, s6
    s_lshl2_add_u32 s58, s58, s4
    s_mul_i32 s58, s58, 2176
    v_min_u32 v12, 256, v13
    v_lshl_add_u32 v12, v12, 3, s58
    buffer_load_dword v22, v12, s[64:67], 0 offen
    s_waitcnt vmcnt(13) lgkmcnt(0)
    s_barrier
    v_add_u32 v37, 114688, v36
    ds_read_b128 v[224:227], v37
    s_add_u32 m0, s27, 49152
    s_mul_i32 s58, s43, s99
    s_add_u32 s58, s58, s42
    buffer_load_dwordx4 v28, s[12:15], s58 offen offset:0 lds
    v_xor_b32 v37, 32, v37
    ds_read_b128 v[228:231], v37
    buffer_load_dwordx4 v29, s[12:15], s58 offen offset:1024 lds
    v_xor_b32 v37, 96, v37
    ds_read_b128 v[232:235], v37
    buffer_load_dwordx4 v30, s[12:15], s58 offen offset:2048 lds
    v_xor_b32 v37, 32, v37
    ds_read_b128 v[236:239], v37
    buffer_load_dwordx4 v31, s[12:15], s58 offen offset:3072 lds
    v_xor_b32 v37, 224, v37
    ds_read_b128 v[240:243], v37
    s_nop 1
    v_xor_b32 v37, 32, v37
    ds_read_b128 v[244:247], v37
    s_nop 1
    v_xor_b32 v37, 96, v37
    ds_read_b128 v[248:251], v37
    s_nop 1
    v_xor_b32 v37, 32, v37
    ds_read_b128 v[252:255], v37
    s_mov_b32 s12, s36
    s_mov_b32 s13, s37
    s_mov_b32 s14, 2211840
    s_movk_i32 s63, 3456
    s_lshl_b32 s64, s47, 7
    s_lshl_b32 s43, s63, 7
    s_mul_i32 s42, s4, s63
    s_lshl_b32 s42, s42, 5
    s_add_u32 s42, s42, s64
    v_lshrrev_b32 v29, 7, v13
    v_mul_u32_u24 v28, s63, v29
    v_lshrrev_b32 v29, 2, v13
    v_xor_b32 v29, v29, v13
    v_and_b32 v29, 0x40, v29
    v_and_b32 v30, 0x30, v13
    v_add3_u32 v28, v28, v29, v30
    s_lshl_b32 s63, s63, 3
    s_sub_u32 s63, s63, 1024
    v_add_u32 v29, s63, v28
    v_add_u32 v30, s63, v29
    v_add_u32 v31, s63, v30
    s_waitcnt vmcnt(5) lgkmcnt(0)
    s_barrier
    s_mov_b32 s44, 1
    s_sub_u32 s58, s7, 10
    s_cmp_lt_u32 s58, 5
    s_cbranch_scc0 LC
    s_setprio 2
    ds_read_b64_tr_b16 v[32:33], v2 offset:0
    ds_read_b64_tr_b16 v[34:35], v2 offset:512
    ds_read_b64_tr_b16 v[36:37], v2 offset:2048
    ds_read_b64_tr_b16 v[38:39], v2 offset:2560
    ds_read_b64_tr_b16 v[40:41], v3 offset:0
    ds_read_b64_tr_b16 v[42:43], v3 offset:512
    ds_read_b64_tr_b16 v[44:45], v3 offset:2048
    ds_read_b64_tr_b16 v[46:47], v3 offset:2560
    v_xor_b32 v2, 0x00001000, v2
    ds_read_b64_tr_b16 v[48:49], v2 offset:0
    ds_read_b64_tr_b16 v[50:51], v2 offset:512
    ds_read_b64_tr_b16 v[52:53], v2 offset:2048
    ds_read_b64_tr_b16 v[54:55], v2 offset:2560
    s_waitcnt lgkmcnt(8)
    v_mfma_f32_32x32x16_bf16 v[64:79], v[96:99], v[32:35], 0
    v_xor_b32 v3, 0x00001000, v3
    ds_read_b64_tr_b16 v[56:57], v3 offset:0
    ds_read_b64_tr_b16 v[58:59], v3 offset:512
    v_mfma_f32_32x32x16_bf16 v[64:79], v[100:103], v[36:39], v[64:79]
    ds_read_b64_tr_b16 v[60:61], v3 offset:2048
    ds_read_b64_tr_b16 v[62:63], v3 offset:2560
    s_waitcnt lgkmcnt(8)
    v_smfmac_f32_16x16x64_bf16 v[20:23], v[16:19], v[32:39], v11
    v_mfma_f32_32x32x16_bf16 v[80:95], v[96:99], v[40:43], 0
    v_xor_b32 v2, 0x00003000, v2
    ds_read_b64_tr_b16 v[32:33], v2 offset:0
    ds_read_b64_tr_b16 v[34:35], v2 offset:512
    v_mfma_f32_32x32x16_bf16 v[80:95], v[100:103], v[44:47], v[80:95]
    ds_read_b64_tr_b16 v[36:37], v2 offset:2048
    ds_read_b64_tr_b16 v[38:39], v2 offset:2560
    s_waitcnt lgkmcnt(8)
    v_smfmac_f32_16x16x64_bf16 v[24:27], v[16:19], v[40:47], v11
    v_mfma_f32_32x32x16_bf16 v[64:79], v[104:107], v[48:51], v[64:79]
    v_xor_b32 v3, 0x00003000, v3
    ds_read_b64_tr_b16 v[40:41], v3 offset:0
    ds_read_b64_tr_b16 v[42:43], v3 offset:512
    v_mfma_f32_32x32x16_bf16 v[64:79], v[108:111], v[52:55], v[64:79]
    ds_read_b64_tr_b16 v[44:45], v3 offset:2048
    ds_read_b64_tr_b16 v[46:47], v3 offset:2560
    s_waitcnt lgkmcnt(8)
    v_mfma_f32_32x32x16_bf16 v[80:95], v[104:107], v[56:59], v[80:95]
    v_xor_b32 v2, 0x00001000, v2
    ds_read_b64_tr_b16 v[48:49], v2 offset:0
    ds_read_b64_tr_b16 v[50:51], v2 offset:512
    v_mfma_f32_32x32x16_bf16 v[80:95], v[108:111], v[60:63], v[80:95]
    ds_read_b64_tr_b16 v[52:53], v2 offset:2048
    ds_read_b64_tr_b16 v[54:55], v2 offset:2560
    s_waitcnt lgkmcnt(8)
    v_mfma_f32_32x32x16_bf16 v[64:79], v[112:115], v[32:35], v[64:79]
    v_xor_b32 v3, 0x00001000, v3
    ds_read_b64_tr_b16 v[56:57], v3 offset:0
    ds_read_b64_tr_b16 v[58:59], v3 offset:512
    v_mfma_f32_32x32x16_bf16 v[64:79], v[116:119], v[36:39], v[64:79]
    ds_read_b64_tr_b16 v[60:61], v3 offset:2048
    ds_read_b64_tr_b16 v[62:63], v3 offset:2560
    s_waitcnt lgkmcnt(8)
    v_mfma_f32_32x32x16_bf16 v[80:95], v[112:115], v[40:43], v[80:95]
    v_xor_b32 v2, 0x00003000, v2
    ds_read_b64_tr_b16 v[32:33], v2 offset:16384
    ds_read_b64_tr_b16 v[34:35], v2 offset:16896
    v_mfma_f32_32x32x16_bf16 v[80:95], v[116:119], v[44:47], v[80:95]
    ds_read_b64_tr_b16 v[36:37], v2 offset:18432
    ds_read_b64_tr_b16 v[38:39], v2 offset:18944
    s_waitcnt lgkmcnt(8)
    v_mfma_f32_32x32x16_bf16 v[64:79], v[120:123], v[48:51], v[64:79]
    v_xor_b32 v3, 0x00003000, v3
    ds_read_b64_tr_b16 v[40:41], v3 offset:16384
    ds_read_b64_tr_b16 v[42:43], v3 offset:16896
    v_mfma_f32_32x32x16_bf16 v[64:79], v[124:127], v[52:55], v[64:79]
    ds_read_b64_tr_b16 v[44:45], v3 offset:18432
    ds_read_b64_tr_b16 v[46:47], v3 offset:18944
    s_waitcnt lgkmcnt(8)
    v_mfma_f32_32x32x16_bf16 v[80:95], v[120:123], v[56:59], v[80:95]
    v_xor_b32 v2, 0x00001000, v2
    ds_read_b64_tr_b16 v[48:49], v2 offset:16384
    ds_read_b64_tr_b16 v[50:51], v2 offset:16896
    v_mfma_f32_32x32x16_bf16 v[80:95], v[124:127], v[60:63], v[80:95]
    ds_read_b64_tr_b16 v[52:53], v2 offset:18432
    ds_read_b64_tr_b16 v[54:55], v2 offset:18944
    s_waitcnt lgkmcnt(8)
    v_mfma_f32_32x32x16_bf16 v[64:79], v[128:131], v[32:35], v[64:79]
    v_xor_b32 v3, 0x00001000, v3
    ds_read_b64_tr_b16 v[56:57], v3 offset:16384
    ds_read_b64_tr_b16 v[58:59], v3 offset:16896
    v_mfma_f32_32x32x16_bf16 v[64:79], v[132:135], v[36:39], v[64:79]
    ds_read_b64_tr_b16 v[60:61], v3 offset:18432
    ds_read_b64_tr_b16 v[62:63], v3 offset:18944
    s_waitcnt lgkmcnt(8)
    v_smfmac_f32_16x16x64_bf16 v[20:23], v[16:19], v[32:39], v11
    v_mfma_f32_32x32x16_bf16 v[80:95], v[128:131], v[40:43], v[80:95]
    v_xor_b32 v2, 0x00003000, v2
    ds_read_b64_tr_b16 v[32:33], v2 offset:16384
    ds_read_b64_tr_b16 v[34:35], v2 offset:16896
    v_mfma_f32_32x32x16_bf16 v[80:95], v[132:135], v[44:47], v[80:95]
    ds_read_b64_tr_b16 v[36:37], v2 offset:18432
    ds_read_b64_tr_b16 v[38:39], v2 offset:18944
    s_waitcnt lgkmcnt(8)
    v_smfmac_f32_16x16x64_bf16 v[24:27], v[16:19], v[40:47], v11
    v_mfma_f32_32x32x16_bf16 v[64:79], v[136:139], v[48:51], v[64:79]
    v_xor_b32 v3, 0x00003000, v3
    ds_read_b64_tr_b16 v[40:41], v3 offset:16384
    ds_read_b64_tr_b16 v[42:43], v3 offset:16896
    v_mfma_f32_32x32x16_bf16 v[64:79], v[140:143], v[52:55], v[64:79]
    ds_read_b64_tr_b16 v[44:45], v3 offset:18432
    ds_read_b64_tr_b16 v[46:47], v3 offset:18944
    s_waitcnt lgkmcnt(8)
    v_mfma_f32_32x32x16_bf16 v[80:95], v[136:139], v[56:59], v[80:95]
    v_xor_b32 v2, 0x00001000, v2
    ds_read_b64_tr_b16 v[48:49], v2 offset:16384
    ds_read_b64_tr_b16 v[50:51], v2 offset:16896
    v_mfma_f32_32x32x16_bf16 v[80:95], v[140:143], v[60:63], v[80:95]
    ds_read_b64_tr_b16 v[52:53], v2 offset:18432
    ds_read_b64_tr_b16 v[54:55], v2 offset:18944
    s_waitcnt lgkmcnt(8)
    v_mfma_f32_32x32x16_bf16 v[64:79], v[144:147], v[32:35], v[64:79]
    v_xor_b32 v3, 0x00001000, v3
    ds_read_b64_tr_b16 v[56:57], v3 offset:16384
    ds_read_b64_tr_b16 v[58:59], v3 offset:16896
    v_mfma_f32_32x32x16_bf16 v[64:79], v[148:151], v[36:39], v[64:79]
    ds_read_b64_tr_b16 v[60:61], v3 offset:18432
    ds_read_b64_tr_b16 v[62:63], v3 offset:18944
    s_waitcnt lgkmcnt(8)
    v_mfma_f32_32x32x16_bf16 v[80:95], v[144:147], v[40:43], v[80:95]
    v_xor_b32 v2, 0x00003000, v2
    ds_read_b64_tr_b16 v[32:33], v2 offset:32768
    ds_read_b64_tr_b16 v[34:35], v2 offset:33280
    v_mfma_f32_32x32x16_bf16 v[80:95], v[148:151], v[44:47], v[80:95]
    ds_read_b64_tr_b16 v[36:37], v2 offset:34816
    ds_read_b64_tr_b16 v[38:39], v2 offset:35328
    s_waitcnt lgkmcnt(8)
    v_mfma_f32_32x32x16_bf16 v[64:79], v[152:155], v[48:51], v[64:79]
    v_xor_b32 v3, 0x00003000, v3
    ds_read_b64_tr_b16 v[40:41], v3 offset:32768
    ds_read_b64_tr_b16 v[42:43], v3 offset:33280
    v_mfma_f32_32x32x16_bf16 v[64:79], v[156:159], v[52:55], v[64:79]
    ds_read_b64_tr_b16 v[44:45], v3 offset:34816
    ds_read_b64_tr_b16 v[46:47], v3 offset:35328
    s_waitcnt lgkmcnt(8)
    v_mfma_f32_32x32x16_bf16 v[80:95], v[152:155], v[56:59], v[80:95]
    v_xor_b32 v2, 0x00001000, v2
    ds_read_b64_tr_b16 v[48:49], v2 offset:32768
    ds_read_b64_tr_b16 v[50:51], v2 offset:33280
    v_mfma_f32_32x32x16_bf16 v[80:95], v[156:159], v[60:63], v[80:95]
    ds_read_b64_tr_b16 v[52:53], v2 offset:34816
    ds_read_b64_tr_b16 v[54:55], v2 offset:35328
    s_waitcnt lgkmcnt(8)
    v_mfma_f32_32x32x16_bf16 v[64:79], v[160:163], v[32:35], v[64:79]
    v_xor_b32 v3, 0x00001000, v3
    ds_read_b64_tr_b16 v[56:57], v3 offset:32768
    ds_read_b64_tr_b16 v[58:59], v3 offset:33280
    v_mfma_f32_32x32x16_bf16 v[64:79], v[164:167], v[36:39], v[64:79]
    ds_read_b64_tr_b16 v[60:61], v3 offset:34816
    ds_read_b64_tr_b16 v[62:63], v3 offset:35328
    s_waitcnt lgkmcnt(8)
    v_smfmac_f32_16x16x64_bf16 v[20:23], v[16:19], v[32:39], v11
    v_mfma_f32_32x32x16_bf16 v[80:95], v[160:163], v[40:43], v[80:95]
    v_xor_b32 v2, 0x00003000, v2
    ds_read_b64_tr_b16 v[32:33], v2 offset:32768
    ds_read_b64_tr_b16 v[34:35], v2 offset:33280
    v_mfma_f32_32x32x16_bf16 v[80:95], v[164:167], v[44:47], v[80:95]
    ds_read_b64_tr_b16 v[36:37], v2 offset:34816
    ds_read_b64_tr_b16 v[38:39], v2 offset:35328
    s_waitcnt lgkmcnt(8)
    v_smfmac_f32_16x16x64_bf16 v[24:27], v[16:19], v[40:47], v11
    v_mfma_f32_32x32x16_bf16 v[64:79], v[168:171], v[48:51], v[64:79]
    v_xor_b32 v3, 0x00003000, v3
    ds_read_b64_tr_b16 v[40:41], v3 offset:32768
    ds_read_b64_tr_b16 v[42:43], v3 offset:33280
    v_mfma_f32_32x32x16_bf16 v[64:79], v[172:175], v[52:55], v[64:79]
    ds_read_b64_tr_b16 v[44:45], v3 offset:34816
    ds_read_b64_tr_b16 v[46:47], v3 offset:35328
    s_waitcnt lgkmcnt(8)
    v_mfma_f32_32x32x16_bf16 v[80:95], v[168:171], v[56:59], v[80:95]
    v_xor_b32 v2, 0x00001000, v2
    ds_read_b64_tr_b16 v[48:49], v2 offset:32768
    ds_read_b64_tr_b16 v[50:51], v2 offset:33280
    v_mfma_f32_32x32x16_bf16 v[80:95], v[172:175], v[60:63], v[80:95]
    ds_read_b64_tr_b16 v[52:53], v2 offset:34816
    ds_read_b64_tr_b16 v[54:55], v2 offset:35328
    s_waitcnt vmcnt(0)
    s_barrier
    s_waitcnt lgkmcnt(8)
    v_mfma_f32_32x32x16_bf16 v[64:79], v[176:179], v[32:35], v[64:79]
    v_xor_b32 v3, 0x00001000, v3
    ds_read_b64_tr_b16 v[56:57], v3 offset:32768
    ds_read_b64_tr_b16 v[58:59], v3 offset:33280
    v_mfma_f32_32x32x16_bf16 v[64:79], v[180:183], v[36:39], v[64:79]
    ds_read_b64_tr_b16 v[60:61], v3 offset:34816
    ds_read_b64_tr_b16 v[62:63], v3 offset:35328
    s_waitcnt lgkmcnt(8)
    v_mfma_f32_32x32x16_bf16 v[80:95], v[176:179], v[40:43], v[80:95]
    v_xor_b32 v2, 0x00003000, v2
    ds_read_b64_tr_b16 v[32:33], v2 offset:49152
    ds_read_b64_tr_b16 v[34:35], v2 offset:49664
    v_mfma_f32_32x32x16_bf16 v[80:95], v[180:183], v[44:47], v[80:95]
    ds_read_b64_tr_b16 v[36:37], v2 offset:51200
    ds_read_b64_tr_b16 v[38:39], v2 offset:51712
    s_waitcnt lgkmcnt(8)
    v_mfma_f32_32x32x16_bf16 v[64:79], v[184:187], v[48:51], v[64:79]
    v_xor_b32 v3, 0x00003000, v3
    ds_read_b64_tr_b16 v[40:41], v3 offset:49152
    ds_read_b64_tr_b16 v[42:43], v3 offset:49664
    v_mfma_f32_32x32x16_bf16 v[64:79], v[188:191], v[52:55], v[64:79]
    ds_read_b64_tr_b16 v[44:45], v3 offset:51200
    ds_read_b64_tr_b16 v[46:47], v3 offset:51712
    s_waitcnt lgkmcnt(8)
    v_mfma_f32_32x32x16_bf16 v[80:95], v[184:187], v[56:59], v[80:95]
    v_xor_b32 v2, 0x00001000, v2
    ds_read_b64_tr_b16 v[48:49], v2 offset:49152
    ds_read_b64_tr_b16 v[50:51], v2 offset:49664
    v_mfma_f32_32x32x16_bf16 v[80:95], v[188:191], v[60:63], v[80:95]
    ds_read_b64_tr_b16 v[52:53], v2 offset:51200
    ds_read_b64_tr_b16 v[54:55], v2 offset:51712
    s_waitcnt lgkmcnt(8)
    v_mfma_f32_32x32x16_bf16 v[64:79], v[192:195], v[32:35], v[64:79]
    v_xor_b32 v3, 0x00001000, v3
    ds_read_b64_tr_b16 v[56:57], v3 offset:49152
    ds_read_b64_tr_b16 v[58:59], v3 offset:49664
    v_mfma_f32_32x32x16_bf16 v[64:79], v[196:199], v[36:39], v[64:79]
    ds_read_b64_tr_b16 v[60:61], v3 offset:51200
    ds_read_b64_tr_b16 v[62:63], v3 offset:51712
    s_waitcnt lgkmcnt(8)
    v_smfmac_f32_16x16x64_bf16 v[20:23], v[16:19], v[32:39], v11
    v_mfma_f32_32x32x16_bf16 v[80:95], v[192:195], v[40:43], v[80:95]
    v_xor_b32 v2, 0x00003000, v2
    ds_read_b64_tr_b16 v[32:33], v2 offset:49152
    ds_read_b64_tr_b16 v[34:35], v2 offset:49664
    v_mfma_f32_32x32x16_bf16 v[80:95], v[196:199], v[44:47], v[80:95]
    ds_read_b64_tr_b16 v[36:37], v2 offset:51200
    ds_read_b64_tr_b16 v[38:39], v2 offset:51712
    s_waitcnt lgkmcnt(8)
    v_smfmac_f32_16x16x64_bf16 v[24:27], v[16:19], v[40:47], v11
    v_mfma_f32_32x32x16_bf16 v[64:79], v[200:203], v[48:51], v[64:79]
    v_xor_b32 v3, 0x00003000, v3
    ds_read_b64_tr_b16 v[40:41], v3 offset:49152
    ds_read_b64_tr_b16 v[42:43], v3 offset:49664
    v_mfma_f32_32x32x16_bf16 v[64:79], v[204:207], v[52:55], v[64:79]
    ds_read_b64_tr_b16 v[44:45], v3 offset:51200
    ds_read_b64_tr_b16 v[46:47], v3 offset:51712
    s_waitcnt lgkmcnt(8)
    v_mfma_f32_32x32x16_bf16 v[80:95], v[200:203], v[56:59], v[80:95]
    v_xor_b32 v2, 0x00001000, v2
    ds_read_b64_tr_b16 v[48:49], v2 offset:49152
    ds_read_b64_tr_b16 v[50:51], v2 offset:49664
    v_mfma_f32_32x32x16_bf16 v[80:95], v[204:207], v[60:63], v[80:95]
    ds_read_b64_tr_b16 v[52:53], v2 offset:51200
    ds_read_b64_tr_b16 v[54:55], v2 offset:51712
    s_waitcnt lgkmcnt(8)
    v_mfma_f32_32x32x16_bf16 v[64:79], v[208:211], v[32:35], v[64:79]
    v_xor_b32 v3, 0x00001000, v3
    ds_read_b64_tr_b16 v[56:57], v3 offset:49152
    ds_read_b64_tr_b16 v[58:59], v3 offset:49664
    v_mfma_f32_32x32x16_bf16 v[64:79], v[212:215], v[36:39], v[64:79]
    ds_read_b64_tr_b16 v[60:61], v3 offset:51200
    ds_read_b64_tr_b16 v[62:63], v3 offset:51712
    s_waitcnt lgkmcnt(8)
    v_mfma_f32_32x32x16_bf16 v[80:95], v[208:211], v[40:43], v[80:95]
    v_xor_b32 v2, 0x00003000, v2
    v_add_u32 v2, s26, v2
    ds_read_b64_tr_b16 v[32:33], v2 offset:0
    ds_read_b64_tr_b16 v[34:35], v2 offset:512
    v_mfma_f32_32x32x16_bf16 v[80:95], v[212:215], v[44:47], v[80:95]
    ds_read_b64_tr_b16 v[36:37], v2 offset:2048
    ds_read_b64_tr_b16 v[38:39], v2 offset:2560
    s_waitcnt lgkmcnt(8)
    v_mfma_f32_32x32x16_bf16 v[64:79], v[216:219], v[48:51], v[64:79]
    v_xor_b32 v3, 0x00003000, v3
    v_add_u32 v3, s26, v3
    ds_read_b64_tr_b16 v[40:41], v3 offset:0
    ds_read_b64_tr_b16 v[42:43], v3 offset:512
    v_mfma_f32_32x32x16_bf16 v[64:79], v[220:223], v[52:55], v[64:79]
    ds_read_b64_tr_b16 v[44:45], v3 offset:2048
    ds_read_b64_tr_b16 v[46:47], v3 offset:2560
    s_waitcnt lgkmcnt(8)
    v_mfma_f32_32x32x16_bf16 v[80:95], v[216:219], v[56:59], v[80:95]
    v_xor_b32 v2, 0x00001000, v2
    ds_read_b64_tr_b16 v[48:49], v2 offset:0
    ds_read_b64_tr_b16 v[50:51], v2 offset:512
    v_mfma_f32_32x32x16_bf16 v[80:95], v[220:223], v[60:63], v[80:95]
    ds_read_b64_tr_b16 v[52:53], v2 offset:2048
    ds_read_b64_tr_b16 v[54:55], v2 offset:2560
    s_waitcnt lgkmcnt(8)
    v_mfma_f32_32x32x16_bf16 v[64:79], v[224:227], v[32:35], v[64:79]
    v_xor_b32 v3, 0x00001000, v3
    ds_read_b64_tr_b16 v[56:57], v3 offset:0
    ds_read_b64_tr_b16 v[58:59], v3 offset:512
    v_mfma_f32_32x32x16_bf16 v[64:79], v[228:231], v[36:39], v[64:79]
    ds_read_b64_tr_b16 v[60:61], v3 offset:2048
    ds_read_b64_tr_b16 v[62:63], v3 offset:2560
    s_waitcnt lgkmcnt(8)
    v_smfmac_f32_16x16x64_bf16 v[20:23], v[16:19], v[32:39], v11
    v_mfma_f32_32x32x16_bf16 v[80:95], v[224:227], v[40:43], v[80:95]
    v_xor_b32 v2, 0x00003000, v2
    ds_read_b64_tr_b16 v[32:33], v2 offset:0
    ds_read_b64_tr_b16 v[34:35], v2 offset:512
    v_mfma_f32_32x32x16_bf16 v[80:95], v[228:231], v[44:47], v[80:95]
    ds_read_b64_tr_b16 v[36:37], v2 offset:2048
    ds_read_b64_tr_b16 v[38:39], v2 offset:2560
    s_waitcnt lgkmcnt(8)
    v_smfmac_f32_16x16x64_bf16 v[24:27], v[16:19], v[40:47], v11
    v_mfma_f32_32x32x16_bf16 v[64:79], v[232:235], v[48:51], v[64:79]
    v_xor_b32 v3, 0x00003000, v3
    ds_read_b64_tr_b16 v[40:41], v3 offset:0
    ds_read_b64_tr_b16 v[42:43], v3 offset:512
    v_mfma_f32_32x32x16_bf16 v[64:79], v[236:239], v[52:55], v[64:79]
    ds_read_b64_tr_b16 v[44:45], v3 offset:2048
    ds_read_b64_tr_b16 v[46:47], v3 offset:2560
    s_waitcnt lgkmcnt(8)
    v_mfma_f32_32x32x16_bf16 v[80:95], v[232:235], v[56:59], v[80:95]
    v_xor_b32 v2, 0x00001000, v2
    ds_read_b64_tr_b16 v[48:49], v2 offset:0
    ds_read_b64_tr_b16 v[50:51], v2 offset:512
    v_mfma_f32_32x32x16_bf16 v[80:95], v[236:239], v[60:63], v[80:95]
    ds_read_b64_tr_b16 v[52:53], v2 offset:2048
    ds_read_b64_tr_b16 v[54:55], v2 offset:2560
    s_lshl2_add_u32 s58, s4, 147456
    v_add_u32 v12, s58, v13
    v_add_f32 v20, v20, v21
    s_waitcnt lgkmcnt(8)
    v_mfma_f32_32x32x16_bf16 v[64:79], v[240:243], v[32:35], v[64:79]
    v_xor_b32 v3, 0x00001000, v3
    ds_read_b64_tr_b16 v[56:57], v3 offset:0
    ds_read_b64_tr_b16 v[58:59], v3 offset:512
    v_add_f32 v20, v20, v0
    v_add_f32 v24, v24, v25
    v_add_f32 v24, v24, v1
    v_mfma_f32_32x32x16_bf16 v[64:79], v[244:247], v[36:39], v[64:79]
    ds_read_b64_tr_b16 v[60:61], v3 offset:2048
    ds_read_b64_tr_b16 v[62:63], v3 offset:2560
    ds_write2st64_b32 v12, v20, v24 offset0:0 offset1:4
    v_mov_b32 v20, 0
    v_mov_b32 v21, 0
    s_waitcnt lgkmcnt(9)
    v_mfma_f32_32x32x16_bf16 v[80:95], v[240:243], v[40:43], v[80:95]
    v_mov_b32 v24, 0
    v_mov_b32 v25, 0
    v_xor_b32 v2, 0x3000, v2
    v_subrev_u32 v2, s26, v2
    v_mfma_f32_32x32x16_bf16 v[80:95], v[244:247], v[44:47], v[80:95]
    v_xor_b32 v3, 0x3000, v3
    v_subrev_u32 v3, s26, v3
    s_waitcnt lgkmcnt(0)
    s_setprio 3
    s_barrier
    v_mfma_f32_32x32x16_bf16 v[64:79], v[248:251], v[48:51], v[64:79]
    v_mfma_f32_32x32x16_bf16 v[64:79], v[252:255], v[52:55], v[64:79]
    v_mfma_f32_32x32x16_bf16 v[80:95], v[248:251], v[56:59], v[80:95]
    v_mfma_f32_32x32x16_bf16 v[80:95], v[252:255], v[60:63], v[80:95]
    s_branch LB_2
LC:
    s_setprio 2
    ds_read_b64_tr_b16 v[32:33], v2 offset:0
    ds_read_b64_tr_b16 v[34:35], v2 offset:512
    ds_read_b64_tr_b16 v[36:37], v2 offset:2048
    ds_read_b64_tr_b16 v[38:39], v2 offset:2560
    ds_read_b64_tr_b16 v[40:41], v3 offset:0
    ds_read_b64_tr_b16 v[42:43], v3 offset:512
    ds_read_b64_tr_b16 v[44:45], v3 offset:2048
    ds_read_b64_tr_b16 v[46:47], v3 offset:2560
    v_xor_b32 v2, 0x00001000, v2
    ds_read_b64_tr_b16 v[48:49], v2 offset:0
    ds_read_b64_tr_b16 v[50:51], v2 offset:512
    ds_read_b64_tr_b16 v[52:53], v2 offset:2048
    ds_read_b64_tr_b16 v[54:55], v2 offset:2560
    s_waitcnt lgkmcnt(8)
    v_mfma_f32_32x32x16_bf16 v[64:79], v[32:35], v[96:99], 0
    v_xor_b32 v3, 0x00001000, v3
    ds_read_b64_tr_b16 v[56:57], v3 offset:0
    ds_read_b64_tr_b16 v[58:59], v3 offset:512
    v_mfma_f32_32x32x16_bf16 v[64:79], v[36:39], v[100:103], v[64:79]
    ds_read_b64_tr_b16 v[60:61], v3 offset:2048
    ds_read_b64_tr_b16 v[62:63], v3 offset:2560
    s_waitcnt lgkmcnt(8)
    v_smfmac_f32_16x16x64_bf16 v[20:23], v[16:19], v[32:39], v11
    v_mfma_f32_32x32x16_bf16 v[80:95], v[40:43], v[96:99], 0
    v_xor_b32 v2, 0x00003000, v2
    ds_read_b64_tr_b16 v[32:33], v2 offset:0
    ds_read_b64_tr_b16 v[34:35], v2 offset:512
    v_mfma_f32_32x32x16_bf16 v[80:95], v[44:47], v[100:103], v[80:95]
    ds_read_b64_tr_b16 v[36:37], v2 offset:2048
    ds_read_b64_tr_b16 v[38:39], v2 offset:2560
    s_waitcnt lgkmcnt(8)
    v_smfmac_f32_16x16x64_bf16 v[24:27], v[16:19], v[40:47], v11
    v_mfma_f32_32x32x16_bf16 v[64:79], v[48:51], v[104:107], v[64:79]
    v_xor_b32 v3, 0x00003000, v3
    ds_read_b64_tr_b16 v[40:41], v3 offset:0
    ds_read_b64_tr_b16 v[42:43], v3 offset:512
    v_mfma_f32_32x32x16_bf16 v[64:79], v[52:55], v[108:111], v[64:79]
    ds_read_b64_tr_b16 v[44:45], v3 offset:2048
    ds_read_b64_tr_b16 v[46:47], v3 offset:2560
    s_waitcnt lgkmcnt(8)
    v_mfma_f32_32x32x16_bf16 v[80:95], v[56:59], v[104:107], v[80:95]
    v_xor_b32 v2, 0x00001000, v2
    ds_read_b64_tr_b16 v[48:49], v2 offset:0
    ds_read_b64_tr_b16 v[50:51], v2 offset:512
    v_mfma_f32_32x32x16_bf16 v[80:95], v[60:63], v[108:111], v[80:95]
    ds_read_b64_tr_b16 v[52:53], v2 offset:2048
    ds_read_b64_tr_b16 v[54:55], v2 offset:2560
    s_waitcnt lgkmcnt(8)
    v_mfma_f32_32x32x16_bf16 v[64:79], v[32:35], v[112:115], v[64:79]
    v_xor_b32 v3, 0x00001000, v3
    ds_read_b64_tr_b16 v[56:57], v3 offset:0
    ds_read_b64_tr_b16 v[58:59], v3 offset:512
    v_mfma_f32_32x32x16_bf16 v[64:79], v[36:39], v[116:119], v[64:79]
    ds_read_b64_tr_b16 v[60:61], v3 offset:2048
    ds_read_b64_tr_b16 v[62:63], v3 offset:2560
    s_waitcnt lgkmcnt(8)
    v_mfma_f32_32x32x16_bf16 v[80:95], v[40:43], v[112:115], v[80:95]
    v_xor_b32 v2, 0x00003000, v2
    ds_read_b64_tr_b16 v[32:33], v2 offset:16384
    ds_read_b64_tr_b16 v[34:35], v2 offset:16896
    v_mfma_f32_32x32x16_bf16 v[80:95], v[44:47], v[116:119], v[80:95]
    ds_read_b64_tr_b16 v[36:37], v2 offset:18432
    ds_read_b64_tr_b16 v[38:39], v2 offset:18944
    s_waitcnt lgkmcnt(8)
    v_mfma_f32_32x32x16_bf16 v[64:79], v[48:51], v[120:123], v[64:79]
    v_xor_b32 v3, 0x00003000, v3
    ds_read_b64_tr_b16 v[40:41], v3 offset:16384
    ds_read_b64_tr_b16 v[42:43], v3 offset:16896
    v_mfma_f32_32x32x16_bf16 v[64:79], v[52:55], v[124:127], v[64:79]
    ds_read_b64_tr_b16 v[44:45], v3 offset:18432
    ds_read_b64_tr_b16 v[46:47], v3 offset:18944
    s_waitcnt lgkmcnt(8)
    v_mfma_f32_32x32x16_bf16 v[80:95], v[56:59], v[120:123], v[80:95]
    v_xor_b32 v2, 0x00001000, v2
    ds_read_b64_tr_b16 v[48:49], v2 offset:16384
    ds_read_b64_tr_b16 v[50:51], v2 offset:16896
    v_mfma_f32_32x32x16_bf16 v[80:95], v[60:63], v[124:127], v[80:95]
    ds_read_b64_tr_b16 v[52:53], v2 offset:18432
    ds_read_b64_tr_b16 v[54:55], v2 offset:18944
    s_waitcnt lgkmcnt(8)
    v_mfma_f32_32x32x16_bf16 v[64:79], v[32:35], v[128:131], v[64:79]
    v_xor_b32 v3, 0x00001000, v3
    ds_read_b64_tr_b16 v[56:57], v3 offset:16384
    ds_read_b64_tr_b16 v[58:59], v3 offset:16896
    v_mfma_f32_32x32x16_bf16 v[64:79], v[36:39], v[132:135], v[64:79]
    ds_read_b64_tr_b16 v[60:61], v3 offset:18432
    ds_read_b64_tr_b16 v[62:63], v3 offset:18944
    s_waitcnt lgkmcnt(8)
    v_smfmac_f32_16x16x64_bf16 v[20:23], v[16:19], v[32:39], v11
    v_mfma_f32_32x32x16_bf16 v[80:95], v[40:43], v[128:131], v[80:95]
    v_xor_b32 v2, 0x00003000, v2
    ds_read_b64_tr_b16 v[32:33], v2 offset:16384
    ds_read_b64_tr_b16 v[34:35], v2 offset:16896
    v_mfma_f32_32x32x16_bf16 v[80:95], v[44:47], v[132:135], v[80:95]
    ds_read_b64_tr_b16 v[36:37], v2 offset:18432
    ds_read_b64_tr_b16 v[38:39], v2 offset:18944
    s_waitcnt lgkmcnt(8)
    v_smfmac_f32_16x16x64_bf16 v[24:27], v[16:19], v[40:47], v11
    v_mfma_f32_32x32x16_bf16 v[64:79], v[48:51], v[136:139], v[64:79]
    v_xor_b32 v3, 0x00003000, v3
    ds_read_b64_tr_b16 v[40:41], v3 offset:16384
    ds_read_b64_tr_b16 v[42:43], v3 offset:16896
    v_mfma_f32_32x32x16_bf16 v[64:79], v[52:55], v[140:143], v[64:79]
    ds_read_b64_tr_b16 v[44:45], v3 offset:18432
    ds_read_b64_tr_b16 v[46:47], v3 offset:18944
    s_waitcnt lgkmcnt(8)
    v_mfma_f32_32x32x16_bf16 v[80:95], v[56:59], v[136:139], v[80:95]
    v_xor_b32 v2, 0x00001000, v2
    ds_read_b64_tr_b16 v[48:49], v2 offset:16384
    ds_read_b64_tr_b16 v[50:51], v2 offset:16896
    v_mfma_f32_32x32x16_bf16 v[80:95], v[60:63], v[140:143], v[80:95]
    ds_read_b64_tr_b16 v[52:53], v2 offset:18432
    ds_read_b64_tr_b16 v[54:55], v2 offset:18944
    s_waitcnt lgkmcnt(8)
    v_mfma_f32_32x32x16_bf16 v[64:79], v[32:35], v[144:147], v[64:79]
    v_xor_b32 v3, 0x00001000, v3
    ds_read_b64_tr_b16 v[56:57], v3 offset:16384
    ds_read_b64_tr_b16 v[58:59], v3 offset:16896
    v_mfma_f32_32x32x16_bf16 v[64:79], v[36:39], v[148:151], v[64:79]
    ds_read_b64_tr_b16 v[60:61], v3 offset:18432
    ds_read_b64_tr_b16 v[62:63], v3 offset:18944
    s_waitcnt lgkmcnt(8)
    v_mfma_f32_32x32x16_bf16 v[80:95], v[40:43], v[144:147], v[80:95]
    v_xor_b32 v2, 0x00003000, v2
    ds_read_b64_tr_b16 v[32:33], v2 offset:32768
    ds_read_b64_tr_b16 v[34:35], v2 offset:33280
    v_mfma_f32_32x32x16_bf16 v[80:95], v[44:47], v[148:151], v[80:95]
    ds_read_b64_tr_b16 v[36:37], v2 offset:34816
    ds_read_b64_tr_b16 v[38:39], v2 offset:35328
    s_waitcnt lgkmcnt(8)
    v_mfma_f32_32x32x16_bf16 v[64:79], v[48:51], v[152:155], v[64:79]
    v_xor_b32 v3, 0x00003000, v3
    ds_read_b64_tr_b16 v[40:41], v3 offset:32768
    ds_read_b64_tr_b16 v[42:43], v3 offset:33280
    v_mfma_f32_32x32x16_bf16 v[64:79], v[52:55], v[156:159], v[64:79]
    ds_read_b64_tr_b16 v[44:45], v3 offset:34816
    ds_read_b64_tr_b16 v[46:47], v3 offset:35328
    s_waitcnt lgkmcnt(8)
    v_mfma_f32_32x32x16_bf16 v[80:95], v[56:59], v[152:155], v[80:95]
    v_xor_b32 v2, 0x00001000, v2
    ds_read_b64_tr_b16 v[48:49], v2 offset:32768
    ds_read_b64_tr_b16 v[50:51], v2 offset:33280
    v_mfma_f32_32x32x16_bf16 v[80:95], v[60:63], v[156:159], v[80:95]
    ds_read_b64_tr_b16 v[52:53], v2 offset:34816
    ds_read_b64_tr_b16 v[54:55], v2 offset:35328
    s_waitcnt lgkmcnt(8)
    v_mfma_f32_32x32x16_bf16 v[64:79], v[32:35], v[160:163], v[64:79]
    v_xor_b32 v3, 0x00001000, v3
    ds_read_b64_tr_b16 v[56:57], v3 offset:32768
    ds_read_b64_tr_b16 v[58:59], v3 offset:33280
    v_mfma_f32_32x32x16_bf16 v[64:79], v[36:39], v[164:167], v[64:79]
    ds_read_b64_tr_b16 v[60:61], v3 offset:34816
    ds_read_b64_tr_b16 v[62:63], v3 offset:35328
    s_waitcnt lgkmcnt(8)
    v_smfmac_f32_16x16x64_bf16 v[20:23], v[16:19], v[32:39], v11
    v_mfma_f32_32x32x16_bf16 v[80:95], v[40:43], v[160:163], v[80:95]
    v_xor_b32 v2, 0x00003000, v2
    ds_read_b64_tr_b16 v[32:33], v2 offset:32768
    ds_read_b64_tr_b16 v[34:35], v2 offset:33280
    v_mfma_f32_32x32x16_bf16 v[80:95], v[44:47], v[164:167], v[80:95]
    ds_read_b64_tr_b16 v[36:37], v2 offset:34816
    ds_read_b64_tr_b16 v[38:39], v2 offset:35328
    s_waitcnt lgkmcnt(8)
    v_smfmac_f32_16x16x64_bf16 v[24:27], v[16:19], v[40:47], v11
    v_mfma_f32_32x32x16_bf16 v[64:79], v[48:51], v[168:171], v[64:79]
    v_xor_b32 v3, 0x00003000, v3
    ds_read_b64_tr_b16 v[40:41], v3 offset:32768
    ds_read_b64_tr_b16 v[42:43], v3 offset:33280
    v_mfma_f32_32x32x16_bf16 v[64:79], v[52:55], v[172:175], v[64:79]
    ds_read_b64_tr_b16 v[44:45], v3 offset:34816
    ds_read_b64_tr_b16 v[46:47], v3 offset:35328
    s_waitcnt lgkmcnt(8)
    v_mfma_f32_32x32x16_bf16 v[80:95], v[56:59], v[168:171], v[80:95]
    v_xor_b32 v2, 0x00001000, v2
    ds_read_b64_tr_b16 v[48:49], v2 offset:32768
    ds_read_b64_tr_b16 v[50:51], v2 offset:33280
    v_mfma_f32_32x32x16_bf16 v[80:95], v[60:63], v[172:175], v[80:95]
    ds_read_b64_tr_b16 v[52:53], v2 offset:34816
    ds_read_b64_tr_b16 v[54:55], v2 offset:35328
    s_waitcnt vmcnt(0)
    s_barrier
    s_waitcnt lgkmcnt(8)
    v_mfma_f32_32x32x16_bf16 v[64:79], v[32:35], v[176:179], v[64:79]
    v_xor_b32 v3, 0x00001000, v3
    ds_read_b64_tr_b16 v[56:57], v3 offset:32768
    ds_read_b64_tr_b16 v[58:59], v3 offset:33280
    v_mfma_f32_32x32x16_bf16 v[64:79], v[36:39], v[180:183], v[64:79]
    ds_read_b64_tr_b16 v[60:61], v3 offset:34816
    ds_read_b64_tr_b16 v[62:63], v3 offset:35328
    s_waitcnt lgkmcnt(8)
    v_mfma_f32_32x32x16_bf16 v[80:95], v[40:43], v[176:179], v[80:95]
    v_xor_b32 v2, 0x00003000, v2
    ds_read_b64_tr_b16 v[32:33], v2 offset:49152
    ds_read_b64_tr_b16 v[34:35], v2 offset:49664
    v_mfma_f32_32x32x16_bf16 v[80:95], v[44:47], v[180:183], v[80:95]
    ds_read_b64_tr_b16 v[36:37], v2 offset:51200
    ds_read_b64_tr_b16 v[38:39], v2 offset:51712
    s_waitcnt lgkmcnt(8)
    v_mfma_f32_32x32x16_bf16 v[64:79], v[48:51], v[184:187], v[64:79]
    v_xor_b32 v3, 0x00003000, v3
    ds_read_b64_tr_b16 v[40:41], v3 offset:49152
    ds_read_b64_tr_b16 v[42:43], v3 offset:49664
    v_mfma_f32_32x32x16_bf16 v[64:79], v[52:55], v[188:191], v[64:79]
    ds_read_b64_tr_b16 v[44:45], v3 offset:51200
    ds_read_b64_tr_b16 v[46:47], v3 offset:51712
    s_waitcnt lgkmcnt(8)
    v_mfma_f32_32x32x16_bf16 v[80:95], v[56:59], v[184:187], v[80:95]
    v_xor_b32 v2, 0x00001000, v2
    ds_read_b64_tr_b16 v[48:49], v2 offset:49152
    ds_read_b64_tr_b16 v[50:51], v2 offset:49664
    v_mfma_f32_32x32x16_bf16 v[80:95], v[60:63], v[188:191], v[80:95]
    ds_read_b64_tr_b16 v[52:53], v2 offset:51200
    ds_read_b64_tr_b16 v[54:55], v2 offset:51712
    s_waitcnt lgkmcnt(8)
    v_mfma_f32_32x32x16_bf16 v[64:79], v[32:35], v[192:195], v[64:79]
    v_xor_b32 v3, 0x00001000, v3
    ds_read_b64_tr_b16 v[56:57], v3 offset:49152
    ds_read_b64_tr_b16 v[58:59], v3 offset:49664
    v_mfma_f32_32x32x16_bf16 v[64:79], v[36:39], v[196:199], v[64:79]
    ds_read_b64_tr_b16 v[60:61], v3 offset:51200
    ds_read_b64_tr_b16 v[62:63], v3 offset:51712
    s_waitcnt lgkmcnt(8)
    v_smfmac_f32_16x16x64_bf16 v[20:23], v[16:19], v[32:39], v11
    v_mfma_f32_32x32x16_bf16 v[80:95], v[40:43], v[192:195], v[80:95]
    v_xor_b32 v2, 0x00003000, v2
    ds_read_b64_tr_b16 v[32:33], v2 offset:49152
    ds_read_b64_tr_b16 v[34:35], v2 offset:49664
    v_mfma_f32_32x32x16_bf16 v[80:95], v[44:47], v[196:199], v[80:95]
    ds_read_b64_tr_b16 v[36:37], v2 offset:51200
    ds_read_b64_tr_b16 v[38:39], v2 offset:51712
    s_waitcnt lgkmcnt(8)
    v_smfmac_f32_16x16x64_bf16 v[24:27], v[16:19], v[40:47], v11
    v_mfma_f32_32x32x16_bf16 v[64:79], v[48:51], v[200:203], v[64:79]
    v_xor_b32 v3, 0x00003000, v3
    ds_read_b64_tr_b16 v[40:41], v3 offset:49152
    ds_read_b64_tr_b16 v[42:43], v3 offset:49664
    v_mfma_f32_32x32x16_bf16 v[64:79], v[52:55], v[204:207], v[64:79]
    ds_read_b64_tr_b16 v[44:45], v3 offset:51200
    ds_read_b64_tr_b16 v[46:47], v3 offset:51712
    s_waitcnt lgkmcnt(8)
    v_mfma_f32_32x32x16_bf16 v[80:95], v[56:59], v[200:203], v[80:95]
    v_xor_b32 v2, 0x00001000, v2
    ds_read_b64_tr_b16 v[48:49], v2 offset:49152
    ds_read_b64_tr_b16 v[50:51], v2 offset:49664
    v_mfma_f32_32x32x16_bf16 v[80:95], v[60:63], v[204:207], v[80:95]
    ds_read_b64_tr_b16 v[52:53], v2 offset:51200
    ds_read_b64_tr_b16 v[54:55], v2 offset:51712
    s_waitcnt lgkmcnt(8)
    v_mfma_f32_32x32x16_bf16 v[64:79], v[32:35], v[208:211], v[64:79]
    v_xor_b32 v3, 0x00001000, v3
    ds_read_b64_tr_b16 v[56:57], v3 offset:49152
    ds_read_b64_tr_b16 v[58:59], v3 offset:49664
    v_mfma_f32_32x32x16_bf16 v[64:79], v[36:39], v[212:215], v[64:79]
    ds_read_b64_tr_b16 v[60:61], v3 offset:51200
    ds_read_b64_tr_b16 v[62:63], v3 offset:51712
    s_waitcnt lgkmcnt(8)
    v_mfma_f32_32x32x16_bf16 v[80:95], v[40:43], v[208:211], v[80:95]
    v_xor_b32 v2, 0x00003000, v2
    v_add_u32 v2, s26, v2
    ds_read_b64_tr_b16 v[32:33], v2 offset:0
    ds_read_b64_tr_b16 v[34:35], v2 offset:512
    v_mfma_f32_32x32x16_bf16 v[80:95], v[44:47], v[212:215], v[80:95]
    ds_read_b64_tr_b16 v[36:37], v2 offset:2048
    ds_read_b64_tr_b16 v[38:39], v2 offset:2560
    s_waitcnt lgkmcnt(8)
    v_mfma_f32_32x32x16_bf16 v[64:79], v[48:51], v[216:219], v[64:79]
    v_xor_b32 v3, 0x00003000, v3
    v_add_u32 v3, s26, v3
    ds_read_b64_tr_b16 v[40:41], v3 offset:0
    ds_read_b64_tr_b16 v[42:43], v3 offset:512
    v_mfma_f32_32x32x16_bf16 v[64:79], v[52:55], v[220:223], v[64:79]
    ds_read_b64_tr_b16 v[44:45], v3 offset:2048
    ds_read_b64_tr_b16 v[46:47], v3 offset:2560
    s_waitcnt lgkmcnt(8)
    v_mfma_f32_32x32x16_bf16 v[80:95], v[56:59], v[216:219], v[80:95]
    v_xor_b32 v2, 0x00001000, v2
    ds_read_b64_tr_b16 v[48:49], v2 offset:0
    ds_read_b64_tr_b16 v[50:51], v2 offset:512
    v_mfma_f32_32x32x16_bf16 v[80:95], v[60:63], v[220:223], v[80:95]
    ds_read_b64_tr_b16 v[52:53], v2 offset:2048
    ds_read_b64_tr_b16 v[54:55], v2 offset:2560
    s_waitcnt lgkmcnt(8)
    v_mfma_f32_32x32x16_bf16 v[64:79], v[32:35], v[224:227], v[64:79]
    v_xor_b32 v3, 0x00001000, v3
    ds_read_b64_tr_b16 v[56:57], v3 offset:0
    ds_read_b64_tr_b16 v[58:59], v3 offset:512
    v_mfma_f32_32x32x16_bf16 v[64:79], v[36:39], v[228:231], v[64:79]
    ds_read_b64_tr_b16 v[60:61], v3 offset:2048
    ds_read_b64_tr_b16 v[62:63], v3 offset:2560
    s_waitcnt lgkmcnt(8)
    v_smfmac_f32_16x16x64_bf16 v[20:23], v[16:19], v[32:39], v11
    v_mfma_f32_32x32x16_bf16 v[80:95], v[40:43], v[224:227], v[80:95]
    v_xor_b32 v2, 0x00003000, v2
    ds_read_b64_tr_b16 v[32:33], v2 offset:0
    ds_read_b64_tr_b16 v[34:35], v2 offset:512
    v_mfma_f32_32x32x16_bf16 v[80:95], v[44:47], v[228:231], v[80:95]
    ds_read_b64_tr_b16 v[36:37], v2 offset:2048
    ds_read_b64_tr_b16 v[38:39], v2 offset:2560
    s_waitcnt lgkmcnt(8)
    v_smfmac_f32_16x16x64_bf16 v[24:27], v[16:19], v[40:47], v11
    v_mfma_f32_32x32x16_bf16 v[64:79], v[48:51], v[232:235], v[64:79]
    v_xor_b32 v3, 0x00003000, v3
    ds_read_b64_tr_b16 v[40:41], v3 offset:0
    ds_read_b64_tr_b16 v[42:43], v3 offset:512
    v_mfma_f32_32x32x16_bf16 v[64:79], v[52:55], v[236:239], v[64:79]
    ds_read_b64_tr_b16 v[44:45], v3 offset:2048
    ds_read_b64_tr_b16 v[46:47], v3 offset:2560
    s_waitcnt lgkmcnt(8)
    v_mfma_f32_32x32x16_bf16 v[80:95], v[56:59], v[232:235], v[80:95]
    v_xor_b32 v2, 0x00001000, v2
    ds_read_b64_tr_b16 v[48:49], v2 offset:0
    ds_read_b64_tr_b16 v[50:51], v2 offset:512
    v_mfma_f32_32x32x16_bf16 v[80:95], v[60:63], v[236:239], v[80:95]
    ds_read_b64_tr_b16 v[52:53], v2 offset:2048
    ds_read_b64_tr_b16 v[54:55], v2 offset:2560
    s_lshl2_add_u32 s58, s4, 147456
    v_add_u32 v12, s58, v13
    v_add_f32 v20, v20, v21
    s_waitcnt lgkmcnt(8)
    v_mfma_f32_32x32x16_bf16 v[64:79], v[32:35], v[240:243], v[64:79]
    v_xor_b32 v3, 0x00001000, v3
    ds_read_b64_tr_b16 v[56:57], v3 offset:0
    ds_read_b64_tr_b16 v[58:59], v3 offset:512
    v_add_f32 v20, v20, v0
    v_add_f32 v24, v24, v25
    v_add_f32 v24, v24, v1
    v_mfma_f32_32x32x16_bf16 v[64:79], v[36:39], v[244:247], v[64:79]
    ds_read_b64_tr_b16 v[60:61], v3 offset:2048
    ds_read_b64_tr_b16 v[62:63], v3 offset:2560
    ds_write2st64_b32 v12, v20, v24 offset0:0 offset1:4
    v_mov_b32 v20, 0
    v_mov_b32 v21, 0
    s_waitcnt lgkmcnt(9)
    v_mfma_f32_32x32x16_bf16 v[80:95], v[40:43], v[240:243], v[80:95]
    v_mov_b32 v24, 0
    v_mov_b32 v25, 0
    v_xor_b32 v2, 0x3000, v2
    v_subrev_u32 v2, s26, v2
    v_mfma_f32_32x32x16_bf16 v[80:95], v[44:47], v[244:247], v[80:95]
    v_xor_b32 v3, 0x3000, v3
    v_subrev_u32 v3, s26, v3
    s_waitcnt lgkmcnt(0)
    s_setprio 3
    s_barrier
    v_mfma_f32_32x32x16_bf16 v[64:79], v[48:51], v[248:251], v[64:79]
    v_mfma_f32_32x32x16_bf16 v[64:79], v[52:55], v[252:255], v[64:79]
    v_mfma_f32_32x32x16_bf16 v[80:95], v[56:59], v[248:251], v[80:95]
    v_mfma_f32_32x32x16_bf16 v[80:95], v[60:63], v[252:255], v[80:95]
    s_cmp_eq_u32 s44, 2
    s_cbranch_scc1 LA_3
    s_cmp_eq_u32 s44, 3
    s_cbranch_scc1 LB_t4
LB_2:
    s_mov_b32 s44, 2
    s_cmp_eq_u32 s7, 15
    s_cbranch_scc1 LH2h
    s_sub_u32 s58, s7, 10
    s_cmp_lt_u32 s58, 5
    s_cbranch_scc0 LH2q
    v_add_u32 v12, 147456, v13
    ds_read_b128 v[32:35], v12 offset:0
    ds_read_b128 v[36:39], v12 offset:1024
    s_setprio 0
    s_lshl_b32 s62, s4, 10
    s_add_u32 s62, s62, 151552
    v_add_u32 v40, s62, v13
    ds_read_b128 v[6:9], v40
    s_mov_b32 m0, s52
    s_mul_i32 s58, s43, s100
    s_add_u32 s58, s58, s42
    buffer_load_dwordx4 v28, s[12:15], s58 offen offset:0 lds
    buffer_load_dwordx4 v29, s[12:15], s58 offen offset:1024 lds
    buffer_load_dwordx4 v30, s[12:15], s58 offen offset:2048 lds
    buffer_load_dwordx4 v31, s[12:15], s58 offen offset:3072 lds
    s_waitcnt lgkmcnt(2)
    v_add_f32 v32, v32, v33
    v_add_f32 v34, v34, v35
    v_add_f32 v32, v32, v34
    v_cvt_pk_bf16_f32 v35, v32, 0
    v_lshlrev_b32 v33, 16, v35
    v_sub_f32 v33, v32, v33
    v_cvt_pk_bf16_f32 v34, v32, v33
    s_waitcnt lgkmcnt(1)
    v_add_f32 v36, v36, v37
    v_add_f32 v38, v38, v39
    v_add_f32 v36, v36, v38
    v_cvt_pk_bf16_f32 v39, v36, 0
    v_lshlrev_b32 v37, 16, v39
    v_sub_f32 v37, v36, v37
    v_cvt_pk_bf16_f32 v38, v36, v37
    s_setprio 3
    s_waitcnt lgkmcnt(0)
    v_mfma_f32_32x32x8_bf16 v[64:79], v[6:7], v[34:35], v[64:79]
    v_mfma_f32_32x32x8_bf16 v[80:95], v[6:7], v[38:39], v[80:95]
    s_setprio 0
    s_lshl_b32 s62, s4, 7
    s_add_u32 s62, s62, 149504
    v_lshl_add_u32 v46, v14, 4, s62
    v_mul_u32_u24 v44, 9728, v14
    v_add_u32 v44, v44, v13
    v_lshl_add_u32 v44, s46, 9, v44
    v_add_u32 v45, 20480, v44
    ds_read_b128 v[32:35], v46 offset:0
    ds_read_b128 v[36:39], v46 offset:64
    s_waitcnt lgkmcnt(1)
    v_mul_f32 v64, v32, v64
    v_mul_f32 v65, v33, v65
    v_mul_f32 v66, v34, v66
    v_mul_f32 v67, v35, v67
    s_waitcnt lgkmcnt(0)
    v_mul_f32 v72, v36, v72
    v_mul_f32 v73, v37, v73
    v_mul_f32 v74, v38, v74
    v_mul_f32 v75, v39, v75
    v_cvt_pk_bf16_f32 v40, v64, v72
    v_cvt_pk_bf16_f32 v41, v65, v73
    v_cvt_pk_bf16_f32 v42, v66, v74
    v_cvt_pk_bf16_f32 v43, v67, v75
    buffer_store_dwordx4 v[40:43], v44, s[16:19], s49 offen offset:0 sc1
    ds_read_b128 v[32:35], v46 offset:32
    ds_read_b128 v[36:39], v46 offset:96
    s_waitcnt lgkmcnt(1)
    v_mul_f32 v68, v32, v68
    v_mul_f32 v69, v33, v69
    v_mul_f32 v70, v34, v70
    v_mul_f32 v71, v35, v71
    s_waitcnt lgkmcnt(0)
    v_mul_f32 v76, v36, v76
    v_mul_f32 v77, v37, v77
    v_mul_f32 v78, v38, v78
    v_mul_f32 v79, v39, v79
    v_cvt_pk_bf16_f32 v40, v68, v76
    v_cvt_pk_bf16_f32 v41, v69, v77
    v_cvt_pk_bf16_f32 v42, v70, v78
    v_cvt_pk_bf16_f32 v43, v71, v79
    buffer_store_dwordx4 v[40:43], v45, s[16:19], s49 offen offset:0 sc1
    ds_read_b128 v[32:35], v46 offset:0
    ds_read_b128 v[36:39], v46 offset:64
    s_waitcnt lgkmcnt(1)
    v_mul_f32 v80, v32, v80
    v_mul_f32 v81, v33, v81
    v_mul_f32 v82, v34, v82
    v_mul_f32 v83, v35, v83
    s_waitcnt lgkmcnt(0)
    v_mul_f32 v88, v36, v88
    v_mul_f32 v89, v37, v89
    v_mul_f32 v90, v38, v90
    v_mul_f32 v91, v39, v91
    v_cvt_pk_bf16_f32 v40, v80, v88
    v_cvt_pk_bf16_f32 v41, v81, v89
    v_cvt_pk_bf16_f32 v42, v82, v90
    v_cvt_pk_bf16_f32 v43, v83, v91
    buffer_store_dwordx4 v[40:43], v44, s[16:19], s49 offen offset:512 sc1
    ds_read_b128 v[32:35], v46 offset:32
    ds_read_b128 v[36:39], v46 offset:96
    s_waitcnt lgkmcnt(1)
    v_mul_f32 v84, v32, v84
    v_mul_f32 v85, v33, v85
    v_mul_f32 v86, v34, v86
    v_mul_f32 v87, v35, v87
    s_waitcnt lgkmcnt(0)
    v_mul_f32 v92, v36, v92
    v_mul_f32 v93, v37, v93
    v_mul_f32 v94, v38, v94
    v_mul_f32 v95, v39, v95
    v_cvt_pk_bf16_f32 v40, v84, v92
    v_cvt_pk_bf16_f32 v41, v85, v93
    v_cvt_pk_bf16_f32 v42, v86, v94
    v_cvt_pk_bf16_f32 v43, v87, v95
    buffer_store_dwordx4 v[40:43], v45, s[16:19], s49 offen offset:512 sc1
    s_add_u32 s42, s42, 128
    s_cmp_eq_u32 s45, 3
    s_cselect_b32 s14, 0, s14
    s_add_u32 m0, s27, 0
    s_mul_i32 s58, s43, s96
    s_add_u32 s58, s58, s42
    buffer_load_dwordx4 v28, s[12:15], s58 offen offset:0 lds
    buffer_load_dwordx4 v29, s[12:15], s58 offen offset:1024 lds
    buffer_load_dwordx4 v30, s[12:15], s58 offen offset:2048 lds
    buffer_load_dwordx4 v31, s[12:15], s58 offen offset:3072 lds
    s_add_u32 m0, s27, 16384
    s_mul_i32 s58, s43, s97
    s_add_u32 s58, s58, s42
    buffer_load_dwordx4 v28, s[12:15], s58 offen offset:0 lds
    buffer_load_dwordx4 v29, s[12:15], s58 offen offset:1024 lds
    buffer_load_dwordx4 v30, s[12:15], s58 offen offset:2048 lds
    buffer_load_dwordx4 v31, s[12:15], s58 offen offset:3072 lds
    s_waitcnt vmcnt(12) lgkmcnt(0)
    s_barrier
    s_add_u32 m0, s27, 32768
    s_mul_i32 s58, s43, s98
    s_add_u32 s58, s58, s42
    buffer_load_dwordx4 v28, s[12:15], s58 offen offset:0 lds
    buffer_load_dwordx4 v29, s[12:15], s58 offen offset:1024 lds
    buffer_load_dwordx4 v30, s[12:15], s58 offen offset:2048 lds
    buffer_load_dwordx4 v31, s[12:15], s58 offen offset:3072 lds
    s_waitcnt vmcnt(12)
    s_lshl_b32 s62, s7, 4
    s_add_u32 s62, s62, s6
    s_lshl_b32 s62, s62, 5
    s_add_u32 s62, s62, s4
    s_lshl_b32 s62, s62, 2
    s_add_u32 s62, s62, 0x01cc0000
    v_lshlrev_b32 v48, 21, v13
    v_mov_b32 v49, s5
    buffer_store_dword v49, v48, s[16:19], s62 offen sc1
    s_add_u32 m0, s27, 49152
    s_mul_i32 s58, s43, s99
    s_add_u32 s58, s58, s42
    buffer_load_dwordx4 v28, s[12:15], s58 offen offset:0 lds
    buffer_load_dwordx4 v29, s[12:15], s58 offen offset:1024 lds
    buffer_load_dwordx4 v30, s[12:15], s58 offen offset:2048 lds
    buffer_load_dwordx4 v31, s[12:15], s58 offen offset:3072 lds
    s_mov_b32 s64, s38
    s_mov_b32 s65, s39
    s_mov_b32 s66, 2211840
    s_mov_b32 s67, 0x00020000
    s_lshl4_add_u32 s58, s7, s6
    s_lshl2_add_u32 s58, s58, s4
    s_mul_i32 s58, s58, 3840
    v_min_u32 v12, 464, v13
    v_lshl_add_u32 v12, v12, 3, s58
    buffer_load_dword v22, v12, s[64:67], 0 offen
    s_mov_b32 s64, s40
    s_mov_b32 s65, s41
    s_mov_b32 s66, 819200
    s_mov_b32 s67, 0x00020000
    s_lshl4_add_u32 s58, s7, s6
    s_lshl2_add_u32 s58, s58, s4
    s_mul_i32 s58, s58, 1536
    v_min_u32 v12, 176, v13
    v_lshl_add_u32 v12, v12, 3, s58
    buffer_load_dword v22, v12, s[64:67], 0 offen
    v_lshlrev_b32 v12, 1, v15
    v_xor_b32 v0, 1, v14
    v_add_u32 v0, s4, v0
    v_lshl_add_u32 v12, v0, 20, v12
    s_movk_i32 s22, 3456
    s_lshl_b32 s58, s47, 7
    s_add_u32 s58, s58, 128
    buffer_load_short_d16_hi v0, v12, s[20:23], s58 offen offset:0
    buffer_load_short_d16_hi v1, v12, s[20:23], s58 offen offset:64
    s_waitcnt vmcnt(9) lgkmcnt(0)
    s_cmp_eq_u32 s45, 4
    s_cbranch_scc1 LH2wV
    s_waitcnt vmcnt(4)
LH2wV:
    s_barrier
    s_branch LB_3
LH2h:
    v_add_u32 v12, 147456, v13
    ds_read_b128 v[32:35], v12 offset:0
    ds_read_b128 v[36:39], v12 offset:1024
    s_setprio 0
    s_lshl_b32 s62, s4, 10
    s_add_u32 s62, s62, 151552
    v_add_u32 v40, s62, v13
    ds_read_b128 v[6:9], v40
    s_mov_b32 m0, s52
    s_mul_i32 s58, s43, s100
    s_add_u32 s58, s58, s42
    buffer_load_dwordx4 v28, s[12:15], s58 offen offset:0 lds
    buffer_load_dwordx4 v29, s[12:15], s58 offen offset:1024 lds
    buffer_load_dwordx4 v30, s[12:15], s58 offen offset:2048 lds
    buffer_load_dwordx4 v31, s[12:15], s58 offen offset:3072 lds
    s_waitcnt lgkmcnt(2)
    v_add_f32 v32, v32, v33
    v_add_f32 v34, v34, v35
    v_add_f32 v32, v32, v34
    v_cvt_pk_bf16_f32 v35, v32, 0
    v_lshlrev_b32 v33, 16, v35
    v_sub_f32 v33, v32, v33
    v_cvt_pk_bf16_f32 v34, v32, v33
    s_waitcnt lgkmcnt(1)
    v_add_f32 v36, v36, v37
    v_add_f32 v38, v38, v39
    v_add_f32 v36, v36, v38
    v_cvt_pk_bf16_f32 v39, v36, 0
    v_lshlrev_b32 v37, 16, v39
    v_sub_f32 v37, v36, v37
    v_cvt_pk_bf16_f32 v38, v36, v37
    s_setprio 3
    s_waitcnt lgkmcnt(0)
    v_mfma_f32_32x32x8_bf16 v[64:79], v[34:35], v[6:7], v[64:79]
    v_mfma_f32_32x32x8_bf16 v[80:95], v[38:39], v[6:7], v[80:95]
    s_setprio 0
    s_nop 9
    v_mul_f32 v64, v9, v64
    v_mul_f32 v65, v9, v65
    v_mul_f32 v66, v9, v66
    v_mul_f32 v67, v9, v67
    v_mul_f32 v68, v9, v68
    v_mul_f32 v69, v9, v69
    v_mul_f32 v70, v9, v70
    v_mul_f32 v71, v9, v71
    v_fmaak_f32 v32, v64, v64, 0x409d30fc
    v_fmaak_f32 v33, v65, v65, 0x409d30fc
    v_fmaak_f32 v34, v66, v66, 0x409d30fc
    v_fmaak_f32 v35, v67, v67, 0x409d30fc
    v_fmaak_f32 v36, v68, v68, 0x409d30fc
    v_fmaak_f32 v37, v69, v69, 0x409d30fc
    v_fmaak_f32 v38, v70, v70, 0x409d30fc
    v_fmaak_f32 v39, v71, v71, 0x409d30fc
    v_mul_f32 v32, v32, v64
    v_mul_f32 v33, v33, v65
    v_mul_f32 v34, v34, v66
    v_mul_f32 v35, v35, v67
    v_mul_f32 v36, v36, v68
    v_mul_f32 v37, v37, v69
    v_mul_f32 v38, v38, v70
    v_mul_f32 v39, v39, v71
    v_exp_f32 v32, v32
    v_exp_f32 v33, v33
    v_exp_f32 v34, v34
    v_exp_f32 v35, v35
    v_exp_f32 v36, v36
    v_exp_f32 v37, v37
    v_exp_f32 v38, v38
    v_exp_f32 v39, v39
    v_fma_f32 v32, v32, v10, v10
    v_fma_f32 v33, v33, v10, v10
    v_fma_f32 v34, v34, v10, v10
    v_fma_f32 v35, v35, v10, v10
    v_fma_f32 v36, v36, v10, v10
    v_fma_f32 v37, v37, v10, v10
    v_fma_f32 v38, v38, v10, v10
    v_fma_f32 v39, v39, v10, v10
    v_rcp_f32 v32, v32
    v_rcp_f32 v33, v33
    v_rcp_f32 v34, v34
    v_rcp_f32 v35, v35
    v_rcp_f32 v36, v36
    v_rcp_f32 v37, v37
    v_rcp_f32 v38, v38
    v_rcp_f32 v39, v39
    v_mul_f32 v64, v64, v32
    v_mul_f32 v65, v65, v33
    v_mul_f32 v66, v66, v34
    v_mul_f32 v67, v67, v35
    v_mul_f32 v68, v68, v36
    v_mul_f32 v69, v69, v37
    v_mul_f32 v70, v70, v38
    v_mul_f32 v71, v71, v39
    v_cvt_pk_bf16_f32 v40, v64, v65
    v_cvt_pk_bf16_f32 v41, v66, v67
    v_cvt_pk_bf16_f32 v42, v68, v69
    v_cvt_pk_bf16_f32 v43, v70, v71
    s_lshl_b32 s62, s46, 11
    s_add_u32 s62, s62, s50
    buffer_store_dwordx4 v[40:43], v13, s[16:19], s62 offen offset:0 sc1
    v_mul_f32 v72, v9, v72
    v_mul_f32 v73, v9, v73
    v_mul_f32 v74, v9, v74
    v_mul_f32 v75, v9, v75
    v_mul_f32 v76, v9, v76
    v_mul_f32 v77, v9, v77
    v_mul_f32 v78, v9, v78
    s_add_u32 s42, s42, 128
    s_cmp_eq_u32 s45, 3
    s_cselect_b32 s14, 0, s14
    s_add_u32 m0, s27, 0
    s_mul_i32 s58, s43, s96
    s_add_u32 s58, s58, s42
    buffer_load_dwordx4 v28, s[12:15], s58 offen offset:0 lds
    buffer_load_dwordx4 v29, s[12:15], s58 offen offset:1024 lds
    buffer_load_dwordx4 v30, s[12:15], s58 offen offset:2048 lds
    buffer_load_dwordx4 v31, s[12:15], s58 offen offset:3072 lds
    s_add_u32 m0, s27, 16384
    s_mul_i32 s58, s43, s97
    s_add_u32 s58, s58, s42
    buffer_load_dwordx4 v28, s[12:15], s58 offen offset:0 lds
    buffer_load_dwordx4 v29, s[12:15], s58 offen offset:1024 lds
    buffer_load_dwordx4 v30, s[12:15], s58 offen offset:2048 lds
    buffer_load_dwordx4 v31, s[12:15], s58 offen offset:3072 lds
    s_waitcnt vmcnt(9) lgkmcnt(0)
    s_barrier
    s_add_u32 m0, s27, 32768
    s_mul_i32 s58, s43, s98
    s_add_u32 s58, s58, s42
    buffer_load_dwordx4 v28, s[12:15], s58 offen offset:0 lds
    buffer_load_dwordx4 v29, s[12:15], s58 offen offset:1024 lds
    buffer_load_dwordx4 v30, s[12:15], s58 offen offset:2048 lds
    buffer_load_dwordx4 v31, s[12:15], s58 offen offset:3072 lds
    s_waitcnt vmcnt(12)
    s_lshl_b32 s62, s7, 4
    s_add_u32 s62, s62, s6
    s_lshl_b32 s62, s62, 5
    s_add_u32 s62, s62, s4
    s_lshl_b32 s62, s62, 2
    s_add_u32 s62, s62, 0x01cc0000
    v_lshlrev_b32 v48, 21, v13
    v_mov_b32 v49, s5
    buffer_store_dword v49, v48, s[16:19], s62 offen sc1
    s_add_u32 m0, s27, 49152
    s_mul_i32 s58, s43, s99
    s_add_u32 s58, s58, s42
    buffer_load_dwordx4 v28, s[12:15], s58 offen offset:0 lds
    v_mul_f32 v79, v9, v79
    v_fmaak_f32 v32, v72, v72, 0x409d30fc
    v_fmaak_f32 v33, v73, v73, 0x409d30fc
    buffer_load_dwordx4 v29, s[12:15], s58 offen offset:1024 lds
    v_fmaak_f32 v34, v74, v74, 0x409d30fc
    v_fmaak_f32 v35, v75, v75, 0x409d30fc
    v_fmaak_f32 v36, v76, v76, 0x409d30fc
    v_fmaak_f32 v37, v77, v77, 0x409d30fc
    v_fmaak_f32 v38, v78, v78, 0x409d30fc
    v_fmaak_f32 v39, v79, v79, 0x409d30fc
    buffer_load_dwordx4 v30, s[12:15], s58 offen offset:2048 lds
    v_mul_f32 v32, v32, v72
    v_mul_f32 v33, v33, v73
    v_mul_f32 v34, v34, v74
    v_mul_f32 v35, v35, v75
    v_mul_f32 v36, v36, v76
    v_mul_f32 v37, v37, v77
    buffer_load_dwordx4 v31, s[12:15], s58 offen offset:3072 lds
    v_mul_f32 v38, v38, v78
    v_mul_f32 v39, v39, v79
    v_exp_f32 v32, v32
    v_exp_f32 v33, v33
    v_exp_f32 v34, v34
    v_exp_f32 v35, v35
    v_exp_f32 v36, v36
    v_exp_f32 v37, v37
    v_exp_f32 v38, v38
    v_exp_f32 v39, v39
    v_fma_f32 v32, v32, v10, v10
    v_fma_f32 v33, v33, v10, v10
    v_fma_f32 v34, v34, v10, v10
    v_fma_f32 v35, v35, v10, v10
    v_fma_f32 v36, v36, v10, v10
    v_fma_f32 v37, v37, v10, v10
    v_fma_f32 v38, v38, v10, v10
    v_fma_f32 v39, v39, v10, v10
    v_rcp_f32 v32, v32
    v_rcp_f32 v33, v33
    v_rcp_f32 v34, v34
    v_rcp_f32 v35, v35
    v_rcp_f32 v36, v36
    v_rcp_f32 v37, v37
    v_rcp_f32 v38, v38
    v_rcp_f32 v39, v39
    v_mul_f32 v72, v72, v32
    v_mul_f32 v73, v73, v33
    v_mul_f32 v74, v74, v34
    v_mul_f32 v75, v75, v35
    v_mul_f32 v76, v76, v36
    v_mul_f32 v77, v77, v37
    v_mul_f32 v78, v78, v38
    v_mul_f32 v79, v79, v39
    v_cvt_pk_bf16_f32 v44, v72, v73
    v_cvt_pk_bf16_f32 v45, v74, v75
    v_cvt_pk_bf16_f32 v46, v76, v77
    v_cvt_pk_bf16_f32 v47, v78, v79
    s_lshl_b32 s62, s46, 11
    s_add_u32 s62, s62, s50
    buffer_store_dwordx4 v[44:47], v13, s[16:19], s62 offen offset:1024 sc1
    v_mul_f32 v80, v9, v80
    v_mul_f32 v81, v9, v81
    v_mul_f32 v82, v9, v82
    v_mul_f32 v83, v9, v83
    v_mul_f32 v84, v9, v84
    v_mul_f32 v85, v9, v85
    v_mul_f32 v86, v9, v86
    v_mul_f32 v87, v9, v87
    v_fmaak_f32 v32, v80, v80, 0x409d30fc
    v_fmaak_f32 v33, v81, v81, 0x409d30fc
    v_fmaak_f32 v34, v82, v82, 0x409d30fc
    v_fmaak_f32 v35, v83, v83, 0x409d30fc
    v_fmaak_f32 v36, v84, v84, 0x409d30fc
    v_fmaak_f32 v37, v85, v85, 0x409d30fc
    v_fmaak_f32 v38, v86, v86, 0x409d30fc
    v_fmaak_f32 v39, v87, v87, 0x409d30fc
    v_mul_f32 v32, v32, v80
    v_mul_f32 v33, v33, v81
    v_mul_f32 v34, v34, v82
    v_mul_f32 v35, v35, v83
    v_mul_f32 v36, v36, v84
    v_mul_f32 v37, v37, v85
    v_mul_f32 v38, v38, v86
    v_mul_f32 v39, v39, v87
    v_exp_f32 v32, v32
    v_exp_f32 v33, v33
    v_exp_f32 v34, v34
    v_exp_f32 v35, v35
    v_exp_f32 v36, v36
    v_exp_f32 v37, v37
    v_exp_f32 v38, v38
    v_exp_f32 v39, v39
    v_fma_f32 v32, v32, v10, v10
    v_fma_f32 v33, v33, v10, v10
    v_fma_f32 v34, v34, v10, v10
    v_fma_f32 v35, v35, v10, v10
    v_fma_f32 v36, v36, v10, v10
    v_fma_f32 v37, v37, v10, v10
    v_fma_f32 v38, v38, v10, v10
    v_fma_f32 v39, v39, v10, v10
    v_rcp_f32 v32, v32
    v_rcp_f32 v33, v33
    v_rcp_f32 v34, v34
    v_rcp_f32 v35, v35
    v_rcp_f32 v36, v36
    v_rcp_f32 v37, v37
    v_rcp_f32 v38, v38
    v_rcp_f32 v39, v39
    v_mul_f32 v80, v80, v32
    v_mul_f32 v81, v81, v33
    v_mul_f32 v82, v82, v34
    v_mul_f32 v83, v83, v35
    v_mul_f32 v84, v84, v36
    v_mul_f32 v85, v85, v37
    v_mul_f32 v86, v86, v38
    v_mul_f32 v87, v87, v39
    v_cvt_pk_bf16_f32 v40, v80, v81
    v_cvt_pk_bf16_f32 v41, v82, v83
    v_cvt_pk_bf16_f32 v42, v84, v85
    v_cvt_pk_bf16_f32 v43, v86, v87
    s_lshl_b32 s62, s46, 11
    s_add_u32 s62, s62, s50
    buffer_store_dwordx4 v[40:43], v13, s[16:19], s62 offen offset:2048 sc1
    v_mul_f32 v88, v9, v88
    v_mul_f32 v89, v9, v89
    v_mul_f32 v90, v9, v90
    v_mul_f32 v91, v9, v91
    v_mul_f32 v92, v9, v92
    v_mul_f32 v93, v9, v93
    v_mul_f32 v94, v9, v94
    v_mul_f32 v95, v9, v95
    v_fmaak_f32 v32, v88, v88, 0x409d30fc
    v_fmaak_f32 v33, v89, v89, 0x409d30fc
    v_fmaak_f32 v34, v90, v90, 0x409d30fc
    v_fmaak_f32 v35, v91, v91, 0x409d30fc
    v_fmaak_f32 v36, v92, v92, 0x409d30fc
    v_fmaak_f32 v37, v93, v93, 0x409d30fc
    v_fmaak_f32 v38, v94, v94, 0x409d30fc
    v_fmaak_f32 v39, v95, v95, 0x409d30fc
    v_mul_f32 v32, v32, v88
    v_mul_f32 v33, v33, v89
    v_mul_f32 v34, v34, v90
    v_mul_f32 v35, v35, v91
    v_mul_f32 v36, v36, v92
    v_mul_f32 v37, v37, v93
    v_mul_f32 v38, v38, v94
    v_mul_f32 v39, v39, v95
    v_exp_f32 v32, v32
    v_exp_f32 v33, v33
    v_exp_f32 v34, v34
    v_exp_f32 v35, v35
    v_exp_f32 v36, v36
    v_exp_f32 v37, v37
    v_exp_f32 v38, v38
    v_exp_f32 v39, v39
    v_fma_f32 v32, v32, v10, v10
    v_fma_f32 v33, v33, v10, v10
    v_fma_f32 v34, v34, v10, v10
    v_fma_f32 v35, v35, v10, v10
    v_fma_f32 v36, v36, v10, v10
    v_fma_f32 v37, v37, v10, v10
    v_fma_f32 v38, v38, v10, v10
    v_fma_f32 v39, v39, v10, v10
    v_rcp_f32 v32, v32
    v_rcp_f32 v33, v33
    v_rcp_f32 v34, v34
    v_rcp_f32 v35, v35
    v_rcp_f32 v36, v36
    v_rcp_f32 v37, v37
    v_rcp_f32 v38, v38
    v_rcp_f32 v39, v39
    v_mul_f32 v88, v88, v32
    v_mul_f32 v89, v89, v33
    v_mul_f32 v90, v90, v34
    v_mul_f32 v91, v91, v35
    v_mul_f32 v92, v92, v36
    v_mul_f32 v93, v93, v37
    v_mul_f32 v94, v94, v38
    v_mul_f32 v95, v95, v39
    v_cvt_pk_bf16_f32 v44, v88, v89
    v_cvt_pk_bf16_f32 v45, v90, v91
    v_cvt_pk_bf16_f32 v46, v92, v93
    v_cvt_pk_bf16_f32 v47, v94, v95
    s_lshl_b32 s62, s46, 11
    s_add_u32 s62, s62, s50
    buffer_store_dwordx4 v[44:47], v13, s[16:19], s62 offen offset:3072 sc1
    s_mov_b32 s64, s38
    s_mov_b32 s65, s39
    s_mov_b32 s66, 2211840
    s_mov_b32 s67, 0x00020000
    s_lshl4_add_u32 s58, s7, s6
    s_lshl2_add_u32 s58, s58, s4
    s_mul_i32 s58, s58, 3840
    v_min_u32 v12, 464, v13
    v_lshl_add_u32 v12, v12, 3, s58
    buffer_load_dword v22, v12, s[64:67], 0 offen
    s_mov_b32 s64, s40
    s_mov_b32 s65, s41
    s_mov_b32 s66, 819200
    s_mov_b32 s67, 0x00020000
    s_lshl4_add_u32 s58, s7, s6
    s_lshl2_add_u32 s58, s58, s4
    s_mul_i32 s58, s58, 1536
    v_min_u32 v12, 176, v13
    v_lshl_add_u32 v12, v12, 3, s58
    buffer_load_dword v22, v12, s[64:67], 0 offen
    v_lshlrev_b32 v12, 1, v15
    v_xor_b32 v0, 1, v14
    v_add_u32 v0, s4, v0
    v_lshl_add_u32 v12, v0, 20, v12
    s_movk_i32 s22, 3456
    s_lshl_b32 s58, s47, 7
    s_add_u32 s58, s58, 128
    buffer_load_short_d16_hi v0, v12, s[20:23], s58 offen offset:0
    buffer_load_short_d16_hi v1, v12, s[20:23], s58 offen offset:64
    s_waitcnt vmcnt(12) lgkmcnt(0)
    s_cmp_eq_u32 s45, 4
    s_cbranch_scc1 LH2wH
    s_waitcnt vmcnt(4)
LH2wH:
    s_barrier
    s_branch LB_3
LH2q:
    v_add_u32 v12, 147456, v13
    ds_read_b128 v[32:35], v12 offset:0
    ds_read_b128 v[36:39], v12 offset:1024
    s_setprio 0
    s_lshl_b32 s62, s4, 10
    s_add_u32 s62, s62, 151552
    v_add_u32 v40, s62, v13
    ds_read_b128 v[6:9], v40
    s_mov_b32 m0, s52
    s_mul_i32 s58, s43, s100
    s_add_u32 s58, s58, s42
    buffer_load_dwordx4 v28, s[12:15], s58 offen offset:0 lds
    buffer_load_dwordx4 v29, s[12:15], s58 offen offset:1024 lds
    buffer_load_dwordx4 v30, s[12:15], s58 offen offset:2048 lds
    buffer_load_dwordx4 v31, s[12:15], s58 offen offset:3072 lds
    s_waitcnt lgkmcnt(2)
    v_add_f32 v32, v32, v33
    v_add_f32 v34, v34, v35
    v_add_f32 v32, v32, v34
    v_cvt_pk_bf16_f32 v35, v32, 0
    v_lshlrev_b32 v33, 16, v35
    v_sub_f32 v33, v32, v33
    v_cvt_pk_bf16_f32 v34, v32, v33
    s_waitcnt lgkmcnt(1)
    v_add_f32 v36, v36, v37
    v_add_f32 v38, v38, v39
    v_add_f32 v36, v36, v38
    v_cvt_pk_bf16_f32 v39, v36, 0
    v_lshlrev_b32 v37, 16, v39
    v_sub_f32 v37, v36, v37
    v_cvt_pk_bf16_f32 v38, v36, v37
    s_setprio 3
    s_waitcnt lgkmcnt(0)
    v_mfma_f32_32x32x8_bf16 v[64:79], v[34:35], v[6:7], v[64:79]
    v_mfma_f32_32x32x8_bf16 v[80:95], v[38:39], v[6:7], v[80:95]
    s_setprio 0
    v_bfe_u32 v32, v13, 8, 1
    v_lshl_add_u32 v32, v32, 1, v14
    v_lshl_add_u32 v32, s46, 3, v32
    v_and_b32 v33, 0xf0, v13
    v_lshl_add_u32 v33, v32, 9, v33
    v_mul_u32_u24 v32, 13108, v32
    v_lshrrev_b32 v34, 16, v32
    v_mul_u32_u24 v34, 79360, v34
    v_add_u32 v34, v34, v33
    v_add_u32 v32, 52432, v32
    v_mul_f32 v64, v8, v64
    v_mul_f32 v65, v8, v65
    v_mul_f32 v66, v8, v66
    v_mul_f32 v67, v8, v67
    v_mul_f32 v68, v8, v68
    v_mul_f32 v69, v8, v69
    v_mul_f32 v70, v8, v70
    v_mul_f32 v71, v8, v71
    v_cvt_pk_bf16_f32 v40, v64, v65
    v_cvt_pk_bf16_f32 v42, v68, v69
    v_cvt_pk_bf16_f32 v41, v66, v67
    v_cvt_pk_bf16_f32 v43, v70, v71
    v_permlane16_swap_b32 v40, v42
    s_nop 0
    v_permlane16_swap_b32 v41, v43
    buffer_store_dwordx4 v[40:43], v34, s[16:19], s48 offen offset:0 sc1
    v_lshrrev_b32 v35, 16, v32
    v_mul_u32_u24 v35, 79360, v35
    v_add_u32 v35, v35, v33
    v_add_u32 v32, 52432, v32
    v_add_u32 v33, 4096, v33
    v_mul_f32 v72, v8, v72
    v_mul_f32 v73, v8, v73
    v_mul_f32 v74, v8, v74
    v_mul_f32 v75, v8, v75
    v_mul_f32 v76, v8, v76
    v_mul_f32 v77, v8, v77
    v_mul_f32 v78, v8, v78
    v_mul_f32 v79, v8, v79
    v_cvt_pk_bf16_f32 v44, v72, v73
    v_cvt_pk_bf16_f32 v46, v76, v77
    v_cvt_pk_bf16_f32 v45, v74, v75
    v_cvt_pk_bf16_f32 v47, v78, v79
    v_permlane16_swap_b32 v44, v46
    s_nop 0
    v_permlane16_swap_b32 v45, v47
    buffer_store_dwordx4 v[44:47], v35, s[16:19], s48 offen offset:2048 sc1
    v_lshrrev_b32 v34, 16, v32
    v_mul_u32_u24 v34, 79360, v34
    v_add_u32 v34, v34, v33
    v_add_u32 v32, 52432, v32
    v_mul_f32 v80, v8, v80
    v_mul_f32 v81, v8, v81
    v_mul_f32 v82, v8, v82
    v_mul_f32 v83, v8, v83
    v_mul_f32 v84, v8, v84
    v_mul_f32 v85, v8, v85
    v_mul_f32 v86, v8, v86
    v_mul_f32 v87, v8, v87
    v_cvt_pk_bf16_f32 v40, v80, v81
    v_cvt_pk_bf16_f32 v42, v84, v85
    v_cvt_pk_bf16_f32 v41, v82, v83
    v_cvt_pk_bf16_f32 v43, v86, v87
    v_permlane16_swap_b32 v40, v42
    s_nop 0
    v_permlane16_swap_b32 v41, v43
    buffer_store_dwordx4 v[40:43], v34, s[16:19], s48 offen offset:0 sc1
    v_lshrrev_b32 v35, 16, v32
    v_mul_u32_u24 v35, 79360, v35
    v_add_u32 v35, v35, v33
    v_mul_f32 v88, v8, v88
    v_mul_f32 v89, v8, v89
    v_mul_f32 v90, v8, v90
    v_mul_f32 v91, v8, v91
    v_mul_f32 v92, v8, v92
    v_mul_f32 v93, v8, v93
    v_mul_f32 v94, v8, v94
    v_mul_f32 v95, v8, v95
    v_cvt_pk_bf16_f32 v44, v88, v89
    v_cvt_pk_bf16_f32 v46, v92, v93
    v_cvt_pk_bf16_f32 v45, v90, v91
    v_cvt_pk_bf16_f32 v47, v94, v95
    v_permlane16_swap_b32 v44, v46
    s_nop 0
    v_permlane16_swap_b32 v45, v47
    buffer_store_dwordx4 v[44:47], v35, s[16:19], s48 offen offset:2048 sc1
    s_add_u32 s42, s42, 128
    s_cmp_eq_u32 s45, 3
    s_cselect_b32 s14, 0, s14
    s_add_u32 m0, s27, 0
    s_mul_i32 s58, s43, s96
    s_add_u32 s58, s58, s42
    buffer_load_dwordx4 v28, s[12:15], s58 offen offset:0 lds
    buffer_load_dwordx4 v29, s[12:15], s58 offen offset:1024 lds
    buffer_load_dwordx4 v30, s[12:15], s58 offen offset:2048 lds
    buffer_load_dwordx4 v31, s[12:15], s58 offen offset:3072 lds
    s_add_u32 m0, s27, 16384
    s_mul_i32 s58, s43, s97
    s_add_u32 s58, s58, s42
    buffer_load_dwordx4 v28, s[12:15], s58 offen offset:0 lds
    buffer_load_dwordx4 v29, s[12:15], s58 offen offset:1024 lds
    buffer_load_dwordx4 v30, s[12:15], s58 offen offset:2048 lds
    buffer_load_dwordx4 v31, s[12:15], s58 offen offset:3072 lds
    s_waitcnt vmcnt(12) lgkmcnt(0)
    s_barrier
    s_add_u32 m0, s27, 32768
    s_mul_i32 s58, s43, s98
    s_add_u32 s58, s58, s42
    buffer_load_dwordx4 v28, s[12:15], s58 offen offset:0 lds
    buffer_load_dwordx4 v29, s[12:15], s58 offen offset:1024 lds
    buffer_load_dwordx4 v30, s[12:15], s58 offen offset:2048 lds
    buffer_load_dwordx4 v31, s[12:15], s58 offen offset:3072 lds
    s_waitcnt vmcnt(12)
    s_lshl_b32 s62, s7, 4
    s_add_u32 s62, s62, s6
    s_lshl_b32 s62, s62, 5
    s_add_u32 s62, s62, s4
    s_lshl_b32 s62, s62, 2
    s_add_u32 s62, s62, 0x01cc0000
    v_lshlrev_b32 v48, 21, v13
    v_mov_b32 v49, s5
    buffer_store_dword v49, v48, s[16:19], s62 offen sc1
    s_add_u32 m0, s27, 49152
    s_mul_i32 s58, s43, s99
    s_add_u32 s58, s58, s42
    buffer_load_dwordx4 v28, s[12:15], s58 offen offset:0 lds
    buffer_load_dwordx4 v29, s[12:15], s58 offen offset:1024 lds
    buffer_load_dwordx4 v30, s[12:15], s58 offen offset:2048 lds
    buffer_load_dwordx4 v31, s[12:15], s58 offen offset:3072 lds
    s_mov_b32 s64, s38
    s_mov_b32 s65, s39
    s_mov_b32 s66, 2211840
    s_mov_b32 s67, 0x00020000
    s_lshl4_add_u32 s58, s7, s6
    s_lshl2_add_u32 s58, s58, s4
    s_mul_i32 s58, s58, 3840
    v_min_u32 v12, 464, v13
    v_lshl_add_u32 v12, v12, 3, s58
    buffer_load_dword v22, v12, s[64:67], 0 offen
    s_mov_b32 s64, s40
    s_mov_b32 s65, s41
    s_mov_b32 s66, 819200
    s_mov_b32 s67, 0x00020000
    s_lshl4_add_u32 s58, s7, s6
    s_lshl2_add_u32 s58, s58, s4
    s_mul_i32 s58, s58, 1536
    v_min_u32 v12, 176, v13
    v_lshl_add_u32 v12, v12, 3, s58
    buffer_load_dword v22, v12, s[64:67], 0 offen
    v_lshlrev_b32 v12, 1, v15
    v_xor_b32 v0, 1, v14
    v_add_u32 v0, s4, v0
    v_lshl_add_u32 v12, v0, 20, v12
    s_movk_i32 s22, 3456
    s_lshl_b32 s58, s47, 7
    s_add_u32 s58, s58, 128
    buffer_load_short_d16_hi v0, v12, s[20:23], s58 offen offset:0
    buffer_load_short_d16_hi v1, v12, s[20:23], s58 offen offset:64
    s_waitcnt vmcnt(9) lgkmcnt(0)
    s_cmp_eq_u32 s45, 4
    s_cbranch_scc1 LH2wQK
    s_waitcnt vmcnt(4)
LH2wQK:
    s_barrier
LB_3:
    s_mov_b32 s44, 3
    s_cmp_eq_u32 s45, 4
    s_cbranch_scc1 LC
    s_setprio 3
    s_mul_i32 s66, s4, 5120
    s_mul_i32 s67, s54, 81920
    s_mul_i32 s64, s4, 3072
    s_mul_i32 s65, s55, 10240
    s_add_u32 s65, s65, s67
    s_add_u32 s65, s65, s64
    s_add_u32 s67, s67, s66
    s_add_u32 s67, s67, 0x00280000
    s_mul_i32 s68, s54, 320
    s_add_u32 s68, s68, 0x00500000
    s_lshl_b32 s58, s66, 5
    s_add_u32 s68, s68, s58
    s_mul_i32 s26, s4, 5376
    v_cmp_le_u32 vcc, 320, v13
    v_mov_b32 v221, 9920
    s_nop 0
    v_cndmask_b32 v220, 0, v221, vcc
    v_add_u32 v220, v220, v13
    v_add_u32 v221, 19808, v220
    v_add_u32 v222, 39616, v220
    v_add_u32 v223, 59424, v220
    v_and_b32 v104, 7, v15
    v_mul_u32_u24 v104, 672, v104
    s_add_u32 s58, s26, 126080
    v_add_u32 v104, s58, v104
    v_mov_b32 v108, 0x3f803f80
    v_mov_b32 v109, 0x3f803f80
    v_mov_b32 v110, 0x3f803f80
    v_mov_b32 v111, 0x3f803f80
    ds_write_b128 v104, v[108:111] offset:0
    v_lshrrev_b32 v101, 6, v13
    v_min_u32 v101, 5, v101
    v_and_b32 v102, 1, v101
    v_mul_u32_u24 v102, 19, v102
    v_lshrrev_b32 v101, 1, v101
    v_mul_u32_u24 v100, 640, v101
    s_mul_i32 s61, s54, 20
    s_add_u32 s61, s61, 640
    v_add3_u32 v100, v100, v102, s61
    v_lshrrev_b32 v100, 7, v100
    v_bfe_u32 v102, v13, 4, 2
    v_lshl_add_u32 v100, v100, 4, v102
    v_and_b32 v103, 0xfffffffd, v100
    s_lshl_b32 s61, s55, 1
    s_sub_u32 s61, s61, 240
    v_add_u32 v103, s61, v103
    v_cmp_eq_u32 vcc, 2, v101
    s_nop 1
    v_cndmask_b32 v100, v100, v103, vcc
    v_lshlrev_b32 v100, 7, v100
    s_mov_b32 s61, 0x01cc0000
    buffer_load_dwordx4 v[96:99], v100, s[16:19], s61 offen sc1
    s_mov_b32 s60, 100000
LB_p1:
    s_waitcnt vmcnt(0)
    v_xor_b32 v96, s5, v96
    v_xor_b32 v97, s5, v97
    v_xor_b32 v98, s5, v98
    v_xor_b32 v99, s5, v99
    v_or3_b32 v96, v96, v97, v98
    v_or_b32 v96, v96, v99
    v_cmp_ne_u32 vcc, 0, v96
    s_nop 0
    s_cmp_eq_u64 vcc, 0
    s_cbranch_scc1 LB_p1_x
    s_sleep 4
    buffer_load_dwordx4 v[96:99], v100, s[16:19], s61 offen sc1
    s_sub_u32 s60, s60, 1
    s_waitcnt vmcnt(0)
    s_cbranch_scc0 LB_p1
LB_p1_x:
    s_add_u32 m0, s64, 151552
    s_nop 0
    buffer_load_dwordx4 v13, s[16:19], s65 offen offset:0 sc1 lds
    buffer_load_dwordx4 v13, s[16:19], s65 offen offset:1024 sc1 lds
    buffer_load_dwordx4 v13, s[16:19], s65 offen offset:2048 sc1 lds
    s_add_u32 m0, s66, 84480
    s_nop 0
    buffer_load_dwordx4 v13, s[16:19], s67 offen offset:0 sc1 lds
    buffer_load_dwordx4 v13, s[16:19], s67 offen offset:1024 sc1 lds
    buffer_load_dwordx4 v13, s[16:19], s67 offen offset:2048 sc1 lds
    buffer_load_dwordx4 v13, s[16:19], s67 offen offset:3072 sc1 lds
    s_add_u32 m0, s66, 88576
    s_add_u32 s67, s67, 4096
    buffer_load_dwordx4 v13, s[16:19], s67 offen offset:0 sc1 lds
    s_add_u32 s67, s67, 16384
    s_add_u32 m0, s26, 125440
    s_mov_b32 exec_hi, 0xff
    buffer_load_dwordx4 v220, s[16:19], s68 offen offset:0 sc1 lds
    buffer_load_dwordx4 v221, s[16:19], s68 offen offset:672 sc1 lds
    buffer_load_dwordx4 v222, s[16:19], s68 offen offset:1344 sc1 lds
    buffer_load_dwordx4 v223, s[16:19], s68 offen offset:2016 sc1 lds
    s_mov_b32 exec_hi, -1
    s_add_u32 s68, s68, 81920
    s_add_u32 m0, s26, 128128
    s_mov_b32 exec_hi, 0xff
    buffer_load_dwordx4 v220, s[16:19], s68 offen offset:0 sc1 lds
    buffer_load_dwordx4 v221, s[16:19], s68 offen offset:672 sc1 lds
    buffer_load_dwordx4 v222, s[16:19], s68 offen offset:1344 sc1 lds
    buffer_load_dwordx4 v223, s[16:19], s68 offen offset:2016 sc1 lds
    s_mov_b32 exec_hi, -1
    s_add_u32 s68, s68, 573440
    s_waitcnt vmcnt(0) lgkmcnt(0)
    s_barrier
    v_and_b32 v104, 7, v15
    v_mul_u32_u24 v104, 672, v104
    s_add_u32 s58, s26, 640
    v_add_u32 v104, s58, v104
    v_mov_b32 v108, 0x3f803f80
    v_mov_b32 v109, 0x3f803f80
    v_mov_b32 v110, 0x3f803f80
    v_mov_b32 v111, 0x3f803f80
    ds_write_b128 v104, v[108:111] offset:0
    ds_write_b128 v104, v[108:111] offset:21504
    s_cmp_ge_u32 s53, 10
    s_cbranch_scc1 LB_r0
    s_and_b32 s63, s2, 7
    s_lshl_b32 s64, s53, 7
    s_cmp_lt_u32 s63, 6
    s_cselect_b32 s12, s38, s40
    s_cselect_b32 s13, s39, s41
    s_cselect_b32 s62, 0, 6
    s_sub_u32 s63, s63, s62
    s_mul_i32 s63, s63, 409600
    s_add_u32 s64, s64, s63
    s_add_u32 s63, s63, 409600
    s_min_u32 s14, s63, 2211840
    s_movk_i32 s63, 1280
    s_mul_i32 s62, s4, 61440
    s_add_u32 s64, s64, s62
    s_lshl_b32 s43, s63, 7
    s_mul_i32 s42, s4, s63
    s_lshl_b32 s42, s42, 5
    s_add_u32 s42, s42, s64
    v_lshrrev_b32 v29, 7, v13
    v_mul_u32_u24 v28, s63, v29
    v_lshrrev_b32 v29, 2, v13
    v_xor_b32 v29, v29, v13
    v_and_b32 v29, 0x40, v29
    v_and_b32 v30, 0x30, v13
    v_add3_u32 v28, v28, v29, v30
    s_lshl_b32 s63, s63, 3
    s_sub_u32 s63, s63, 1024
    v_add_u32 v29, s63, v28
    v_add_u32 v30, s63, v29
    v_add_u32 v31, s63, v30
    s_mul_i32 s62, s4, 10240
    s_add_u32 m0, s62, 43520
    s_add_u32 s58, s42, 0
    buffer_load_dwordx4 v28, s[12:15], s58 offen offset:0 lds
    buffer_load_dwordx4 v29, s[12:15], s58 offen offset:1024 lds
    buffer_load_dwordx4 v30, s[12:15], s58 offen offset:2048 lds
    buffer_load_dwordx4 v31, s[12:15], s58 offen offset:3072 lds
    s_add_u32 m0, s62, 47616
    s_add_u32 s58, s42, 40960
    buffer_load_dwordx4 v28, s[12:15], s58 offen offset:0 lds
    buffer_load_dwordx4 v29, s[12:15], s58 offen offset:1024 lds
    buffer_load_dwordx4 v30, s[12:15], s58 offen offset:2048 lds
    buffer_load_dwordx4 v31, s[12:15], s58 offen offset:3072 lds
    s_add_u32 m0, s62, 51712
    s_add_u32 s58, s42, 81920
    buffer_load_dwordx4 v28, s[12:15], s58 offen offset:0 lds
    buffer_load_dwordx4 v29, s[12:15], s58 offen offset:1024 lds
LB_r0:
    v_lshrrev_b32 v101, 8, v13
    v_and_b32 v102, 1, v101
    v_mul_u32_u24 v102, 19, v102
    v_lshrrev_b32 v101, 1, v101
    v_mul_u32_u24 v100, 640, v101
    s_mul_i32 s61, s54, 20
    s_add_u32 s61, s61, 640
    v_add3_u32 v100, v100, v102, s61
    v_lshrrev_b32 v100, 7, v100
    v_bfe_u32 v102, v13, 4, 4
    v_lshl_add_u32 v100, v100, 4, v102
    v_lshlrev_b32 v100, 7, v100
    s_mov_b32 s61, 0x01cc0000
    buffer_load_dwordx4 v[96:99], v100, s[16:19], s61 offen sc1
    s_lshl_b32 s58, s6, 2
    s_add_u32 s58, s58, s4
    s_lshl_b32 s58, s58, 4
    s_add_u32 s58, s58, s7
    s_lshl_b32 s58, s58, 6
    s_and_b32 s59, s3, 4
    s_add_u32 s58, s58, s59
    s_lshl_b32 s58, s58, 1
    s_add_u32 s58, s58, 0x01c00000
    v_lshlrev_b32 v34, 21, v13
    v_mov_b32 v32, s5
    v_mov_b32 v33, s5
    buffer_store_dwordx2 v[32:33], v34, s[16:19], s58 offen sc1
    s_mov_b32 s60, 100000
LB_p5:
    s_waitcnt vmcnt(1)
    v_xor_b32 v96, s5, v96
    v_xor_b32 v97, s5, v97
    v_xor_b32 v98, s5, v98
    v_xor_b32 v99, s5, v99
    v_or3_b32 v96, v96, v97, v98
    v_or_b32 v96, v96, v99
    v_cmp_ne_u32 vcc, 0, v96
    s_nop 0
    s_cmp_eq_u64 vcc, 0
    s_cbranch_scc1 LB_p5_x
    s_sleep 1
    buffer_load_dwordx4 v[96:99], v100, s[16:19], s61 offen sc1
    s_sub_u32 s60, s60, 1
    s_waitcnt vmcnt(0)
    s_cbranch_scc0 LB_p5
LB_p5_x:
    s_add_u32 m0, s66, 104960
    s_nop 0
    buffer_load_dwordx4 v13, s[16:19], s67 offen offset:0 sc1 lds
    buffer_load_dwordx4 v13, s[16:19], s67 offen offset:1024 sc1 lds
    buffer_load_dwordx4 v13, s[16:19], s67 offen offset:2048 sc1 lds
    buffer_load_dwordx4 v13, s[16:19], s67 offen offset:3072 sc1 lds
    s_add_u32 m0, s66, 109056
    s_add_u32 s67, s67, 4096
    buffer_load_dwordx4 v13, s[16:19], s67 offen offset:0 sc1 lds
    s_add_u32 s67, s67, 16384
    s_add_u32 m0, s26, 0
    s_mov_b32 exec_hi, 0xff
    buffer_load_dwordx4 v220, s[16:19], s68 offen offset:0 sc1 lds
    buffer_load_dwordx4 v221, s[16:19], s68 offen offset:672 sc1 lds
    buffer_load_dwordx4 v222, s[16:19], s68 offen offset:1344 sc1 lds
    buffer_load_dwordx4 v223, s[16:19], s68 offen offset:2016 sc1 lds
    s_mov_b32 exec_hi, -1
    s_add_u32 s68, s68, 81920
    s_add_u32 m0, s26, 2688
    s_mov_b32 exec_hi, 0xff
    buffer_load_dwordx4 v220, s[16:19], s68 offen offset:0 sc1 lds
    buffer_load_dwordx4 v221, s[16:19], s68 offen offset:672 sc1 lds
    buffer_load_dwordx4 v222, s[16:19], s68 offen offset:1344 sc1 lds
    buffer_load_dwordx4 v223, s[16:19], s68 offen offset:2016 sc1 lds
    s_mov_b32 exec_hi, -1
    s_add_u32 s68, s68, 573440
    s_cmp_ge_u32 s53, 10
    s_cbranch_scc1 LB_r1
    v_and_b32 v32, 0x1ff, v2
    s_mul_i32 s58, s4, 10240
    s_add_u32 s58, s58, 43520
    v_add_u32 v32, s58, v32
    s_and_b32 s60, s2, 7
    s_cmp_lt_u32 s60, 6
    s_cselect_b32 s58, 16, 20
    s_cselect_b32 s59, 4, 40
    s_cselect_b32 s62, 8, 20
    s_cselect_b32 s63, 64, 16
    s_lshl_b32 s58, s58, 7
    s_lshl_b32 s59, s59, 7
    s_lshl_b32 s62, s62, 7
    s_lshl_b32 s63, s63, 7
    v_lshl_add_u32 v33, v14, 9, v32
    v_xor_b32 v34, 64, v33
    ds_read_b64_tr_b16 v[112:113], v33
    ds_read_b64_tr_b16 v[114:115], v33 offset:1024
    ds_read_b64_tr_b16 v[116:117], v34
    ds_read_b64_tr_b16 v[118:119], v34 offset:1024
    v_add_u32 v33, s58, v33
    v_xor_b32 v34, 64, v33
    ds_read_b64_tr_b16 v[120:121], v33
    ds_read_b64_tr_b16 v[122:123], v33 offset:1024
    ds_read_b64_tr_b16 v[124:125], v34
    ds_read_b64_tr_b16 v[126:127], v34 offset:1024
    v_add_u32 v33, s58, v33
    v_xor_b32 v34, 64, v33
    ds_read_b64_tr_b16 v[128:129], v33
    ds_read_b64_tr_b16 v[130:131], v33 offset:1024
    ds_read_b64_tr_b16 v[132:133], v34
    ds_read_b64_tr_b16 v[134:135], v34 offset:1024
    v_add_u32 v33, s58, v33
    v_xor_b32 v34, 64, v33
    ds_read_b64_tr_b16 v[136:137], v33
    ds_read_b64_tr_b16 v[138:139], v33 offset:1024
    ds_read_b64_tr_b16 v[140:141], v34
    ds_read_b64_tr_b16 v[142:143], v34 offset:1024
    v_add_u32 v33, s58, v33
    v_mad_u32_u24 v33, v14, s59, v32
    v_add_u32 v33, s63, v33
    v_add_u32 v34, s62, v33
    v_xor_b32 v35, 64, v33
    v_xor_b32 v36, 64, v34
    ds_read_b64_tr_b16 v[144:145], v33
    ds_read_b64_tr_b16 v[146:147], v34
    ds_read_b64_tr_b16 v[148:149], v35
    ds_read_b64_tr_b16 v[150:151], v36
    s_cmp_lt_u32 s60, 6
    s_cselect_b32 s43, 108, 40
    s_cselect_b32 s62, 0, 0x00280000
    s_cselect_b32 s58, 5, 4
    s_cselect_b32 s59, 5, 1
    s_cselect_b32 s63, 4, 32
    s_cselect_b32 s64, 0, 6
    s_sub_u32 s60, s60, s64
    s_lshl2_add_u32 s60, s60, s4
    s_mul_i32 s51, s58, s60
    s_mul_i32 s59, s59, s60
    s_add_u32 s63, s63, s59
    s_mul_i32 s51, s51, 5120
    s_mul_i32 s63, s63, 5120
    s_mul_i32 s43, s43, 5120
    s_add_u32 s62, s62, 0x01000000
    s_lshl1_add_u32 s58, s53, 0
    s_mul_i32 s59, s58, 52
    s_lshr_b32 s59, s59, 8
    s_mul_i32 s60, s59, 5
    s_sub_u32 s58, s58, s60
    s_lshl_b32 s58, s58, 10
    s_mul_i32 s59, s59, s43
    s_add_u32 s44, s58, s59
    s_add_u32 s44, s44, s62
    s_lshl1_add_u32 s58, s53, 1
    s_mul_i32 s59, s58, 52
    s_lshr_b32 s59, s59, 8
    s_mul_i32 s60, s59, 5
    s_sub_u32 s58, s58, s60
    s_lshl_b32 s58, s58, 10
    s_mul_i32 s59, s59, s43
    s_add_u32 s46, s58, s59
    s_add_u32 s46, s46, s62
    s_waitcnt lgkmcnt(0)
    s_cmp_lt_u32 s51, s43
    s_cbranch_scc0 LB_rs0
    s_add_u32 s58, s51, s44
    s_add_u32 s59, s51, s46
    buffer_store_dwordx4 v[112:115], v13, s[16:19], s58 offen sc1
    buffer_store_dwordx4 v[116:119], v13, s[16:19], s59 offen sc1
LB_rs0:
    s_add_u32 s51, s51, 5120
    s_cmp_lt_u32 s51, s43
    s_cbranch_scc0 LB_rs1
    s_add_u32 s58, s51, s44
    s_add_u32 s59, s51, s46
    buffer_store_dwordx4 v[120:123], v13, s[16:19], s58 offen sc1
    buffer_store_dwordx4 v[124:127], v13, s[16:19], s59 offen sc1
LB_rs1:
    s_add_u32 s51, s51, 5120
    s_cmp_lt_u32 s51, s43
    s_cbranch_scc0 LB_rs2
    s_add_u32 s58, s51, s44
    s_add_u32 s59, s51, s46
    buffer_store_dwordx4 v[128:131], v13, s[16:19], s58 offen sc1
    buffer_store_dwordx4 v[132:135], v13, s[16:19], s59 offen sc1
LB_rs2:
    s_add_u32 s51, s51, 5120
    s_cmp_lt_u32 s51, s43
    s_cbranch_scc0 LB_rs3
    s_add_u32 s58, s51, s44
    s_add_u32 s59, s51, s46
    buffer_store_dwordx4 v[136:139], v13, s[16:19], s58 offen sc1
    buffer_store_dwordx4 v[140:143], v13, s[16:19], s59 offen sc1
LB_rs3:
    s_add_u32 s51, s51, 5120
    s_mov_b32 s51, s63
    s_cmp_lt_u32 s51, s43
    s_cbranch_scc0 LB_rs4
    s_add_u32 s58, s51, s44
    s_add_u32 s59, s51, s46
    buffer_store_dwordx4 v[144:147], v13, s[16:19], s58 offen sc1
    buffer_store_dwordx4 v[148:151], v13, s[16:19], s59 offen sc1
LB_rs4:
    s_add_u32 s51, s51, 5120
LB_r1:
    s_add_u32 m0, s26, 21504
    s_mov_b32 exec_hi, 0xff
    buffer_load_dwordx4 v220, s[16:19], s68 offen offset:0 sc1 lds
    buffer_load_dwordx4 v221, s[16:19], s68 offen offset:672 sc1 lds
    buffer_load_dwordx4 v222, s[16:19], s68 offen offset:1344 sc1 lds
    buffer_load_dwordx4 v223, s[16:19], s68 offen offset:2016 sc1 lds
    s_mov_b32 exec_hi, -1
    s_add_u32 s68, s68, 81920
    s_add_u32 m0, s26, 24192
    s_mov_b32 exec_hi, 0xff
    buffer_load_dwordx4 v220, s[16:19], s68 offen offset:0 sc1 lds
    buffer_load_dwordx4 v221, s[16:19], s68 offen offset:672 sc1 lds
    buffer_load_dwordx4 v222, s[16:19], s68 offen offset:1344 sc1 lds
    buffer_load_dwordx4 v223, s[16:19], s68 offen offset:2016 sc1 lds
    s_mov_b32 exec_hi, -1
    s_add_u32 s68, s68, 573440
    s_cmp_ge_u32 s53, 10
    s_cbranch_scc1 LB_g
    s_waitcnt vmcnt(8)
    s_and_b32 s58, s2, 7
    s_lshl3_add_u32 s58, s53, s58
    s_lshl_b32 s58, s58, 5
    s_add_u32 s58, s58, s4
    s_lshl2_add_u32 s58, s58, 0x01c40000
    v_lshlrev_b32 v32, 21, v13
    v_mov_b32 v33, s5
    buffer_store_dword v33, v32, s[16:19], s58 offen sc1
    s_branch LB_g
LB_t4:
    v_add_u32 v12, 147456, v13
    ds_read_b128 v[32:35], v12 offset:0
    ds_read_b128 v[36:39], v12 offset:1024
    v_lshrrev_b32 v101, 8, v13
    v_and_b32 v102, 1, v101
    v_mul_u32_u24 v102, 19, v102
    v_lshrrev_b32 v101, 1, v101
    v_mul_u32_u24 v100, 640, v101
    s_mul_i32 s61, s54, 20
    s_add_u32 s61, s61, 640
    v_add3_u32 v100, v100, v102, s61
    v_lshrrev_b32 v100, 7, v100
    v_bfe_u32 v102, v13, 4, 4
    v_lshl_add_u32 v100, v100, 4, v102
    v_lshlrev_b32 v100, 7, v100
    s_mov_b32 s61, 0x01cc0000
    buffer_load_dwordx4 v[96:99], v100, s[16:19], s61 offen sc1
    s_mul_i32 s66, s4, 5120
    s_mul_i32 s67, s54, 81920
    s_add_u32 s67, s67, s66
    s_add_u32 s67, s67, 0x00285000
    s_mul_i32 s68, s54, 320
    s_add_u32 s68, s68, 0x005a0000
    s_lshl_b32 s58, s66, 5
    s_add_u32 s68, s68, s58
    s_mul_i32 s26, s4, 5376
    v_cmp_le_u32 vcc, 320, v13
    v_mov_b32 v221, 9920
    s_nop 0
    v_cndmask_b32 v220, 0, v221, vcc
    v_add_u32 v220, v220, v13
    v_add_u32 v221, 19808, v220
    v_add_u32 v222, 39616, v220
    v_add_u32 v223, 59424, v220
    v_and_b32 v104, 7, v15
    v_mul_u32_u24 v104, 672, v104
    s_add_u32 s58, s26, 640
    v_add_u32 v104, s58, v104
    v_mov_b32 v108, 0x3f803f80
    v_mov_b32 v109, 0x3f803f80
    v_mov_b32 v110, 0x3f803f80
    v_mov_b32 v111, 0x3f803f80
    ds_write_b128 v104, v[108:111] offset:0
    ds_write_b128 v104, v[108:111] offset:21504
    s_lshl_b32 s46, s47, 1
    s_add_u32 s46, s46, 2
    s_waitcnt lgkmcnt(3)
    v_add_f32 v32, v32, v33
    v_add_f32 v34, v34, v35
    v_add_f32 v32, v32, v34
    v_cvt_pk_bf16_f32 v35, v32, 0
    v_lshlrev_b32 v33, 16, v35
    v_sub_f32 v33, v32, v33
    v_cvt_pk_bf16_f32 v34, v32, v33
    s_waitcnt lgkmcnt(2)
    v_add_f32 v36, v36, v37
    v_add_f32 v38, v38, v39
    v_add_f32 v36, v36, v38
    v_cvt_pk_bf16_f32 v39, v36, 0
    v_lshlrev_b32 v37, 16, v39
    v_sub_f32 v37, v36, v37
    v_cvt_pk_bf16_f32 v38, v36, v37
    v_mfma_f32_32x32x8_bf16 v[64:79], v[34:35], v[6:7], v[64:79]
    s_nop 0
    v_mfma_f32_32x32x8_bf16 v[80:95], v[38:39], v[6:7], v[80:95]
    s_nop 9
    v_mul_f32 v64, v9, v64
    v_mul_f32 v65, v9, v65
    v_mul_f32 v66, v9, v66
    v_mul_f32 v67, v9, v67
    v_mul_f32 v68, v9, v68
    v_mul_f32 v69, v9, v69
    v_mul_f32 v70, v9, v70
    v_mul_f32 v71, v9, v71
    v_fmaak_f32 v32, v64, v64, 0x409d30fc
    v_fmaak_f32 v33, v65, v65, 0x409d30fc
    v_fmaak_f32 v34, v66, v66, 0x409d30fc
    v_fmaak_f32 v35, v67, v67, 0x409d30fc
    v_fmaak_f32 v36, v68, v68, 0x409d30fc
    v_fmaak_f32 v37, v69, v69, 0x409d30fc
    v_fmaak_f32 v38, v70, v70, 0x409d30fc
    v_fmaak_f32 v39, v71, v71, 0x409d30fc
    v_mul_f32 v32, v32, v64
    v_mul_f32 v33, v33, v65
    v_mul_f32 v34, v34, v66
    v_mul_f32 v35, v35, v67
    v_mul_f32 v36, v36, v68
    v_mul_f32 v37, v37, v69
    v_mul_f32 v38, v38, v70
    v_mul_f32 v39, v39, v71
    v_exp_f32 v32, v32
    v_exp_f32 v33, v33
    v_exp_f32 v34, v34
    v_exp_f32 v35, v35
    v_exp_f32 v36, v36
    v_exp_f32 v37, v37
    v_exp_f32 v38, v38
    v_exp_f32 v39, v39
    v_fma_f32 v32, v32, v10, v10
    v_fma_f32 v33, v33, v10, v10
    v_fma_f32 v34, v34, v10, v10
    v_fma_f32 v35, v35, v10, v10
    v_fma_f32 v36, v36, v10, v10
    v_fma_f32 v37, v37, v10, v10
    v_fma_f32 v38, v38, v10, v10
    v_fma_f32 v39, v39, v10, v10
    v_rcp_f32 v32, v32
    v_rcp_f32 v33, v33
    v_rcp_f32 v34, v34
    v_rcp_f32 v35, v35
    v_rcp_f32 v36, v36
    v_rcp_f32 v37, v37
    v_rcp_f32 v38, v38
    v_rcp_f32 v39, v39
    v_mul_f32 v64, v64, v32
    v_mul_f32 v65, v65, v33
    v_mul_f32 v66, v66, v34
    v_mul_f32 v67, v67, v35
    v_mul_f32 v68, v68, v36
    v_mul_f32 v69, v69, v37
    v_mul_f32 v70, v70, v38
    v_mul_f32 v71, v71, v39
    v_cvt_pk_bf16_f32 v40, v64, v65
    v_cvt_pk_bf16_f32 v41, v66, v67
    v_cvt_pk_bf16_f32 v42, v68, v69
    v_cvt_pk_bf16_f32 v43, v70, v71
    s_lshl_b32 s62, s46, 11
    s_add_u32 s62, s62, s50
    buffer_store_dwordx4 v[40:43], v13, s[16:19], s62 offen offset:0 sc1
    v_mul_f32 v72, v9, v72
    v_mul_f32 v73, v9, v73
    v_mul_f32 v74, v9, v74
    v_mul_f32 v75, v9, v75
    v_mul_f32 v76, v9, v76
    v_mul_f32 v77, v9, v77
    v_mul_f32 v78, v9, v78
    v_mul_f32 v79, v9, v79
    v_fmaak_f32 v32, v72, v72, 0x409d30fc
    v_fmaak_f32 v33, v73, v73, 0x409d30fc
    v_fmaak_f32 v34, v74, v74, 0x409d30fc
    v_fmaak_f32 v35, v75, v75, 0x409d30fc
    v_fmaak_f32 v36, v76, v76, 0x409d30fc
    v_fmaak_f32 v37, v77, v77, 0x409d30fc
    v_fmaak_f32 v38, v78, v78, 0x409d30fc
    v_fmaak_f32 v39, v79, v79, 0x409d30fc
    v_mul_f32 v32, v32, v72
    v_mul_f32 v33, v33, v73
    v_mul_f32 v34, v34, v74
    v_mul_f32 v35, v35, v75
    v_mul_f32 v36, v36, v76
    v_mul_f32 v37, v37, v77
    v_mul_f32 v38, v38, v78
    v_mul_f32 v39, v39, v79
    v_exp_f32 v32, v32
    v_exp_f32 v33, v33
    v_exp_f32 v34, v34
    v_exp_f32 v35, v35
    v_exp_f32 v36, v36
    v_exp_f32 v37, v37
    v_exp_f32 v38, v38
    v_exp_f32 v39, v39
    v_fma_f32 v32, v32, v10, v10
    v_fma_f32 v33, v33, v10, v10
    v_fma_f32 v34, v34, v10, v10
    v_fma_f32 v35, v35, v10, v10
    v_fma_f32 v36, v36, v10, v10
    v_fma_f32 v37, v37, v10, v10
    v_fma_f32 v38, v38, v10, v10
    v_fma_f32 v39, v39, v10, v10
    v_rcp_f32 v32, v32
    v_rcp_f32 v33, v33
    v_rcp_f32 v34, v34
    v_rcp_f32 v35, v35
    v_rcp_f32 v36, v36
    v_rcp_f32 v37, v37
    v_rcp_f32 v38, v38
    v_rcp_f32 v39, v39
    v_mul_f32 v72, v72, v32
    v_mul_f32 v73, v73, v33
    v_mul_f32 v74, v74, v34
    v_mul_f32 v75, v75, v35
    v_mul_f32 v76, v76, v36
    v_mul_f32 v77, v77, v37
    v_mul_f32 v78, v78, v38
    v_mul_f32 v79, v79, v39
    v_cvt_pk_bf16_f32 v44, v72, v73
    v_cvt_pk_bf16_f32 v45, v74, v75
    v_cvt_pk_bf16_f32 v46, v76, v77
    v_cvt_pk_bf16_f32 v47, v78, v79
    s_lshl_b32 s62, s46, 11
    s_add_u32 s62, s62, s50
    buffer_store_dwordx4 v[44:47], v13, s[16:19], s62 offen offset:1024 sc1
    v_mul_f32 v80, v9, v80
    v_mul_f32 v81, v9, v81
    v_mul_f32 v82, v9, v82
    v_mul_f32 v83, v9, v83
    v_mul_f32 v84, v9, v84
    v_mul_f32 v85, v9, v85
    v_mul_f32 v86, v9, v86
    v_mul_f32 v87, v9, v87
    v_fmaak_f32 v32, v80, v80, 0x409d30fc
    v_fmaak_f32 v33, v81, v81, 0x409d30fc
    v_fmaak_f32 v34, v82, v82, 0x409d30fc
    v_fmaak_f32 v35, v83, v83, 0x409d30fc
    v_fmaak_f32 v36, v84, v84, 0x409d30fc
    v_fmaak_f32 v37, v85, v85, 0x409d30fc
    v_fmaak_f32 v38, v86, v86, 0x409d30fc
    v_fmaak_f32 v39, v87, v87, 0x409d30fc
    v_mul_f32 v32, v32, v80
    v_mul_f32 v33, v33, v81
    v_mul_f32 v34, v34, v82
    v_mul_f32 v35, v35, v83
    v_mul_f32 v36, v36, v84
    v_mul_f32 v37, v37, v85
    v_mul_f32 v38, v38, v86
    v_mul_f32 v39, v39, v87
    v_exp_f32 v32, v32
    v_exp_f32 v33, v33
    v_exp_f32 v34, v34
    v_exp_f32 v35, v35
    v_exp_f32 v36, v36
    v_exp_f32 v37, v37
    v_exp_f32 v38, v38
    v_exp_f32 v39, v39
    v_fma_f32 v32, v32, v10, v10
    v_fma_f32 v33, v33, v10, v10
    v_fma_f32 v34, v34, v10, v10
    v_fma_f32 v35, v35, v10, v10
    v_fma_f32 v36, v36, v10, v10
    v_fma_f32 v37, v37, v10, v10
    v_fma_f32 v38, v38, v10, v10
    v_fma_f32 v39, v39, v10, v10
    v_rcp_f32 v32, v32
    v_rcp_f32 v33, v33
    v_rcp_f32 v34, v34
    v_rcp_f32 v35, v35
    v_rcp_f32 v36, v36
    v_rcp_f32 v37, v37
    v_rcp_f32 v38, v38
    v_rcp_f32 v39, v39
    v_mul_f32 v80, v80, v32
    v_mul_f32 v81, v81, v33
    v_mul_f32 v82, v82, v34
    v_mul_f32 v83, v83, v35
    v_mul_f32 v84, v84, v36
    v_mul_f32 v85, v85, v37
    v_mul_f32 v86, v86, v38
    v_mul_f32 v87, v87, v39
    v_cvt_pk_bf16_f32 v40, v80, v81
    v_cvt_pk_bf16_f32 v41, v82, v83
    v_cvt_pk_bf16_f32 v42, v84, v85
    v_cvt_pk_bf16_f32 v43, v86, v87
    s_lshl_b32 s62, s46, 11
    s_add_u32 s62, s62, s50
    buffer_store_dwordx4 v[40:43], v13, s[16:19], s62 offen offset:2048 sc1
    v_mul_f32 v88, v9, v88
    v_mul_f32 v89, v9, v89
    v_mul_f32 v90, v9, v90
    v_mul_f32 v91, v9, v91
    v_mul_f32 v92, v9, v92
    v_mul_f32 v93, v9, v93
    v_mul_f32 v94, v9, v94
    v_mul_f32 v95, v9, v95
    v_fmaak_f32 v32, v88, v88, 0x409d30fc
    v_fmaak_f32 v33, v89, v89, 0x409d30fc
    v_fmaak_f32 v34, v90, v90, 0x409d30fc
    v_fmaak_f32 v35, v91, v91, 0x409d30fc
    v_fmaak_f32 v36, v92, v92, 0x409d30fc
    v_fmaak_f32 v37, v93, v93, 0x409d30fc
    v_fmaak_f32 v38, v94, v94, 0x409d30fc
    v_fmaak_f32 v39, v95, v95, 0x409d30fc
    v_mul_f32 v32, v32, v88
    v_mul_f32 v33, v33, v89
    v_mul_f32 v34, v34, v90
    v_mul_f32 v35, v35, v91
    v_mul_f32 v36, v36, v92
    v_mul_f32 v37, v37, v93
    v_mul_f32 v38, v38, v94
    v_mul_f32 v39, v39, v95
    v_exp_f32 v32, v32
    v_exp_f32 v33, v33
    v_exp_f32 v34, v34
    v_exp_f32 v35, v35
    v_exp_f32 v36, v36
    v_exp_f32 v37, v37
    v_exp_f32 v38, v38
    v_exp_f32 v39, v39
    v_fma_f32 v32, v32, v10, v10
    v_fma_f32 v33, v33, v10, v10
    v_fma_f32 v34, v34, v10, v10
    v_fma_f32 v35, v35, v10, v10
    v_fma_f32 v36, v36, v10, v10
    v_fma_f32 v37, v37, v10, v10
    v_fma_f32 v38, v38, v10, v10
    v_fma_f32 v39, v39, v10, v10
    v_rcp_f32 v32, v32
    v_rcp_f32 v33, v33
    v_rcp_f32 v34, v34
    v_rcp_f32 v35, v35
    v_rcp_f32 v36, v36
    v_rcp_f32 v37, v37
    v_rcp_f32 v38, v38
    v_rcp_f32 v39, v39
    v_mul_f32 v88, v88, v32
    v_mul_f32 v89, v89, v33
    v_mul_f32 v90, v90, v34
    v_mul_f32 v91, v91, v35
    v_mul_f32 v92, v92, v36
    v_mul_f32 v93, v93, v37
    v_mul_f32 v94, v94, v38
    v_mul_f32 v95, v95, v39
    v_cvt_pk_bf16_f32 v44, v88, v89
    v_cvt_pk_bf16_f32 v45, v90, v91
    v_cvt_pk_bf16_f32 v46, v92, v93
    v_cvt_pk_bf16_f32 v47, v94, v95
    s_lshl_b32 s62, s46, 11
    s_add_u32 s62, s62, s50
    buffer_store_dwordx4 v[44:47], v13, s[16:19], s62 offen offset:3072 sc1
    s_mov_b32 s60, 100000
LB_p4:
    s_waitcnt vmcnt(4)
    v_xor_b32 v96, s5, v96
    v_xor_b32 v97, s5, v97
    v_xor_b32 v98, s5, v98
    v_xor_b32 v99, s5, v99
    v_or3_b32 v96, v96, v97, v98
    v_or_b32 v96, v96, v99
    v_cmp_ne_u32 vcc, 0, v96
    s_nop 0
    s_cmp_eq_u64 vcc, 0
    s_cbranch_scc1 LB_p4_x
    s_sleep 1
    buffer_load_dwordx4 v[96:99], v100, s[16:19], s61 offen sc1
    s_sub_u32 s60, s60, 1
    s_waitcnt vmcnt(0)
    s_cbranch_scc0 LB_p4
LB_p4_x:
    s_add_u32 m0, s66, 104960
    s_nop 0
    buffer_load_dwordx4 v13, s[16:19], s67 offen offset:0 sc1 lds
    buffer_load_dwordx4 v13, s[16:19], s67 offen offset:1024 sc1 lds
    buffer_load_dwordx4 v13, s[16:19], s67 offen offset:2048 sc1 lds
    buffer_load_dwordx4 v13, s[16:19], s67 offen offset:3072 sc1 lds
    s_add_u32 m0, s66, 109056
    s_add_u32 s67, s67, 4096
    buffer_load_dwordx4 v13, s[16:19], s67 offen offset:0 sc1 lds
    s_add_u32 s67, s67, 16384
    s_add_u32 m0, s26, 0
    s_mov_b32 exec_hi, 0xff
    buffer_load_dwordx4 v220, s[16:19], s68 offen offset:0 sc1 lds
    buffer_load_dwordx4 v221, s[16:19], s68 offen offset:672 sc1 lds
    buffer_load_dwordx4 v222, s[16:19], s68 offen offset:1344 sc1 lds
    buffer_load_dwordx4 v223, s[16:19], s68 offen offset:2016 sc1 lds
    s_mov_b32 exec_hi, -1
    s_add_u32 s68, s68, 81920
    s_add_u32 m0, s26, 2688
    s_mov_b32 exec_hi, 0xff
    buffer_load_dwordx4 v220, s[16:19], s68 offen offset:0 sc1 lds
    buffer_load_dwordx4 v221, s[16:19], s68 offen offset:672 sc1 lds
    buffer_load_dwordx4 v222, s[16:19], s68 offen offset:1344 sc1 lds
    buffer_load_dwordx4 v223, s[16:19], s68 offen offset:2016 sc1 lds
    s_mov_b32 exec_hi, -1
    s_add_u32 s68, s68, 573440
    s_lshl_b32 s58, s6, 2
    s_add_u32 s58, s58, s4
    s_lshl_b32 s58, s58, 4
    s_add_u32 s58, s58, s7
    s_lshl_b32 s58, s58, 6
    s_and_b32 s59, s3, 4
    s_add_u32 s58, s58, s59
    s_lshl_b32 s58, s58, 1
    s_add_u32 s58, s58, 0x01c00000
    s_waitcnt vmcnt(13)
    v_lshlrev_b32 v34, 21, v13
    v_mov_b32 v32, s5
    v_mov_b32 v33, s5
    buffer_store_dwordx2 v[32:33], v34, s[16:19], s58 offen sc1
    s_add_u32 m0, s26, 21504
    s_mov_b32 exec_hi, 0xff
    buffer_load_dwordx4 v220, s[16:19], s68 offen offset:0 sc1 lds
    buffer_load_dwordx4 v221, s[16:19], s68 offen offset:672 sc1 lds
    buffer_load_dwordx4 v222, s[16:19], s68 offen offset:1344 sc1 lds
    buffer_load_dwordx4 v223, s[16:19], s68 offen offset:2016 sc1 lds
    s_mov_b32 exec_hi, -1
    s_add_u32 s68, s68, 81920
    s_add_u32 m0, s26, 24192
    s_mov_b32 exec_hi, 0xff
    buffer_load_dwordx4 v220, s[16:19], s68 offen offset:0 sc1 lds
    buffer_load_dwordx4 v221, s[16:19], s68 offen offset:672 sc1 lds
    buffer_load_dwordx4 v222, s[16:19], s68 offen offset:1344 sc1 lds
    buffer_load_dwordx4 v223, s[16:19], s68 offen offset:2016 sc1 lds
    s_mov_b32 exec_hi, -1
    s_add_u32 s68, s68, 573440
LB_g:
    s_and_b32 s58, s56, 1
    s_and_b32 s45, s57, 1
    s_lshl1_add_u32 s47, s58, s45
    s_lshl_b32 s45, s45, 2
    s_sub_u32 s45, 4, s45
    v_lshl_add_u32 v12, s47, 10, v13
    v_lshl_add_u32 v3, s45, 10, v13
    s_mul_i32 s58, s58, 110592
    v_and_b32 v255, 0x300, v13
    v_add_u32 v255, v255, v13
    v_add_u32 v254, s58, v255
    s_sub_u32 s58, 110592, s58
    v_lshl_add_u32 v0, v14, 12, v255
    v_add_u32 v255, s58, v255
    v_min_u32 v2, 23, v15
    s_mul_i32 s58, s57, 5
    s_lshr_b32 s58, s58, 1
    s_lshl_b32 s58, s58, 3
    v_add_lshl_u32 v2, v2, s58, 7
    v_add_u32 v9, 0x00040000, v2
    v_lshlrev_b32 v2, 3, v13
    s_lshr_b32 s61, s56, 1
    s_lshl_b32 s61, s61, 12
    v_add_u32 v2, s61, v2
    v_cmp_eq_u32 vcc, 0, v14
    s_nop 1
    v_cndmask_b32 v2, v9, v2, vcc
    s_mov_b32 s61, 0x01c00000
    s_lshl_b32 s58, s2, 2
    s_add_u32 s58, s58, s4
    s_cmp_eq_u32 s58, 0
    s_cbranch_scc0 LB_nep
    v_lshlrev_b32 v10, 3, v13
    s_mov_b32 s58, 0x01cc0000
    buffer_load_dword v11, v10, s[16:19], s58 offen sc1
    s_waitcnt vmcnt(0)
    s_mov_b32 s60, 100000
LB_pe0:
    v_cmp_ne_u32 vcc, s5, v11
    s_nop 0
    s_cmp_eq_u64 vcc, 0
    s_cbranch_scc1 LB_pe0_x
    s_sleep 1
    buffer_load_dword v11, v10, s[16:19], s58 offen sc1
    s_sub_u32 s60, s60, 1
    s_waitcnt vmcnt(0)
    s_cbranch_scc0 LB_pe0
LB_pe0_x:
    s_mov_b32 s58, 0x01cc2000
    buffer_load_dword v11, v10, s[16:19], s58 offen sc1
    s_waitcnt vmcnt(0)
    s_mov_b32 s60, 100000
LB_pe1:
    v_cmp_ne_u32 vcc, s5, v11
    s_nop 0
    s_cmp_eq_u64 vcc, 0
    s_cbranch_scc1 LB_pe1_x
    s_sleep 1
    buffer_load_dword v11, v10, s[16:19], s58 offen sc1
    s_sub_u32 s60, s60, 1
    s_waitcnt vmcnt(0)
    s_cbranch_scc0 LB_pe1
LB_pe1_x:
    s_mov_b32 s58, 0x01cc4000
    buffer_load_dword v11, v10, s[16:19], s58 offen sc1
    s_waitcnt vmcnt(0)
    s_mov_b32 s60, 100000
LB_pe2:
    v_cmp_ne_u32 vcc, s5, v11
    s_nop 0
    s_cmp_eq_u64 vcc, 0
    s_cbranch_scc1 LB_pe2_x
    s_sleep 1
    buffer_load_dword v11, v10, s[16:19], s58 offen sc1
    s_sub_u32 s60, s60, 1
    s_waitcnt vmcnt(0)
    s_cbranch_scc0 LB_pe2
LB_pe2_x:
    s_mov_b32 s58, 0x01cc6000
    buffer_load_dword v11, v10, s[16:19], s58 offen sc1
    s_waitcnt vmcnt(0)
    s_mov_b32 s60, 100000
LB_pe3:
    v_cmp_ne_u32 vcc, s5, v11
    s_nop 0
    s_cmp_eq_u64 vcc, 0
    s_cbranch_scc1 LB_pe3_x
    s_sleep 1
    buffer_load_dword v11, v10, s[16:19], s58 offen sc1
    s_sub_u32 s60, s60, 1
    s_waitcnt vmcnt(0)
    s_cbranch_scc0 LB_pe3
LB_pe3_x:
    s_mov_b32 s58, 0x01cf0000
    v_lshlrev_b32 v10, 21, v13
    v_mov_b32 v11, s5
    buffer_store_dword v11, v10, s[16:19], s58 offen sc1
LB_nep:
    s_lshl2_add_u32 s58, s55, s4
    s_mul_i32 s51, s58, 81920
    s_add_u32 s51, s51, 0x01400000
    s_lshl_b32 s52, s54, 10
    s_add_u32 s52, s52, s51
    s_add_u32 s43, s52, 40960
    s_lshl_b32 s58, s54, 8
    s_add_u32 s51, s51, s58
    s_add_u32 s51, s51, 32768
    v_bfe_u32 v159, v13, 8, 1
    v_mul_u32_u24 v159, 40704, v159
    v_add_u32 v159, v159, v13
    v_lshl_add_u32 v159, v14, 30, v159
    v_mov_b32 v164, -1
    v_mov_b32 v165, -1
    v_mov_b32 v166, -1
    v_mov_b32 v167, -1
    buffer_store_dwordx4 v[164:167], v13, s[16:19], s52 offen sc1
    buffer_store_dwordx4 v[164:167], v13, s[16:19], s43 offen sc1
    buffer_store_dwordx4 v[164:167], v159, s[16:19], s51 offen sc1
    v_lshrrev_b32 v244, 8, v13
    v_lshl_add_u32 v244, s3, 2, v244
    v_lshrrev_b32 v245, 1, v13
    v_and_b32 v245, 0x80, v245
    v_xor_b32 v245, v245, v13
    v_bfe_u32 v245, v245, 4, 4
    v_and_b32 v246, 7, v244
    v_xor_b32 v246, v246, v245
    v_mul_u32_u24 v250, 640, v244
    v_lshl_add_u32 v252, v245, 2, v250
    v_lshl_add_u32 v250, v246, 4, v250
    v_add_u32 v251, 122880, v250
    v_lshlrev_b32 v252, 1, v252
    v_lshrrev_b32 v245, 3, v245
    v_lshl_add_u32 v253, v245, 30, v252
    s_mul_i32 s58, s57, 320
    s_mul_i32 s42, s56, 40960
    s_add_u32 s42, s42, s58
    s_lshl_b32 s59, s47, 6
    s_add_u32 s49, s42, s59
    s_lshl_b32 s48, s45, 6
    s_add_u32 s42, s42, s48
    s_add_u32 s58, s58, s59
    s_xor_b32 s48, s56, 1
    s_mul_i32 s48, s48, 40960
    s_add_u32 s48, s48, s58
    buffer_load_dwordx2 v[244:245], v252, s[8:11], s48 offen
    buffer_load_dwordx2 v[246:247], v252, s[8:11], s49 offen
    buffer_load_dwordx2 v[248:249], v253, s[8:11], s42 offen
    v_and_b32 v5, 7, v15
    v_xor_b32 v5, v5, v14
    v_mul_u32_u24 v4, 640, v15
    v_lshl_add_u32 v4, v5, 4, v4
    s_mov_b32 s58, 20480
    s_cmp_eq_u32 s4, 1
    s_cselect_b32 s58, 64000, s58
    s_cmp_eq_u32 s4, 2
    s_cselect_b32 s58, 122880, s58
    s_cmp_eq_u32 s4, 3
    s_cselect_b32 s58, 143360, s58
    v_add_u32 v4, s58, v4
    v_xor_b32 v5, 32, v4
    v_xor_b32 v6, 64, v4
    v_xor_b32 v7, 96, v4
    v_lshrrev_b32 v96, 8, v13
    v_add_u32 v96, s4, v96
    v_lshlrev_b32 v96, 20, v96
    v_lshl_add_u32 v96, v15, 1, v96
    s_mul_i32 s58, s57, 320
    v_mov_b32 v98, 0x3f80
    v_mov_b32 v99, 0
    s_lshl_b32 s59, s47, 6
    s_add_u32 s59, s59, s58
    s_lshl_b32 s62, s45, 6
    s_add_u32 s58, s58, s62
    buffer_load_ushort v100, v96, s[28:31], s59 offen offset:0
    buffer_load_ushort v102, v96, s[28:31], s59 offen offset:32
    buffer_load_ushort v104, v96, s[28:31], s59 offen offset:64
    buffer_load_ushort v106, v96, s[28:31], s59 offen offset:96
    buffer_load_ushort v108, v96, s[28:31], s58 offen offset:0
    buffer_load_ushort v110, v96, s[28:31], s58 offen offset:32
    v_mov_b32 v101, 0
    v_mov_b32 v103, 0
    v_mov_b32 v105, 0
    v_mov_b32 v107, 0
    v_mov_b32 v109, 0
    v_mov_b32 v111, 0
    s_waitcnt vmcnt(5)
    v_mfma_f32_16x16x16_bf16 v[216:219], v[100:101], v[98:99], 0
    s_waitcnt vmcnt(4)
    v_mfma_f32_16x16x16_bf16 v[224:227], v[102:103], v[98:99], 0
    s_waitcnt vmcnt(3)
    v_mfma_f32_16x16x16_bf16 v[228:231], v[104:105], v[98:99], 0
    s_waitcnt vmcnt(2)
    v_mfma_f32_16x16x16_bf16 v[232:235], v[106:107], v[98:99], 0
    s_waitcnt vmcnt(1)
    v_mfma_f32_16x16x16_bf16 v[236:239], v[108:109], v[98:99], 0
    s_waitcnt vmcnt(0)
    v_mfma_f32_16x16x16_bf16 v[240:243], v[110:111], v[98:99], 0
    s_waitcnt vmcnt(0) lgkmcnt(0)
    s_barrier
    buffer_load_dwordx4 v[8:11], v2, s[16:19], s61 offen sc1
    s_add_u32 m0, s66, 43520
    s_nop 0
    buffer_load_dwordx4 v13, s[16:19], s67 offen offset:0 sc1 lds
    buffer_load_dwordx4 v13, s[16:19], s67 offen offset:1024 sc1 lds
    buffer_load_dwordx4 v13, s[16:19], s67 offen offset:2048 sc1 lds
    buffer_load_dwordx4 v13, s[16:19], s67 offen offset:3072 sc1 lds
    s_add_u32 m0, s66, 47616
    s_add_u32 s67, s67, 4096
    buffer_load_dwordx4 v13, s[16:19], s67 offen offset:0 sc1 lds
    s_add_u32 s67, s67, 16384
    s_add_u32 m0, s66, 64000
    s_nop 0
    buffer_load_dwordx4 v13, s[16:19], s67 offen offset:0 sc1 lds
    buffer_load_dwordx4 v13, s[16:19], s67 offen offset:1024 sc1 lds
    buffer_load_dwordx4 v13, s[16:19], s67 offen offset:2048 sc1 lds
    buffer_load_dwordx4 v13, s[16:19], s67 offen offset:3072 sc1 lds
    s_add_u32 m0, s66, 68096
    s_add_u32 s67, s67, 4096
    buffer_load_dwordx4 v13, s[16:19], s67 offen offset:0 sc1 lds
    s_add_u32 s67, s67, 16384
    s_mov_b32 s60, 100000
LB_p2:
    s_waitcnt vmcnt(10)
    v_xor_b32 v8, s5, v8
    v_xor_b32 v9, s5, v9
    v_xor_b32 v10, s5, v10
    v_xor_b32 v11, s5, v11
    v_or3_b32 v8, v8, v9, v10
    v_or_b32 v8, v8, v11
    v_cmp_ne_u32 vcc, 0, v8
    s_nop 0
    s_cmp_eq_u64 vcc, 0
    s_cbranch_scc1 LB_p2_x
    s_sleep 3
    buffer_load_dwordx4 v[8:11], v2, s[16:19], s61 offen sc1
    s_sub_u32 s60, s60, 1
    s_waitcnt vmcnt(0)
    s_cbranch_scc0 LB_p2
LB_p2_x:
    v_lshl_add_u32 v10, s47, 10, v0
    v_lshl_add_u32 v11, s45, 10, v0
    v_and_b32 v0, 15, v15
    v_mul_u32_u24 v0, 640, v0
    v_lshrrev_b32 v1, 4, v13
    v_xor_b32 v1, v1, v13
    v_and_b32 v1, 0x70, v1
    v_readfirstlane_b32 s58, v4
    s_nop 1
    v_add3_u32 v0, v0, v1, s58
    v_xor_b32 v1, 64, v0
    s_setprio 0
    s_and_b32 s69, s56, 62
    s_mul_i32 s69, s69, 108
    s_min_u32 s59, s4, 2
    s_mul_i32 s58, s4, 13
    s_add_u32 s58, s58, s59
    s_lshl_b32 s58, s58, 1
    s_add_u32 s69, s69, s58
    s_lshl_b32 s69, s69, 10
    s_add_u32 s69, s69, 0x00800000
    s_mul_i32 s65, s57, 108
    s_add_u32 s65, s65, s58
    s_mul_i32 s65, s65, 5120
    s_add_u32 s65, s65, 0x01000000
    buffer_load_dwordx4 v[96:99], v255, s[16:19], s69 offen offset:0 sc1
    buffer_load_dwordx4 v[112:115], v10, s[16:19], s65 offen offset:0 sc1
    buffer_load_dwordx4 v[100:103], v255, s[16:19], s69 offen offset:256 sc1
    buffer_load_dwordx4 v[116:119], v10, s[16:19], s65 offen offset:256 sc1
    buffer_load_dwordx4 v[120:123], v10, s[16:19], s65 offen offset:1024 sc1
    buffer_load_dwordx4 v[124:127], v10, s[16:19], s65 offen offset:1280 sc1
    buffer_load_dwordx4 v[104:107], v254, s[16:19], s69 offen offset:0 sc1
    buffer_load_dwordx4 v[108:111], v254, s[16:19], s69 offen offset:256 sc1
    buffer_load_dwordx4 v[128:131], v11, s[16:19], s65 offen offset:0 sc1
    buffer_load_dwordx4 v[132:135], v11, s[16:19], s65 offen offset:256 sc1
    s_add_u32 s69, s69, 2048
    s_add_u32 s65, s65, 10240
    buffer_load_dwordx4 v[136:139], v255, s[16:19], s69 offen offset:0 sc1
    buffer_load_dwordx4 v[152:155], v10, s[16:19], s65 offen offset:0 sc1
    buffer_load_dwordx4 v[140:143], v255, s[16:19], s69 offen offset:256 sc1
    buffer_load_dwordx4 v[156:159], v10, s[16:19], s65 offen offset:256 sc1
    buffer_load_dwordx4 v[160:163], v10, s[16:19], s65 offen offset:1024 sc1
    buffer_load_dwordx4 v[164:167], v10, s[16:19], s65 offen offset:1280 sc1
    buffer_load_dwordx4 v[144:147], v254, s[16:19], s69 offen offset:0 sc1
    buffer_load_dwordx4 v[148:151], v254, s[16:19], s69 offen offset:256 sc1
    buffer_load_dwordx4 v[168:171], v11, s[16:19], s65 offen offset:0 sc1
    buffer_load_dwordx4 v[172:175], v11, s[16:19], s65 offen offset:256 sc1
    s_add_u32 s69, s69, 2048
    s_add_u32 s65, s65, 10240
    s_waitcnt vmcnt(18)
    v_mfma_f32_16x16x32_bf16 v[16:19], v[112:115], v[96:99], v[216:219]
    s_waitcnt vmcnt(17)
    v_mfma_f32_16x16x32_bf16 v[20:23], v[112:115], v[100:103], v[216:219]
    buffer_load_dwordx4 v[176:179], v255, s[16:19], s69 offen offset:0 sc1
    s_waitcnt vmcnt(17)
    v_mfma_f32_16x16x32_bf16 v[24:27], v[116:119], v[96:99], v[224:227]
    v_mfma_f32_16x16x32_bf16 v[28:31], v[116:119], v[100:103], v[224:227]
    buffer_load_dwordx4 v[192:195], v10, s[16:19], s65 offen offset:0 sc1
    s_waitcnt vmcnt(17)
    v_mfma_f32_16x16x32_bf16 v[32:35], v[120:123], v[96:99], v[228:231]
    v_mfma_f32_16x16x32_bf16 v[36:39], v[120:123], v[100:103], v[228:231]
    buffer_load_dwordx4 v[180:183], v255, s[16:19], s69 offen offset:256 sc1
    s_waitcnt vmcnt(17)
    v_mfma_f32_16x16x32_bf16 v[40:43], v[124:127], v[96:99], v[232:235]
    v_mfma_f32_16x16x32_bf16 v[44:47], v[124:127], v[100:103], v[232:235]
    buffer_load_dwordx4 v[196:199], v10, s[16:19], s65 offen offset:256 sc1
    s_waitcnt vmcnt(17)
    v_mfma_f32_16x16x32_bf16 v[48:51], v[112:115], v[104:107], v[216:219]
    s_waitcnt vmcnt(16)
    v_mfma_f32_16x16x32_bf16 v[52:55], v[112:115], v[108:111], v[216:219]
    buffer_load_dwordx4 v[200:203], v10, s[16:19], s65 offen offset:1024 sc1
    v_mfma_f32_16x16x32_bf16 v[56:59], v[116:119], v[104:107], v[224:227]
    v_mfma_f32_16x16x32_bf16 v[60:63], v[116:119], v[108:111], v[224:227]
    buffer_load_dwordx4 v[204:207], v10, s[16:19], s65 offen offset:1280 sc1
    v_mfma_f32_16x16x32_bf16 v[64:67], v[120:123], v[104:107], v[228:231]
    v_mfma_f32_16x16x32_bf16 v[68:71], v[120:123], v[108:111], v[228:231]
    buffer_load_dwordx4 v[184:187], v254, s[16:19], s69 offen offset:0 sc1
    v_mfma_f32_16x16x32_bf16 v[72:75], v[124:127], v[104:107], v[232:235]
    v_mfma_f32_16x16x32_bf16 v[76:79], v[124:127], v[108:111], v[232:235]
    buffer_load_dwordx4 v[188:191], v254, s[16:19], s69 offen offset:256 sc1
    s_waitcnt vmcnt(19)
    v_mfma_f32_16x16x32_bf16 v[80:83], v[128:131], v[104:107], v[236:239]
    v_mfma_f32_16x16x32_bf16 v[84:87], v[128:131], v[108:111], v[236:239]
    buffer_load_dwordx4 v[208:211], v11, s[16:19], s65 offen offset:0 sc1
    s_waitcnt vmcnt(19)
    v_mfma_f32_16x16x32_bf16 v[88:91], v[132:135], v[104:107], v[240:243]
    v_mfma_f32_16x16x32_bf16 v[92:95], v[132:135], v[108:111], v[240:243]
    buffer_load_dwordx4 v[212:215], v11, s[16:19], s65 offen offset:256 sc1
    s_add_u32 s69, s69, 2048
    s_add_u32 s65, s65, 10240
    s_waitcnt vmcnt(18)
    v_mfma_f32_16x16x32_bf16 v[16:19], v[152:155], v[136:139], v[16:19]
    s_waitcnt vmcnt(17)
    v_mfma_f32_16x16x32_bf16 v[20:23], v[152:155], v[140:143], v[20:23]
    buffer_load_dwordx4 v[96:99], v255, s[16:19], s69 offen offset:0 sc1
    s_waitcnt vmcnt(17)
    v_mfma_f32_16x16x32_bf16 v[24:27], v[156:159], v[136:139], v[24:27]
    v_mfma_f32_16x16x32_bf16 v[28:31], v[156:159], v[140:143], v[28:31]
    buffer_load_dwordx4 v[112:115], v10, s[16:19], s65 offen offset:0 sc1
    s_waitcnt vmcnt(17)
    v_mfma_f32_16x16x32_bf16 v[32:35], v[160:163], v[136:139], v[32:35]
    v_mfma_f32_16x16x32_bf16 v[36:39], v[160:163], v[140:143], v[36:39]
    buffer_load_dwordx4 v[100:103], v255, s[16:19], s69 offen offset:256 sc1
    s_waitcnt vmcnt(17)
    v_mfma_f32_16x16x32_bf16 v[40:43], v[164:167], v[136:139], v[40:43]
    v_mfma_f32_16x16x32_bf16 v[44:47], v[164:167], v[140:143], v[44:47]
    buffer_load_dwordx4 v[116:119], v10, s[16:19], s65 offen offset:256 sc1
    s_waitcnt vmcnt(17)
    v_mfma_f32_16x16x32_bf16 v[48:51], v[152:155], v[144:147], v[48:51]
    s_waitcnt vmcnt(16)
    v_mfma_f32_16x16x32_bf16 v[52:55], v[152:155], v[148:151], v[52:55]
    buffer_load_dwordx4 v[120:123], v10, s[16:19], s65 offen offset:1024 sc1
    v_mfma_f32_16x16x32_bf16 v[56:59], v[156:159], v[144:147], v[56:59]
    v_mfma_f32_16x16x32_bf16 v[60:63], v[156:159], v[148:151], v[60:63]
    buffer_load_dwordx4 v[124:127], v10, s[16:19], s65 offen offset:1280 sc1
    v_mfma_f32_16x16x32_bf16 v[64:67], v[160:163], v[144:147], v[64:67]
    v_mfma_f32_16x16x32_bf16 v[68:71], v[160:163], v[148:151], v[68:71]
    buffer_load_dwordx4 v[104:107], v254, s[16:19], s69 offen offset:0 sc1
    v_mfma_f32_16x16x32_bf16 v[72:75], v[164:167], v[144:147], v[72:75]
    v_mfma_f32_16x16x32_bf16 v[76:79], v[164:167], v[148:151], v[76:79]
    buffer_load_dwordx4 v[108:111], v254, s[16:19], s69 offen offset:256 sc1
    s_waitcnt vmcnt(19)
    v_mfma_f32_16x16x32_bf16 v[80:83], v[168:171], v[144:147], v[80:83]
    v_mfma_f32_16x16x32_bf16 v[84:87], v[168:171], v[148:151], v[84:87]
    buffer_load_dwordx4 v[128:131], v11, s[16:19], s65 offen offset:0 sc1
    s_waitcnt vmcnt(19)
    v_mfma_f32_16x16x32_bf16 v[88:91], v[172:175], v[144:147], v[88:91]
    v_mfma_f32_16x16x32_bf16 v[92:95], v[172:175], v[148:151], v[92:95]
    buffer_load_dwordx4 v[132:135], v11, s[16:19], s65 offen offset:256 sc1
    s_add_u32 s69, s69, 2048
    s_add_u32 s65, s65, 10240
    s_barrier
    s_add_u32 m0, s26, 125440
    s_mov_b32 exec_hi, 0xff
    buffer_load_dwordx4 v220, s[16:19], s68 offen offset:0 sc1 lds
    buffer_load_dwordx4 v221, s[16:19], s68 offen offset:672 sc1 lds
    buffer_load_dwordx4 v222, s[16:19], s68 offen offset:1344 sc1 lds
    buffer_load_dwordx4 v223, s[16:19], s68 offen offset:2016 sc1 lds
    s_mov_b32 exec_hi, -1
    s_add_u32 s68, s68, 81920
    s_add_u32 m0, s26, 128128
    s_mov_b32 exec_hi, 0xff
    buffer_load_dwordx4 v220, s[16:19], s68 offen offset:0 sc1 lds
    buffer_load_dwordx4 v221, s[16:19], s68 offen offset:672 sc1 lds
    buffer_load_dwordx4 v222, s[16:19], s68 offen offset:1344 sc1 lds
    buffer_load_dwordx4 v223, s[16:19], s68 offen offset:2016 sc1 lds
    s_mov_b32 exec_hi, -1
    s_add_u32 s68, s68, 573440
    s_waitcnt vmcnt(26)
    v_mfma_f32_16x16x32_bf16 v[16:19], v[192:195], v[176:179], v[16:19]
    s_waitcnt vmcnt(25)
    v_mfma_f32_16x16x32_bf16 v[20:23], v[192:195], v[180:183], v[20:23]
    buffer_load_dwordx4 v[136:139], v255, s[16:19], s69 offen offset:0 sc1
    s_waitcnt vmcnt(25)
    v_mfma_f32_16x16x32_bf16 v[24:27], v[196:199], v[176:179], v[24:27]
    v_mfma_f32_16x16x32_bf16 v[28:31], v[196:199], v[180:183], v[28:31]
    buffer_load_dwordx4 v[152:155], v10, s[16:19], s65 offen offset:0 sc1
    s_waitcnt vmcnt(25)
    v_mfma_f32_16x16x32_bf16 v[32:35], v[200:203], v[176:179], v[32:35]
    v_mfma_f32_16x16x32_bf16 v[36:39], v[200:203], v[180:183], v[36:39]
    buffer_load_dwordx4 v[140:143], v255, s[16:19], s69 offen offset:256 sc1
    s_waitcnt vmcnt(25)
    v_mfma_f32_16x16x32_bf16 v[40:43], v[204:207], v[176:179], v[40:43]
    v_mfma_f32_16x16x32_bf16 v[44:47], v[204:207], v[180:183], v[44:47]
    buffer_load_dwordx4 v[156:159], v10, s[16:19], s65 offen offset:256 sc1
    s_waitcnt vmcnt(25)
    v_mfma_f32_16x16x32_bf16 v[48:51], v[192:195], v[184:187], v[48:51]
    s_waitcnt vmcnt(24)
    v_mfma_f32_16x16x32_bf16 v[52:55], v[192:195], v[188:191], v[52:55]
    buffer_load_dwordx4 v[160:163], v10, s[16:19], s65 offen offset:1024 sc1
    v_mfma_f32_16x16x32_bf16 v[56:59], v[196:199], v[184:187], v[56:59]
    v_mfma_f32_16x16x32_bf16 v[60:63], v[196:199], v[188:191], v[60:63]
    buffer_load_dwordx4 v[164:167], v10, s[16:19], s65 offen offset:1280 sc1
    v_mfma_f32_16x16x32_bf16 v[64:67], v[200:203], v[184:187], v[64:67]
    v_mfma_f32_16x16x32_bf16 v[68:71], v[200:203], v[188:191], v[68:71]
    buffer_load_dwordx4 v[144:147], v254, s[16:19], s69 offen offset:0 sc1
    v_mfma_f32_16x16x32_bf16 v[72:75], v[204:207], v[184:187], v[72:75]
    v_mfma_f32_16x16x32_bf16 v[76:79], v[204:207], v[188:191], v[76:79]
    buffer_load_dwordx4 v[148:151], v254, s[16:19], s69 offen offset:256 sc1
    s_waitcnt vmcnt(27)
    v_mfma_f32_16x16x32_bf16 v[80:83], v[208:211], v[184:187], v[80:83]
    v_mfma_f32_16x16x32_bf16 v[84:87], v[208:211], v[188:191], v[84:87]
    buffer_load_dwordx4 v[168:171], v11, s[16:19], s65 offen offset:0 sc1
    s_waitcnt vmcnt(27)
    v_mfma_f32_16x16x32_bf16 v[88:91], v[212:215], v[184:187], v[88:91]
    v_mfma_f32_16x16x32_bf16 v[92:95], v[212:215], v[188:191], v[92:95]
    buffer_load_dwordx4 v[172:175], v11, s[16:19], s65 offen offset:256 sc1
    s_add_u32 s69, s69, 2048
    s_add_u32 s65, s65, 10240
    s_waitcnt vmcnt(26)
    v_mfma_f32_16x16x32_bf16 v[16:19], v[112:115], v[96:99], v[16:19]
    s_waitcnt vmcnt(25)
    v_mfma_f32_16x16x32_bf16 v[20:23], v[112:115], v[100:103], v[20:23]
    buffer_load_dwordx4 v[176:179], v255, s[16:19], s69 offen offset:0 sc1
    s_waitcnt vmcnt(25)
    v_mfma_f32_16x16x32_bf16 v[24:27], v[116:119], v[96:99], v[24:27]
    v_mfma_f32_16x16x32_bf16 v[28:31], v[116:119], v[100:103], v[28:31]
    buffer_load_dwordx4 v[192:195], v10, s[16:19], s65 offen offset:0 sc1
    s_waitcnt vmcnt(25)
    v_mfma_f32_16x16x32_bf16 v[32:35], v[120:123], v[96:99], v[32:35]
    v_mfma_f32_16x16x32_bf16 v[36:39], v[120:123], v[100:103], v[36:39]
    buffer_load_dwordx4 v[180:183], v255, s[16:19], s69 offen offset:256 sc1
    s_waitcnt vmcnt(25)
    v_mfma_f32_16x16x32_bf16 v[40:43], v[124:127], v[96:99], v[40:43]
    v_mfma_f32_16x16x32_bf16 v[44:47], v[124:127], v[100:103], v[44:47]
    buffer_load_dwordx4 v[196:199], v10, s[16:19], s65 offen offset:256 sc1
    s_waitcnt vmcnt(25)
    v_mfma_f32_16x16x32_bf16 v[48:51], v[112:115], v[104:107], v[48:51]
    s_waitcnt vmcnt(24)
    v_mfma_f32_16x16x32_bf16 v[52:55], v[112:115], v[108:111], v[52:55]
    buffer_load_dwordx4 v[200:203], v10, s[16:19], s65 offen offset:1024 sc1
    v_mfma_f32_16x16x32_bf16 v[56:59], v[116:119], v[104:107], v[56:59]
    v_mfma_f32_16x16x32_bf16 v[60:63], v[116:119], v[108:111], v[60:63]
    buffer_load_dwordx4 v[204:207], v10, s[16:19], s65 offen offset:1280 sc1
    v_mfma_f32_16x16x32_bf16 v[64:67], v[120:123], v[104:107], v[64:67]
    v_mfma_f32_16x16x32_bf16 v[68:71], v[120:123], v[108:111], v[68:71]
    buffer_load_dwordx4 v[184:187], v254, s[16:19], s69 offen offset:0 sc1
    v_mfma_f32_16x16x32_bf16 v[72:75], v[124:127], v[104:107], v[72:75]
    v_mfma_f32_16x16x32_bf16 v[76:79], v[124:127], v[108:111], v[76:79]
    buffer_load_dwordx4 v[188:191], v254, s[16:19], s69 offen offset:256 sc1
    s_waitcnt vmcnt(27)
    v_mfma_f32_16x16x32_bf16 v[80:83], v[128:131], v[104:107], v[80:83]
    v_mfma_f32_16x16x32_bf16 v[84:87], v[128:131], v[108:111], v[84:87]
    buffer_load_dwordx4 v[208:211], v11, s[16:19], s65 offen offset:0 sc1
    s_waitcnt vmcnt(27)
    v_mfma_f32_16x16x32_bf16 v[88:91], v[132:135], v[104:107], v[88:91]
    v_mfma_f32_16x16x32_bf16 v[92:95], v[132:135], v[108:111], v[92:95]
    buffer_load_dwordx4 v[212:215], v11, s[16:19], s65 offen offset:256 sc1
    s_add_u32 s69, s69, 2048
    s_add_u32 s65, s65, 10240
    s_waitcnt vmcnt(18)
    v_mfma_f32_16x16x32_bf16 v[16:19], v[152:155], v[136:139], v[16:19]
    s_waitcnt vmcnt(17)
    v_mfma_f32_16x16x32_bf16 v[20:23], v[152:155], v[140:143], v[20:23]
    buffer_load_dwordx4 v[96:99], v255, s[16:19], s69 offen offset:0 sc1
    s_waitcnt vmcnt(17)
    v_mfma_f32_16x16x32_bf16 v[24:27], v[156:159], v[136:139], v[24:27]
    v_mfma_f32_16x16x32_bf16 v[28:31], v[156:159], v[140:143], v[28:31]
    buffer_load_dwordx4 v[112:115], v10, s[16:19], s65 offen offset:0 sc1
    s_waitcnt vmcnt(17)
    v_mfma_f32_16x16x32_bf16 v[32:35], v[160:163], v[136:139], v[32:35]
    v_mfma_f32_16x16x32_bf16 v[36:39], v[160:163], v[140:143], v[36:39]
    buffer_load_dwordx4 v[100:103], v255, s[16:19], s69 offen offset:256 sc1
    s_waitcnt vmcnt(17)
    v_mfma_f32_16x16x32_bf16 v[40:43], v[164:167], v[136:139], v[40:43]
    v_mfma_f32_16x16x32_bf16 v[44:47], v[164:167], v[140:143], v[44:47]
    buffer_load_dwordx4 v[116:119], v10, s[16:19], s65 offen offset:256 sc1
    s_waitcnt vmcnt(17)
    v_mfma_f32_16x16x32_bf16 v[48:51], v[152:155], v[144:147], v[48:51]
    s_waitcnt vmcnt(16)
    v_mfma_f32_16x16x32_bf16 v[52:55], v[152:155], v[148:151], v[52:55]
    buffer_load_dwordx4 v[120:123], v10, s[16:19], s65 offen offset:1024 sc1
    v_mfma_f32_16x16x32_bf16 v[56:59], v[156:159], v[144:147], v[56:59]
    v_mfma_f32_16x16x32_bf16 v[60:63], v[156:159], v[148:151], v[60:63]
    buffer_load_dwordx4 v[124:127], v10, s[16:19], s65 offen offset:1280 sc1
    v_mfma_f32_16x16x32_bf16 v[64:67], v[160:163], v[144:147], v[64:67]
    v_mfma_f32_16x16x32_bf16 v[68:71], v[160:163], v[148:151], v[68:71]
    buffer_load_dwordx4 v[104:107], v254, s[16:19], s69 offen offset:0 sc1
    v_mfma_f32_16x16x32_bf16 v[72:75], v[164:167], v[144:147], v[72:75]
    v_mfma_f32_16x16x32_bf16 v[76:79], v[164:167], v[148:151], v[76:79]
    buffer_load_dwordx4 v[108:111], v254, s[16:19], s69 offen offset:256 sc1
    s_waitcnt vmcnt(19)
    v_mfma_f32_16x16x32_bf16 v[80:83], v[168:171], v[144:147], v[80:83]
    v_mfma_f32_16x16x32_bf16 v[84:87], v[168:171], v[148:151], v[84:87]
    buffer_load_dwordx4 v[128:131], v11, s[16:19], s65 offen offset:0 sc1
    s_waitcnt vmcnt(19)
    v_mfma_f32_16x16x32_bf16 v[88:91], v[172:175], v[144:147], v[88:91]
    v_mfma_f32_16x16x32_bf16 v[92:95], v[172:175], v[148:151], v[92:95]
    buffer_load_dwordx4 v[132:135], v11, s[16:19], s65 offen offset:256 sc1
    s_add_u32 s69, s69, 2048
    s_add_u32 s65, s65, 10240
    s_waitcnt vmcnt(18)
    v_mfma_f32_16x16x32_bf16 v[16:19], v[192:195], v[176:179], v[16:19]
    s_waitcnt vmcnt(17)
    v_mfma_f32_16x16x32_bf16 v[20:23], v[192:195], v[180:183], v[20:23]
    buffer_load_dwordx4 v[136:139], v255, s[16:19], s69 offen offset:0 sc1
    s_waitcnt vmcnt(17)
    v_mfma_f32_16x16x32_bf16 v[24:27], v[196:199], v[176:179], v[24:27]
    v_mfma_f32_16x16x32_bf16 v[28:31], v[196:199], v[180:183], v[28:31]
    buffer_load_dwordx4 v[152:155], v10, s[16:19], s65 offen offset:0 sc1
    s_waitcnt vmcnt(17)
    v_mfma_f32_16x16x32_bf16 v[32:35], v[200:203], v[176:179], v[32:35]
    v_mfma_f32_16x16x32_bf16 v[36:39], v[200:203], v[180:183], v[36:39]
    buffer_load_dwordx4 v[140:143], v255, s[16:19], s69 offen offset:256 sc1
    s_waitcnt vmcnt(17)
    v_mfma_f32_16x16x32_bf16 v[40:43], v[204:207], v[176:179], v[40:43]
    v_mfma_f32_16x16x32_bf16 v[44:47], v[204:207], v[180:183], v[44:47]
    buffer_load_dwordx4 v[156:159], v10, s[16:19], s65 offen offset:256 sc1
    s_waitcnt vmcnt(17)
    v_mfma_f32_16x16x32_bf16 v[48:51], v[192:195], v[184:187], v[48:51]
    s_waitcnt vmcnt(16)
    v_mfma_f32_16x16x32_bf16 v[52:55], v[192:195], v[188:191], v[52:55]
    buffer_load_dwordx4 v[160:163], v10, s[16:19], s65 offen offset:1024 sc1
    v_mfma_f32_16x16x32_bf16 v[56:59], v[196:199], v[184:187], v[56:59]
    v_mfma_f32_16x16x32_bf16 v[60:63], v[196:199], v[188:191], v[60:63]
    buffer_load_dwordx4 v[164:167], v10, s[16:19], s65 offen offset:1280 sc1
    v_mfma_f32_16x16x32_bf16 v[64:67], v[200:203], v[184:187], v[64:67]
    v_mfma_f32_16x16x32_bf16 v[68:71], v[200:203], v[188:191], v[68:71]
    buffer_load_dwordx4 v[144:147], v254, s[16:19], s69 offen offset:0 sc1
    v_mfma_f32_16x16x32_bf16 v[72:75], v[204:207], v[184:187], v[72:75]
    v_mfma_f32_16x16x32_bf16 v[76:79], v[204:207], v[188:191], v[76:79]
    buffer_load_dwordx4 v[148:151], v254, s[16:19], s69 offen offset:256 sc1
    s_waitcnt vmcnt(19)
    v_mfma_f32_16x16x32_bf16 v[80:83], v[208:211], v[184:187], v[80:83]
    v_mfma_f32_16x16x32_bf16 v[84:87], v[208:211], v[188:191], v[84:87]
    buffer_load_dwordx4 v[168:171], v11, s[16:19], s65 offen offset:0 sc1
    s_waitcnt vmcnt(19)
    v_mfma_f32_16x16x32_bf16 v[88:91], v[212:215], v[184:187], v[88:91]
    v_mfma_f32_16x16x32_bf16 v[92:95], v[212:215], v[188:191], v[92:95]
    buffer_load_dwordx4 v[172:175], v11, s[16:19], s65 offen offset:256 sc1
    s_add_u32 s69, s69, 2048
    s_add_u32 s65, s65, 10240
    s_waitcnt vmcnt(18)
    v_mfma_f32_16x16x32_bf16 v[16:19], v[112:115], v[96:99], v[16:19]
    s_waitcnt vmcnt(17)
    v_mfma_f32_16x16x32_bf16 v[20:23], v[112:115], v[100:103], v[20:23]
    buffer_load_dwordx4 v[176:179], v255, s[16:19], s69 offen offset:0 sc1
    s_waitcnt vmcnt(17)
    v_mfma_f32_16x16x32_bf16 v[24:27], v[116:119], v[96:99], v[24:27]
    v_mfma_f32_16x16x32_bf16 v[28:31], v[116:119], v[100:103], v[28:31]
    buffer_load_dwordx4 v[192:195], v10, s[16:19], s65 offen offset:0 sc1
    s_waitcnt vmcnt(17)
    v_mfma_f32_16x16x32_bf16 v[32:35], v[120:123], v[96:99], v[32:35]
    v_mfma_f32_16x16x32_bf16 v[36:39], v[120:123], v[100:103], v[36:39]
    buffer_load_dwordx4 v[180:183], v255, s[16:19], s69 offen offset:256 sc1
    s_waitcnt vmcnt(17)
    v_mfma_f32_16x16x32_bf16 v[40:43], v[124:127], v[96:99], v[40:43]
    v_mfma_f32_16x16x32_bf16 v[44:47], v[124:127], v[100:103], v[44:47]
    buffer_load_dwordx4 v[196:199], v10, s[16:19], s65 offen offset:256 sc1
    s_waitcnt vmcnt(17)
    v_mfma_f32_16x16x32_bf16 v[48:51], v[112:115], v[104:107], v[48:51]
    s_waitcnt vmcnt(16)
    v_mfma_f32_16x16x32_bf16 v[52:55], v[112:115], v[108:111], v[52:55]
    buffer_load_dwordx4 v[200:203], v10, s[16:19], s65 offen offset:1024 sc1
    v_mfma_f32_16x16x32_bf16 v[56:59], v[116:119], v[104:107], v[56:59]
    v_mfma_f32_16x16x32_bf16 v[60:63], v[116:119], v[108:111], v[60:63]
    buffer_load_dwordx4 v[204:207], v10, s[16:19], s65 offen offset:1280 sc1
    v_mfma_f32_16x16x32_bf16 v[64:67], v[120:123], v[104:107], v[64:67]
    v_mfma_f32_16x16x32_bf16 v[68:71], v[120:123], v[108:111], v[68:71]
    buffer_load_dwordx4 v[184:187], v254, s[16:19], s69 offen offset:0 sc1
    v_mfma_f32_16x16x32_bf16 v[72:75], v[124:127], v[104:107], v[72:75]
    v_mfma_f32_16x16x32_bf16 v[76:79], v[124:127], v[108:111], v[76:79]
    buffer_load_dwordx4 v[188:191], v254, s[16:19], s69 offen offset:256 sc1
    s_waitcnt vmcnt(19)
    v_mfma_f32_16x16x32_bf16 v[80:83], v[128:131], v[104:107], v[80:83]
    v_mfma_f32_16x16x32_bf16 v[84:87], v[128:131], v[108:111], v[84:87]
    buffer_load_dwordx4 v[208:211], v11, s[16:19], s65 offen offset:0 sc1
    s_waitcnt vmcnt(19)
    v_mfma_f32_16x16x32_bf16 v[88:91], v[132:135], v[104:107], v[88:91]
    v_mfma_f32_16x16x32_bf16 v[92:95], v[132:135], v[108:111], v[92:95]
    buffer_load_dwordx4 v[212:215], v11, s[16:19], s65 offen offset:256 sc1
    s_add_u32 s69, s69, 2048
    s_add_u32 s65, s65, 10240
    s_waitcnt vmcnt(18)
    v_mfma_f32_16x16x32_bf16 v[16:19], v[152:155], v[136:139], v[16:19]
    s_waitcnt vmcnt(17)
    v_mfma_f32_16x16x32_bf16 v[20:23], v[152:155], v[140:143], v[20:23]
    buffer_load_dwordx4 v[96:99], v255, s[16:19], s69 offen offset:0 sc1
    s_waitcnt vmcnt(17)
    v_mfma_f32_16x16x32_bf16 v[24:27], v[156:159], v[136:139], v[24:27]
    v_mfma_f32_16x16x32_bf16 v[28:31], v[156:159], v[140:143], v[28:31]
    buffer_load_dwordx4 v[112:115], v10, s[16:19], s65 offen offset:0 sc1
    s_waitcnt vmcnt(17)
    v_mfma_f32_16x16x32_bf16 v[32:35], v[160:163], v[136:139], v[32:35]
    v_mfma_f32_16x16x32_bf16 v[36:39], v[160:163], v[140:143], v[36:39]
    buffer_load_dwordx4 v[100:103], v255, s[16:19], s69 offen offset:256 sc1
    s_waitcnt vmcnt(17)
    v_mfma_f32_16x16x32_bf16 v[40:43], v[164:167], v[136:139], v[40:43]
    v_mfma_f32_16x16x32_bf16 v[44:47], v[164:167], v[140:143], v[44:47]
    buffer_load_dwordx4 v[116:119], v10, s[16:19], s65 offen offset:256 sc1
    s_waitcnt vmcnt(54)
    s_barrier
    s_waitcnt vmcnt(17)
    v_mfma_f32_16x16x32_bf16 v[48:51], v[152:155], v[144:147], v[48:51]
    s_waitcnt vmcnt(16)
    v_mfma_f32_16x16x32_bf16 v[52:55], v[152:155], v[148:151], v[52:55]
    buffer_load_dwordx4 v[120:123], v10, s[16:19], s65 offen offset:1024 sc1
    v_mfma_f32_16x16x32_bf16 v[56:59], v[156:159], v[144:147], v[56:59]
    v_mfma_f32_16x16x32_bf16 v[60:63], v[156:159], v[148:151], v[60:63]
    buffer_load_dwordx4 v[124:127], v10, s[16:19], s65 offen offset:1280 sc1
    v_mfma_f32_16x16x32_bf16 v[64:67], v[160:163], v[144:147], v[64:67]
    v_mfma_f32_16x16x32_bf16 v[68:71], v[160:163], v[148:151], v[68:71]
    buffer_load_dwordx4 v[104:107], v254, s[16:19], s69 offen offset:0 sc1
    v_mfma_f32_16x16x32_bf16 v[72:75], v[164:167], v[144:147], v[72:75]
    v_mfma_f32_16x16x32_bf16 v[76:79], v[164:167], v[148:151], v[76:79]
    buffer_load_dwordx4 v[108:111], v254, s[16:19], s69 offen offset:256 sc1
    s_waitcnt vmcnt(19)
    v_mfma_f32_16x16x32_bf16 v[80:83], v[168:171], v[144:147], v[80:83]
    v_mfma_f32_16x16x32_bf16 v[84:87], v[168:171], v[148:151], v[84:87]
    buffer_load_dwordx4 v[128:131], v11, s[16:19], s65 offen offset:0 sc1
    s_waitcnt vmcnt(19)
    v_mfma_f32_16x16x32_bf16 v[88:91], v[172:175], v[144:147], v[88:91]
    v_mfma_f32_16x16x32_bf16 v[92:95], v[172:175], v[148:151], v[92:95]
    buffer_load_dwordx4 v[132:135], v11, s[16:19], s65 offen offset:256 sc1
    s_add_u32 s69, s69, 2048
    s_add_u32 s65, s65, 10240
    s_waitcnt vmcnt(18)
    v_mfma_f32_16x16x32_bf16 v[16:19], v[192:195], v[176:179], v[16:19]
    s_waitcnt vmcnt(17)
    v_mfma_f32_16x16x32_bf16 v[20:23], v[192:195], v[180:183], v[20:23]
    buffer_load_dwordx4 v[136:139], v255, s[16:19], s69 offen offset:0 sc1
    s_waitcnt vmcnt(17)
    v_mfma_f32_16x16x32_bf16 v[24:27], v[196:199], v[176:179], v[24:27]
    v_mfma_f32_16x16x32_bf16 v[28:31], v[196:199], v[180:183], v[28:31]
    buffer_load_dwordx4 v[152:155], v10, s[16:19], s65 offen offset:0 sc1
    s_waitcnt vmcnt(17)
    v_mfma_f32_16x16x32_bf16 v[32:35], v[200:203], v[176:179], v[32:35]
    v_mfma_f32_16x16x32_bf16 v[36:39], v[200:203], v[180:183], v[36:39]
    buffer_load_dwordx4 v[140:143], v255, s[16:19], s69 offen offset:256 sc1
    s_waitcnt vmcnt(17)
    v_mfma_f32_16x16x32_bf16 v[40:43], v[204:207], v[176:179], v[40:43]
    v_mfma_f32_16x16x32_bf16 v[44:47], v[204:207], v[180:183], v[44:47]
    buffer_load_dwordx4 v[156:159], v10, s[16:19], s65 offen offset:256 sc1
    s_waitcnt vmcnt(17)
    v_mfma_f32_16x16x32_bf16 v[48:51], v[192:195], v[184:187], v[48:51]
    s_waitcnt vmcnt(16)
    v_mfma_f32_16x16x32_bf16 v[52:55], v[192:195], v[188:191], v[52:55]
    buffer_load_dwordx4 v[160:163], v10, s[16:19], s65 offen offset:1024 sc1
    v_mfma_f32_16x16x32_bf16 v[56:59], v[196:199], v[184:187], v[56:59]
    v_mfma_f32_16x16x32_bf16 v[60:63], v[196:199], v[188:191], v[60:63]
    buffer_load_dwordx4 v[164:167], v10, s[16:19], s65 offen offset:1280 sc1
    v_mfma_f32_16x16x32_bf16 v[64:67], v[200:203], v[184:187], v[64:67]
    v_mfma_f32_16x16x32_bf16 v[68:71], v[200:203], v[188:191], v[68:71]
    buffer_load_dwordx4 v[144:147], v254, s[16:19], s69 offen offset:0 sc1
    v_mfma_f32_16x16x32_bf16 v[72:75], v[204:207], v[184:187], v[72:75]
    v_mfma_f32_16x16x32_bf16 v[76:79], v[204:207], v[188:191], v[76:79]
    buffer_load_dwordx4 v[148:151], v254, s[16:19], s69 offen offset:256 sc1
    s_waitcnt vmcnt(19)
    v_mfma_f32_16x16x32_bf16 v[80:83], v[208:211], v[184:187], v[80:83]
    v_mfma_f32_16x16x32_bf16 v[84:87], v[208:211], v[188:191], v[84:87]
    buffer_load_dwordx4 v[168:171], v11, s[16:19], s65 offen offset:0 sc1
    s_waitcnt vmcnt(19)
    v_mfma_f32_16x16x32_bf16 v[88:91], v[212:215], v[184:187], v[88:91]
    v_mfma_f32_16x16x32_bf16 v[92:95], v[212:215], v[188:191], v[92:95]
    buffer_load_dwordx4 v[172:175], v11, s[16:19], s65 offen offset:256 sc1
    s_add_u32 s69, s69, 2048
    s_add_u32 s65, s65, 10240
    s_waitcnt vmcnt(18)
    v_mfma_f32_16x16x32_bf16 v[16:19], v[112:115], v[96:99], v[16:19]
    s_waitcnt vmcnt(17)
    v_mfma_f32_16x16x32_bf16 v[20:23], v[112:115], v[100:103], v[20:23]
    buffer_load_dwordx4 v[176:179], v255, s[16:19], s69 offen offset:0 sc1
    s_waitcnt vmcnt(17)
    v_mfma_f32_16x16x32_bf16 v[24:27], v[116:119], v[96:99], v[24:27]
    v_mfma_f32_16x16x32_bf16 v[28:31], v[116:119], v[100:103], v[28:31]
    buffer_load_dwordx4 v[192:195], v10, s[16:19], s65 offen offset:0 sc1
    s_waitcnt vmcnt(17)
    v_mfma_f32_16x16x32_bf16 v[32:35], v[120:123], v[96:99], v[32:35]
    v_mfma_f32_16x16x32_bf16 v[36:39], v[120:123], v[100:103], v[36:39]
    buffer_load_dwordx4 v[180:183], v255, s[16:19], s69 offen offset:256 sc1
    s_waitcnt vmcnt(17)
    v_mfma_f32_16x16x32_bf16 v[40:43], v[124:127], v[96:99], v[40:43]
    v_mfma_f32_16x16x32_bf16 v[44:47], v[124:127], v[100:103], v[44:47]
    buffer_load_dwordx4 v[196:199], v10, s[16:19], s65 offen offset:256 sc1
    s_waitcnt vmcnt(17)
    v_mfma_f32_16x16x32_bf16 v[48:51], v[112:115], v[104:107], v[48:51]
    s_waitcnt vmcnt(16)
    v_mfma_f32_16x16x32_bf16 v[52:55], v[112:115], v[108:111], v[52:55]
    buffer_load_dwordx4 v[200:203], v10, s[16:19], s65 offen offset:1024 sc1
    v_mfma_f32_16x16x32_bf16 v[56:59], v[116:119], v[104:107], v[56:59]
    v_mfma_f32_16x16x32_bf16 v[60:63], v[116:119], v[108:111], v[60:63]
    buffer_load_dwordx4 v[204:207], v10, s[16:19], s65 offen offset:1280 sc1
    v_mfma_f32_16x16x32_bf16 v[64:67], v[120:123], v[104:107], v[64:67]
    v_mfma_f32_16x16x32_bf16 v[68:71], v[120:123], v[108:111], v[68:71]
    buffer_load_dwordx4 v[184:187], v254, s[16:19], s69 offen offset:0 sc1
    v_mfma_f32_16x16x32_bf16 v[72:75], v[124:127], v[104:107], v[72:75]
    v_mfma_f32_16x16x32_bf16 v[76:79], v[124:127], v[108:111], v[76:79]
    buffer_load_dwordx4 v[188:191], v254, s[16:19], s69 offen offset:256 sc1
    s_waitcnt vmcnt(19)
    v_mfma_f32_16x16x32_bf16 v[80:83], v[128:131], v[104:107], v[80:83]
    v_mfma_f32_16x16x32_bf16 v[84:87], v[128:131], v[108:111], v[84:87]
    buffer_load_dwordx4 v[208:211], v11, s[16:19], s65 offen offset:0 sc1
    s_waitcnt vmcnt(19)
    v_mfma_f32_16x16x32_bf16 v[88:91], v[132:135], v[104:107], v[88:91]
    v_mfma_f32_16x16x32_bf16 v[92:95], v[132:135], v[108:111], v[92:95]
    buffer_load_dwordx4 v[212:215], v11, s[16:19], s65 offen offset:256 sc1
    s_add_u32 s69, s69, 2048
    s_add_u32 s65, s65, 10240
    s_waitcnt vmcnt(18)
    v_mfma_f32_16x16x32_bf16 v[16:19], v[152:155], v[136:139], v[16:19]
    s_waitcnt vmcnt(17)
    v_mfma_f32_16x16x32_bf16 v[20:23], v[152:155], v[140:143], v[20:23]
    buffer_load_dwordx4 v[96:99], v255, s[16:19], s69 offen offset:0 sc1
    s_waitcnt vmcnt(17)
    v_mfma_f32_16x16x32_bf16 v[24:27], v[156:159], v[136:139], v[24:27]
    v_mfma_f32_16x16x32_bf16 v[28:31], v[156:159], v[140:143], v[28:31]
    buffer_load_dwordx4 v[112:115], v10, s[16:19], s65 offen offset:0 sc1
    s_waitcnt vmcnt(17)
    v_mfma_f32_16x16x32_bf16 v[32:35], v[160:163], v[136:139], v[32:35]
    v_mfma_f32_16x16x32_bf16 v[36:39], v[160:163], v[140:143], v[36:39]
    buffer_load_dwordx4 v[100:103], v255, s[16:19], s69 offen offset:256 sc1
    s_waitcnt vmcnt(17)
    v_mfma_f32_16x16x32_bf16 v[40:43], v[164:167], v[136:139], v[40:43]
    v_mfma_f32_16x16x32_bf16 v[44:47], v[164:167], v[140:143], v[44:47]
    buffer_load_dwordx4 v[116:119], v10, s[16:19], s65 offen offset:256 sc1
    s_waitcnt vmcnt(17)
    v_mfma_f32_16x16x32_bf16 v[48:51], v[152:155], v[144:147], v[48:51]
    s_waitcnt vmcnt(16)
    v_mfma_f32_16x16x32_bf16 v[52:55], v[152:155], v[148:151], v[52:55]
    buffer_load_dwordx4 v[120:123], v10, s[16:19], s65 offen offset:1024 sc1
    v_mfma_f32_16x16x32_bf16 v[56:59], v[156:159], v[144:147], v[56:59]
    v_mfma_f32_16x16x32_bf16 v[60:63], v[156:159], v[148:151], v[60:63]
    buffer_load_dwordx4 v[124:127], v10, s[16:19], s65 offen offset:1280 sc1
    v_mfma_f32_16x16x32_bf16 v[64:67], v[160:163], v[144:147], v[64:67]
    v_mfma_f32_16x16x32_bf16 v[68:71], v[160:163], v[148:151], v[68:71]
    buffer_load_dwordx4 v[104:107], v254, s[16:19], s69 offen offset:0 sc1
    v_mfma_f32_16x16x32_bf16 v[72:75], v[164:167], v[144:147], v[72:75]
    v_mfma_f32_16x16x32_bf16 v[76:79], v[164:167], v[148:151], v[76:79]
    buffer_load_dwordx4 v[108:111], v254, s[16:19], s69 offen offset:256 sc1
    s_waitcnt vmcnt(19)
    v_mfma_f32_16x16x32_bf16 v[80:83], v[168:171], v[144:147], v[80:83]
    v_mfma_f32_16x16x32_bf16 v[84:87], v[168:171], v[148:151], v[84:87]
    buffer_load_dwordx4 v[128:131], v11, s[16:19], s65 offen offset:0 sc1
    s_waitcnt vmcnt(19)
    v_mfma_f32_16x16x32_bf16 v[88:91], v[172:175], v[144:147], v[88:91]
    v_mfma_f32_16x16x32_bf16 v[92:95], v[172:175], v[148:151], v[92:95]
    buffer_load_dwordx4 v[132:135], v11, s[16:19], s65 offen offset:256 sc1
    s_add_u32 s69, s69, 2048
    s_add_u32 s65, s65, 10240
    s_waitcnt vmcnt(18)
    v_mfma_f32_16x16x32_bf16 v[16:19], v[192:195], v[176:179], v[16:19]
    s_waitcnt vmcnt(17)
    v_mfma_f32_16x16x32_bf16 v[20:23], v[192:195], v[180:183], v[20:23]
    buffer_load_dwordx4 v[136:139], v255, s[16:19], s69 offen offset:0 sc1
    s_waitcnt vmcnt(17)
    v_mfma_f32_16x16x32_bf16 v[24:27], v[196:199], v[176:179], v[24:27]
    v_mfma_f32_16x16x32_bf16 v[28:31], v[196:199], v[180:183], v[28:31]
    buffer_load_dwordx4 v[152:155], v10, s[16:19], s65 offen offset:0 sc1
    s_waitcnt vmcnt(17)
    v_mfma_f32_16x16x32_bf16 v[32:35], v[200:203], v[176:179], v[32:35]
    v_mfma_f32_16x16x32_bf16 v[36:39], v[200:203], v[180:183], v[36:39]
    buffer_load_dwordx4 v[140:143], v255, s[16:19], s69 offen offset:256 sc1
    s_waitcnt vmcnt(17)
    v_mfma_f32_16x16x32_bf16 v[40:43], v[204:207], v[176:179], v[40:43]
    v_mfma_f32_16x16x32_bf16 v[44:47], v[204:207], v[180:183], v[44:47]
    buffer_load_dwordx4 v[156:159], v10, s[16:19], s65 offen offset:256 sc1
    s_waitcnt vmcnt(17)
    v_mfma_f32_16x16x32_bf16 v[48:51], v[192:195], v[184:187], v[48:51]
    s_waitcnt vmcnt(16)
    v_mfma_f32_16x16x32_bf16 v[52:55], v[192:195], v[188:191], v[52:55]
    buffer_load_dwordx4 v[160:163], v10, s[16:19], s65 offen offset:1024 sc1
    v_mfma_f32_16x16x32_bf16 v[56:59], v[196:199], v[184:187], v[56:59]
    v_mfma_f32_16x16x32_bf16 v[60:63], v[196:199], v[188:191], v[60:63]
    buffer_load_dwordx4 v[164:167], v10, s[16:19], s65 offen offset:1280 sc1
    v_mfma_f32_16x16x32_bf16 v[64:67], v[200:203], v[184:187], v[64:67]
    v_mfma_f32_16x16x32_bf16 v[68:71], v[200:203], v[188:191], v[68:71]
    buffer_load_dwordx4 v[144:147], v254, s[16:19], s69 offen offset:0 sc1
    v_mfma_f32_16x16x32_bf16 v[72:75], v[204:207], v[184:187], v[72:75]
    v_mfma_f32_16x16x32_bf16 v[76:79], v[204:207], v[188:191], v[76:79]
    buffer_load_dwordx4 v[148:151], v254, s[16:19], s69 offen offset:256 sc1
    s_waitcnt vmcnt(19)
    v_mfma_f32_16x16x32_bf16 v[80:83], v[208:211], v[184:187], v[80:83]
    v_mfma_f32_16x16x32_bf16 v[84:87], v[208:211], v[188:191], v[84:87]
    buffer_load_dwordx4 v[168:171], v11, s[16:19], s65 offen offset:0 sc1
    s_waitcnt vmcnt(19)
    v_mfma_f32_16x16x32_bf16 v[88:91], v[212:215], v[184:187], v[88:91]
    v_mfma_f32_16x16x32_bf16 v[92:95], v[212:215], v[188:191], v[92:95]
    buffer_load_dwordx4 v[172:175], v11, s[16:19], s65 offen offset:256 sc1
    s_add_u32 s69, s69, 2048
    s_add_u32 s65, s65, 10240
    s_mul_i32 s58, s57, 40
    s_add_u32 s58, s58, s4
    s_mul_i32 s58, s58, 5120
    s_add_u32 s58, s58, 0x01280000
    s_mul_i32 s59, s4, 5120
    buffer_load_dwordx4 v[204:207], v3, s[16:19], s58 offen offset:0 sc1
    s_add_u32 s58, s58, 20480
    buffer_load_dwordx4 v[208:211], v3, s[16:19], s58 offen offset:0 sc1
    s_add_u32 s58, s58, 20480
    buffer_load_dwordx4 v[212:215], v3, s[16:19], s58 offen offset:0 sc1
    s_add_u32 s58, s58, 20480
    buffer_load_dwordx4 v[216:219], v3, s[16:19], s58 offen offset:0 sc1
    s_add_u32 s58, s58, 20480
    buffer_load_dwordx4 v[220:223], v3, s[16:19], s58 offen offset:0 sc1
    s_add_u32 s58, s58, 20480
    buffer_load_dwordx4 v[224:227], v3, s[16:19], s58 offen offset:0 sc1
    s_add_u32 s58, s58, 20480
    buffer_load_dwordx4 v[228:231], v3, s[16:19], s58 offen offset:0 sc1
    s_add_u32 s58, s58, 20480
    buffer_load_dwordx4 v[232:235], v3, s[16:19], s58 offen offset:0 sc1
    s_add_u32 s58, s58, 20480
    s_add_u32 s58, s58, s59
    buffer_load_dwordx4 v[188:191], v12, s[16:19], s58 offen offset:0 sc1
    buffer_load_dwordx4 v[196:199], v12, s[16:19], s58 offen offset:1024 sc1
    buffer_load_dwordx4 v[236:239], v3, s[16:19], s58 offen offset:0 sc1
    s_add_u32 s58, s58, 5120
    buffer_load_dwordx4 v[192:195], v12, s[16:19], s58 offen offset:0 sc1
    buffer_load_dwordx4 v[200:203], v12, s[16:19], s58 offen offset:1024 sc1
    buffer_load_dwordx4 v[240:243], v3, s[16:19], s58 offen offset:0 sc1
    s_mov_b32 s59, 0
    s_cmp_eq_u32 s4, 1
    s_cselect_b32 s59, 43520, s59
    s_cmp_eq_u32 s4, 2
    s_cselect_b32 s59, 84480, s59
    s_cmp_eq_u32 s4, 3
    s_cselect_b32 s59, 100864, s59
    s_mul_i32 s58, s57, 40
    s_add_u32 s58, s58, s4
    s_mul_i32 s58, s58, 5120
    s_add_u32 s58, s58, 0x01280000
    s_add_u32 m0, s59, 0
    s_nop 0
    buffer_load_dwordx4 v12, s[16:19], s58 offen offset:0 sc1 lds
    buffer_load_dwordx4 v12, s[16:19], s58 offen offset:1024 sc1 lds
    s_add_u32 s58, s58, 20480
    s_add_u32 m0, s59, 2048
    s_nop 0
    buffer_load_dwordx4 v12, s[16:19], s58 offen offset:0 sc1 lds
    buffer_load_dwordx4 v12, s[16:19], s58 offen offset:1024 sc1 lds
    s_add_u32 s58, s58, 20480
    s_add_u32 m0, s59, 4096
    s_nop 0
    buffer_load_dwordx4 v12, s[16:19], s58 offen offset:0 sc1 lds
    buffer_load_dwordx4 v12, s[16:19], s58 offen offset:1024 sc1 lds
    s_add_u32 s58, s58, 20480
    s_add_u32 m0, s59, 6144
    s_nop 0
    buffer_load_dwordx4 v12, s[16:19], s58 offen offset:0 sc1 lds
    buffer_load_dwordx4 v12, s[16:19], s58 offen offset:1024 sc1 lds
    s_add_u32 s58, s58, 20480
    s_add_u32 m0, s59, 8192
    s_nop 0
    buffer_load_dwordx4 v12, s[16:19], s58 offen offset:0 sc1 lds
    buffer_load_dwordx4 v12, s[16:19], s58 offen offset:1024 sc1 lds
    s_add_u32 s58, s58, 20480
    s_add_u32 m0, s59, 10240
    s_nop 0
    buffer_load_dwordx4 v12, s[16:19], s58 offen offset:0 sc1 lds
    buffer_load_dwordx4 v12, s[16:19], s58 offen offset:1024 sc1 lds
    s_add_u32 s58, s58, 20480
    s_add_u32 m0, s59, 12288
    s_nop 0
    buffer_load_dwordx4 v12, s[16:19], s58 offen offset:0 sc1 lds
    buffer_load_dwordx4 v12, s[16:19], s58 offen offset:1024 sc1 lds
    s_add_u32 s58, s58, 20480
    s_add_u32 m0, s59, 14336
    s_nop 0
    buffer_load_dwordx4 v12, s[16:19], s58 offen offset:0 sc1 lds
    buffer_load_dwordx4 v12, s[16:19], s58 offen offset:1024 sc1 lds
    s_add_u32 s58, s58, 20480
    v_add_u32 v8, s59, v13
    s_xor_b32 s62, s56, 0
    s_mul_i32 s62, s62, 40
    s_add_u32 s62, s62, s4
    s_add_u32 s63, s62, s4
    s_lshl_b32 s62, s62, 10
    s_add_u32 s62, s62, 0x01400000
    s_lshl_b32 s63, s63, 10
    s_add_u32 s63, s63, 0x01408000
    s_mov_b32 s64, 100000
    s_barrier
    s_waitcnt vmcnt(0)
    s_barrier
    v_mfma_f32_16x16x32_bf16 v[16:19], v[112:115], v[96:99], v[16:19]
    v_mfma_f32_16x16x32_bf16 v[20:23], v[112:115], v[100:103], v[20:23]
    v_mfma_f32_16x16x32_bf16 v[24:27], v[116:119], v[96:99], v[24:27]
    v_mfma_f32_16x16x32_bf16 v[28:31], v[116:119], v[100:103], v[28:31]
    v_mfma_f32_16x16x32_bf16 v[32:35], v[120:123], v[96:99], v[32:35]
    v_mfma_f32_16x16x32_bf16 v[36:39], v[120:123], v[100:103], v[36:39]
    v_mfma_f32_16x16x32_bf16 v[40:43], v[124:127], v[96:99], v[40:43]
    v_mfma_f32_16x16x32_bf16 v[44:47], v[124:127], v[100:103], v[44:47]
    v_mfma_f32_16x16x32_bf16 v[48:51], v[112:115], v[104:107], v[48:51]
    v_mfma_f32_16x16x32_bf16 v[52:55], v[112:115], v[108:111], v[52:55]
    v_mfma_f32_16x16x32_bf16 v[56:59], v[116:119], v[104:107], v[56:59]
    v_mfma_f32_16x16x32_bf16 v[60:63], v[116:119], v[108:111], v[60:63]
    v_mfma_f32_16x16x32_bf16 v[64:67], v[120:123], v[104:107], v[64:67]
    v_mfma_f32_16x16x32_bf16 v[68:71], v[120:123], v[108:111], v[68:71]
    v_mfma_f32_16x16x32_bf16 v[72:75], v[124:127], v[104:107], v[72:75]
    v_mfma_f32_16x16x32_bf16 v[76:79], v[124:127], v[108:111], v[76:79]
    v_mfma_f32_16x16x32_bf16 v[80:83], v[128:131], v[104:107], v[80:83]
    v_mfma_f32_16x16x32_bf16 v[84:87], v[128:131], v[108:111], v[84:87]
    v_mfma_f32_16x16x32_bf16 v[88:91], v[132:135], v[104:107], v[88:91]
    v_mfma_f32_16x16x32_bf16 v[92:95], v[132:135], v[108:111], v[92:95]
    s_cmp_ge_u32 s4, 2
    s_cbranch_scc1 LB_g13
    v_mfma_f32_16x16x32_bf16 v[16:19], v[152:155], v[136:139], v[16:19]
    v_mfma_f32_16x16x32_bf16 v[20:23], v[152:155], v[140:143], v[20:23]
    v_mfma_f32_16x16x32_bf16 v[24:27], v[156:159], v[136:139], v[24:27]
    v_mfma_f32_16x16x32_bf16 v[28:31], v[156:159], v[140:143], v[28:31]
    v_mfma_f32_16x16x32_bf16 v[32:35], v[160:163], v[136:139], v[32:35]
    v_mfma_f32_16x16x32_bf16 v[36:39], v[160:163], v[140:143], v[36:39]
    v_mfma_f32_16x16x32_bf16 v[40:43], v[164:167], v[136:139], v[40:43]
    v_mfma_f32_16x16x32_bf16 v[44:47], v[164:167], v[140:143], v[44:47]
    v_mfma_f32_16x16x32_bf16 v[48:51], v[152:155], v[144:147], v[48:51]
    v_mfma_f32_16x16x32_bf16 v[52:55], v[152:155], v[148:151], v[52:55]
    v_mfma_f32_16x16x32_bf16 v[56:59], v[156:159], v[144:147], v[56:59]
    v_mfma_f32_16x16x32_bf16 v[60:63], v[156:159], v[148:151], v[60:63]
    v_mfma_f32_16x16x32_bf16 v[64:67], v[160:163], v[144:147], v[64:67]
    v_mfma_f32_16x16x32_bf16 v[68:71], v[160:163], v[148:151], v[68:71]
    v_mfma_f32_16x16x32_bf16 v[72:75], v[164:167], v[144:147], v[72:75]
    v_mfma_f32_16x16x32_bf16 v[76:79], v[164:167], v[148:151], v[76:79]
    v_mfma_f32_16x16x32_bf16 v[80:83], v[168:171], v[144:147], v[80:83]
    v_mfma_f32_16x16x32_bf16 v[84:87], v[168:171], v[148:151], v[84:87]
    v_mfma_f32_16x16x32_bf16 v[88:91], v[172:175], v[144:147], v[88:91]
    v_mfma_f32_16x16x32_bf16 v[92:95], v[172:175], v[148:151], v[92:95]
LB_g13:
    s_nop 7
    v_lshlrev_b32 v2, 7, v15
    s_lshr_b32 s61, s56, 1
    s_lshl_b32 s61, s61, 12
    s_add_u32 s61, s61, 0x01c80000
    ds_write_b128 v0, v[16:19] offset:0
    ds_write_b128 v0, v[20:23] offset:10240
    ds_write_b128 v1, v[24:27] offset:0
    ds_write_b128 v1, v[28:31] offset:10240
    ds_write_b128 v0, v[32:35] offset:128
    ds_write_b128 v0, v[36:39] offset:10368
    ds_write_b128 v1, v[40:43] offset:128
    ds_write_b128 v1, v[44:47] offset:10368
    ds_write_b128 v0, v[48:51] offset:256
    ds_write_b128 v0, v[52:55] offset:10496
    ds_write_b128 v1, v[56:59] offset:256
    ds_write_b128 v1, v[60:63] offset:10496
    ds_write_b128 v0, v[64:67] offset:384
    ds_write_b128 v0, v[68:71] offset:10624
    ds_write_b128 v1, v[72:75] offset:384
    ds_write_b128 v1, v[76:79] offset:10624
    ds_write_b128 v0, v[80:83] offset:512
    ds_write_b128 v0, v[84:87] offset:10752
    ds_write_b128 v1, v[88:91] offset:512
    ds_write_b128 v1, v[92:95] offset:10752
    s_cmp_eq_u32 s4, 0
    s_cbranch_scc0 LB_np0
    buffer_load_dword v116, v2, s[16:19], s61 offen sc1
LB_np0:
    s_waitcnt lgkmcnt(0)
    s_barrier
    ds_read_b128 v[16:19], v250 offset:20480
    ds_read_b128 v[20:23], v250 offset:64000
    ds_read_b128 v[24:27], v251 offset:0
    ds_read_b128 v[28:31], v251 offset:20480
    ds_read_b128 v[32:35], v250 offset:20736
    ds_read_b128 v[36:39], v250 offset:64256
    ds_read_b128 v[40:43], v251 offset:256
    ds_read_b128 v[44:47], v251 offset:20736
    ds_read_b128 v[48:51], v250 offset:20992
    ds_read_b128 v[52:55], v250 offset:64512
    ds_read_b128 v[56:59], v251 offset:512
    ds_read_b128 v[60:63], v251 offset:20992
    s_waitcnt lgkmcnt(10)
    v_pk_add_f32 v[16:17], v[16:17], v[20:21]
    v_pk_add_f32 v[18:19], v[18:19], v[22:23]
    s_waitcnt lgkmcnt(8)
    v_pk_add_f32 v[24:25], v[24:25], v[28:29]
    v_pk_add_f32 v[26:27], v[26:27], v[30:31]
    v_pk_add_f32 v[104:105], v[16:17], v[24:25]
    v_pk_add_f32 v[106:107], v[18:19], v[26:27]
    s_waitcnt lgkmcnt(6)
    v_pk_add_f32 v[32:33], v[32:33], v[36:37]
    v_pk_add_f32 v[34:35], v[34:35], v[38:39]
    s_waitcnt lgkmcnt(4)
    v_pk_add_f32 v[40:41], v[40:41], v[44:45]
    v_pk_add_f32 v[42:43], v[42:43], v[46:47]
    v_pk_add_f32 v[108:109], v[32:33], v[40:41]
    v_pk_add_f32 v[110:111], v[34:35], v[42:43]
    s_waitcnt lgkmcnt(2)
    v_pk_add_f32 v[48:49], v[48:49], v[52:53]
    v_pk_add_f32 v[50:51], v[50:51], v[54:55]
    s_waitcnt lgkmcnt(0)
    v_pk_add_f32 v[56:57], v[56:57], v[60:61]
    v_pk_add_f32 v[58:59], v[58:59], v[62:63]
    v_pk_add_f32 v[112:113], v[48:49], v[56:57]
    v_pk_add_f32 v[114:115], v[50:51], v[58:59]
    s_setprio 1
    s_waitcnt vmcnt(0)
    s_cmp_eq_u32 s4, 0
    s_cbranch_scc0 LB_np1
    s_mov_b32 s60, 100000
LB_p3:
    v_cmp_ne_u32 vcc, s5, v116
    s_nop 0
    s_cmp_eq_u64 vcc, 0
    s_cbranch_scc1 LB_p3_x
    s_sleep 1
    buffer_load_dword v116, v2, s[16:19], s61 offen sc1
    s_sub_u32 s60, s60, 1
    s_waitcnt vmcnt(0)
    s_cbranch_scc0 LB_p3
LB_p3_x:
LB_np1:
    s_barrier
    s_add_u32 s58, s62, 0
    buffer_load_dwordx4 v[64:67], v13, s[16:19], s58 offen sc1
    s_add_u32 s58, s62, 4096
    buffer_load_dwordx4 v[68:71], v13, s[16:19], s58 offen sc1
    s_add_u32 s58, s62, 8192
    buffer_load_dwordx4 v[72:75], v13, s[16:19], s58 offen sc1
    s_add_u32 s58, s62, 12288
    buffer_load_dwordx4 v[76:79], v13, s[16:19], s58 offen sc1
    s_add_u32 s58, s62, 16384
    buffer_load_dwordx4 v[80:83], v13, s[16:19], s58 offen sc1
    s_add_u32 s58, s62, 20480
    buffer_load_dwordx4 v[84:87], v13, s[16:19], s58 offen sc1
    s_add_u32 s58, s62, 24576
    buffer_load_dwordx4 v[88:91], v13, s[16:19], s58 offen sc1
    s_add_u32 s58, s62, 28672
    buffer_load_dwordx4 v[92:95], v13, s[16:19], s58 offen sc1
    buffer_load_dwordx4 v[96:99], v13, s[16:19], s63 offen offset:0 sc1
    buffer_load_dwordx4 v[100:103], v13, s[16:19], s63 offen offset:1024 sc1
    ds_read_b128 v[124:127], v8 offset:0
    ds_read_b128 v[128:131], v8 offset:2048
    ds_read_b128 v[132:135], v8 offset:4096
    ds_read_b128 v[136:139], v8 offset:6144
    ds_read_b128 v[140:143], v8 offset:8192
    ds_read_b128 v[144:147], v8 offset:10240
    ds_read_b128 v[148:151], v8 offset:12288
    ds_read_b128 v[152:155], v8 offset:14336
    ds_read_b128 v[156:159], v8 offset:1024
    ds_read_b128 v[160:163], v8 offset:3072
    ds_read_b128 v[164:167], v8 offset:5120
    ds_read_b128 v[168:171], v8 offset:7168
    ds_read_b128 v[172:175], v8 offset:9216
    ds_read_b128 v[176:179], v8 offset:11264
    ds_read_b128 v[180:183], v8 offset:13312
    ds_read_b128 v[184:187], v8 offset:15360
    v_mul_f32 v118, 0xbfb8aa3b, v104
    v_mul_f32 v119, 0xbfb8aa3b, v105
    v_mul_f32 v120, 0xbfb8aa3b, v106
    v_mul_f32 v121, 0xbfb8aa3b, v107
    v_mul_f32 v122, 0xbfb8aa3b, v108
    v_mul_f32 v123, 0xbfb8aa3b, v109
    v_exp_f32 v118, v118
    v_exp_f32 v119, v119
    v_exp_f32 v120, v120
    v_exp_f32 v121, v121
    v_exp_f32 v122, v122
    v_exp_f32 v123, v123
    v_add_f32 v118, 1.0, v118
    v_add_f32 v119, 1.0, v119
    v_add_f32 v120, 1.0, v120
    v_add_f32 v121, 1.0, v121
    v_add_f32 v122, 1.0, v122
    v_add_f32 v123, 1.0, v123
    v_rcp_f32 v118, v118
    v_rcp_f32 v119, v119
    v_rcp_f32 v120, v120
    v_rcp_f32 v121, v121
    v_rcp_f32 v122, v122
    v_rcp_f32 v123, v123
    v_mul_f32 v104, v104, v118
    v_mul_f32 v105, v105, v119
    v_mul_f32 v106, v106, v120
    v_mul_f32 v107, v107, v121
    v_mul_f32 v108, v108, v122
    v_mul_f32 v109, v109, v123
    v_mul_f32 v118, 0xbfb8aa3b, v110
    v_mul_f32 v119, 0xbfb8aa3b, v111
    v_mul_f32 v120, 0xbfb8aa3b, v112
    v_mul_f32 v121, 0xbfb8aa3b, v113
    v_mul_f32 v122, 0xbfb8aa3b, v114
    v_mul_f32 v123, 0xbfb8aa3b, v115
    v_exp_f32 v118, v118
    v_exp_f32 v119, v119
    v_exp_f32 v120, v120
    v_exp_f32 v121, v121
    v_exp_f32 v122, v122
    v_exp_f32 v123, v123
    v_add_f32 v118, 1.0, v118
    v_add_f32 v119, 1.0, v119
    v_add_f32 v120, 1.0, v120
    v_add_f32 v121, 1.0, v121
    v_add_f32 v122, 1.0, v122
    v_add_f32 v123, 1.0, v123
    v_rcp_f32 v118, v118
    v_rcp_f32 v119, v119
    v_rcp_f32 v120, v120
    v_rcp_f32 v121, v121
    v_rcp_f32 v122, v122
    v_rcp_f32 v123, v123
    v_mul_f32 v110, v110, v118
    v_mul_f32 v111, v111, v119
    v_mul_f32 v112, v112, v120
    v_mul_f32 v113, v113, v121
    v_mul_f32 v114, v114, v122
    v_mul_f32 v115, v115, v123
    s_waitcnt lgkmcnt(0)
    s_branch L_p3b_g
L_p3b:
    s_add_u32 s58, s62, 0
    buffer_load_dwordx4 v[64:67], v13, s[16:19], s58 offen sc1
    s_add_u32 s58, s62, 4096
    buffer_load_dwordx4 v[68:71], v13, s[16:19], s58 offen sc1
    s_add_u32 s58, s62, 8192
    buffer_load_dwordx4 v[72:75], v13, s[16:19], s58 offen sc1
    s_add_u32 s58, s62, 12288
    buffer_load_dwordx4 v[76:79], v13, s[16:19], s58 offen sc1
    s_add_u32 s58, s62, 16384
    buffer_load_dwordx4 v[80:83], v13, s[16:19], s58 offen sc1
    s_add_u32 s58, s62, 20480
    buffer_load_dwordx4 v[84:87], v13, s[16:19], s58 offen sc1
    s_add_u32 s58, s62, 24576
    buffer_load_dwordx4 v[88:91], v13, s[16:19], s58 offen sc1
    s_add_u32 s58, s62, 28672
    buffer_load_dwordx4 v[92:95], v13, s[16:19], s58 offen sc1
    buffer_load_dwordx4 v[96:99], v13, s[16:19], s63 offen offset:0 sc1
    buffer_load_dwordx4 v[100:103], v13, s[16:19], s63 offen offset:1024 sc1
    s_waitcnt vmcnt(0)
L_p3b_g:
    s_waitcnt vmcnt(9)
    v_mfma_f32_32x32x16_bf16 v[16:31], v[124:127], v[64:67], 0
    v_max3_u32 v116, v64, v65, 0
    v_max3_u32 v116, v66, v67, v116
    s_waitcnt vmcnt(8)
    v_mfma_f32_32x32x16_bf16 v[16:31], v[128:131], v[68:71], v[16:31]
    v_max3_u32 v116, v68, v69, v116
    v_max3_u32 v116, v70, v71, v116
    s_waitcnt vmcnt(7)
    v_mfma_f32_32x32x16_bf16 v[16:31], v[132:135], v[72:75], v[16:31]
    v_max3_u32 v116, v72, v73, v116
    v_max3_u32 v116, v74, v75, v116
    s_waitcnt vmcnt(6)
    v_mfma_f32_32x32x16_bf16 v[16:31], v[136:139], v[76:79], v[16:31]
    v_max3_u32 v116, v76, v77, v116
    v_max3_u32 v116, v78, v79, v116
    s_waitcnt vmcnt(5)
    v_mfma_f32_32x32x16_bf16 v[16:31], v[140:143], v[80:83], v[16:31]
    v_max3_u32 v116, v80, v81, v116
    v_max3_u32 v116, v82, v83, v116
    s_waitcnt vmcnt(4)
    v_mfma_f32_32x32x16_bf16 v[16:31], v[144:147], v[84:87], v[16:31]
    v_max3_u32 v116, v84, v85, v116
    v_max3_u32 v116, v86, v87, v116
    s_waitcnt vmcnt(3)
    v_mfma_f32_32x32x16_bf16 v[16:31], v[148:151], v[88:91], v[16:31]
    v_max3_u32 v116, v88, v89, v116
    v_max3_u32 v116, v90, v91, v116
    s_waitcnt vmcnt(2)
    v_mfma_f32_32x32x16_bf16 v[16:31], v[152:155], v[92:95], v[16:31]
    v_max3_u32 v116, v92, v93, v116
    v_max3_u32 v116, v94, v95, v116
    s_waitcnt vmcnt(1)
    v_permlane16_swap_b32 v96, v98
    v_permlane16_swap_b32 v97, v99
    s_nop 1
    v_mfma_f32_32x32x16_bf16 v[16:31], v[188:191], v[96:99], v[16:31]
    v_max3_u32 v116, v96, v97, v116
    v_max3_u32 v116, v98, v99, v116
    s_waitcnt vmcnt(0)
    v_permlane16_swap_b32 v100, v102
    v_permlane16_swap_b32 v101, v103
    s_nop 1
    v_mfma_f32_32x32x16_bf16 v[16:31], v[192:195], v[100:103], v[16:31]
    v_max3_u32 v116, v100, v101, v116
    v_max3_u32 v116, v102, v103, v116
    v_mfma_f32_32x32x16_bf16 v[32:47], v[156:159], v[64:67], 0
    v_cmp_eq_u32 vcc, -1, v116
    s_sub_u32 s64, s64, 1
    s_cselect_b64 vcc, 0, vcc
    s_cmp_lg_u64 vcc, 0
    s_cbranch_scc1 L_p3b
    v_mfma_f32_32x32x16_bf16 v[32:47], v[160:163], v[68:71], v[32:47]
    v_mfma_f32_32x32x16_bf16 v[32:47], v[164:167], v[72:75], v[32:47]
    v_mfma_f32_32x32x16_bf16 v[32:47], v[168:171], v[76:79], v[32:47]
    v_mfma_f32_32x32x16_bf16 v[32:47], v[172:175], v[80:83], v[32:47]
    v_mfma_f32_32x32x16_bf16 v[32:47], v[176:179], v[84:87], v[32:47]
    ds_write_b128 v4, v[16:19] offset:256
    v_mfma_f32_32x32x16_bf16 v[32:47], v[180:183], v[88:91], v[32:47]
    ds_write_b128 v5, v[20:23] offset:256
    v_mfma_f32_32x32x16_bf16 v[32:47], v[184:187], v[92:95], v[32:47]
    ds_write_b128 v6, v[24:27] offset:256
    v_mfma_f32_32x32x16_bf16 v[32:47], v[196:199], v[96:99], v[32:47]
    ds_write_b128 v7, v[28:31] offset:256
    v_mfma_f32_32x32x16_bf16 v[32:47], v[200:203], v[100:103], v[32:47]
    v_mfma_f32_32x32x16_bf16 v[48:63], v[204:207], v[64:67], 0
    v_mfma_f32_32x32x16_bf16 v[48:63], v[208:211], v[68:71], v[48:63]
    v_mfma_f32_32x32x16_bf16 v[48:63], v[212:215], v[72:75], v[48:63]
    v_mfma_f32_32x32x16_bf16 v[48:63], v[216:219], v[76:79], v[48:63]
    v_mfma_f32_32x32x16_bf16 v[48:63], v[220:223], v[80:83], v[48:63]
    v_mfma_f32_32x32x16_bf16 v[48:63], v[224:227], v[84:87], v[48:63]
    s_nop 5
    ds_write_b128 v4, v[32:35] offset:384
    v_mfma_f32_32x32x16_bf16 v[48:63], v[228:231], v[88:91], v[48:63]
    ds_write_b128 v5, v[36:39] offset:384
    v_mfma_f32_32x32x16_bf16 v[48:63], v[232:235], v[92:95], v[48:63]
    ds_write_b128 v6, v[40:43] offset:384
    v_mfma_f32_32x32x16_bf16 v[48:63], v[236:239], v[96:99], v[48:63]
    ds_write_b128 v7, v[44:47] offset:384
    v_mfma_f32_32x32x16_bf16 v[48:63], v[240:243], v[100:103], v[48:63]
    s_nop 11
    ds_write_b128 v4, v[48:51] offset:512
    ds_write_b128 v5, v[52:55] offset:512
    ds_write_b128 v6, v[56:59] offset:512
    ds_write_b128 v7, v[60:63] offset:512
L_p3j:
    v_lshlrev_b32 v64, 16, v244
    v_and_b32 v65, 0xffff0000, v244
    v_lshlrev_b32 v66, 16, v245
    v_and_b32 v67, 0xffff0000, v245
    v_lshlrev_b32 v68, 16, v246
    v_and_b32 v69, 0xffff0000, v246
    v_lshlrev_b32 v70, 16, v247
    v_and_b32 v71, 0xffff0000, v247
    v_lshlrev_b32 v72, 16, v248
    v_and_b32 v73, 0xffff0000, v248
    v_lshlrev_b32 v74, 16, v249
    v_and_b32 v75, 0xffff0000, v249
    s_waitcnt lgkmcnt(0)
    s_barrier
    ds_read_b128 v[16:19], v250 offset:20480
    ds_read_b128 v[20:23], v250 offset:64000
    ds_read_b128 v[24:27], v251 offset:0
    ds_read_b128 v[28:31], v251 offset:20480
    ds_read_b128 v[32:35], v250 offset:20736
    ds_read_b128 v[36:39], v250 offset:64256
    ds_read_b128 v[40:43], v251 offset:256
    ds_read_b128 v[44:47], v251 offset:20736
    ds_read_b128 v[48:51], v250 offset:20992
    ds_read_b128 v[52:55], v250 offset:64512
    ds_read_b128 v[56:59], v251 offset:512
    ds_read_b128 v[60:63], v251 offset:20992
    s_waitcnt lgkmcnt(10)
    v_pk_add_f32 v[16:17], v[16:17], v[20:21]
    v_pk_add_f32 v[18:19], v[18:19], v[22:23]
    s_waitcnt lgkmcnt(8)
    v_pk_add_f32 v[24:25], v[24:25], v[28:29]
    v_pk_add_f32 v[26:27], v[26:27], v[30:31]
    v_pk_add_f32 v[16:17], v[16:17], v[24:25]
    v_pk_add_f32 v[18:19], v[18:19], v[26:27]
    v_pk_fma_f32 v[16:17], v[16:17], v[104:105], v[64:65]
    v_pk_fma_f32 v[18:19], v[18:19], v[106:107], v[66:67]
    v_cvt_pk_bf16_f32 v80, v16, v17
    v_cvt_pk_bf16_f32 v81, v18, v19
    buffer_store_dwordx2 v[80:81], v252, s[32:35], s48 offen sc1
    s_waitcnt lgkmcnt(6)
    v_pk_add_f32 v[32:33], v[32:33], v[36:37]
    v_pk_add_f32 v[34:35], v[34:35], v[38:39]
    s_waitcnt lgkmcnt(4)
    v_pk_add_f32 v[40:41], v[40:41], v[44:45]
    v_pk_add_f32 v[42:43], v[42:43], v[46:47]
    v_pk_add_f32 v[32:33], v[32:33], v[40:41]
    v_pk_add_f32 v[34:35], v[34:35], v[42:43]
    v_pk_fma_f32 v[32:33], v[32:33], v[108:109], v[68:69]
    v_pk_fma_f32 v[34:35], v[34:35], v[110:111], v[70:71]
    v_cvt_pk_bf16_f32 v82, v32, v33
    v_cvt_pk_bf16_f32 v83, v34, v35
    buffer_store_dwordx2 v[82:83], v252, s[32:35], s49 offen sc1
    s_waitcnt lgkmcnt(2)
    v_pk_add_f32 v[48:49], v[48:49], v[52:53]
    v_pk_add_f32 v[50:51], v[50:51], v[54:55]
    s_waitcnt lgkmcnt(0)
    v_pk_add_f32 v[56:57], v[56:57], v[60:61]
    v_pk_add_f32 v[58:59], v[58:59], v[62:63]
    v_pk_add_f32 v[48:49], v[48:49], v[56:57]
    v_pk_add_f32 v[50:51], v[50:51], v[58:59]
    v_pk_fma_f32 v[48:49], v[48:49], v[112:113], v[72:73]
    v_pk_fma_f32 v[50:51], v[50:51], v[114:115], v[74:75]
    v_cvt_pk_bf16_f32 v84, v48, v49
    v_cvt_pk_bf16_f32 v85, v50, v51
    buffer_store_dwordx2 v[84:85], v253, s[32:35], s42 offen sc1
L_end:
    s_endpgm
LA:
    v_lshlrev_b32 v13, 4, v0
    s_lshl_b32 s52, s4, 12
    s_add_u32 s52, s52, 65536
    s_mov_b32 s15, 0x00020000
    s_load_dwordx2 s[16:17], s[0:1], 80
    s_load_dwordx2 s[20:21], s[0:1], 40
    s_load_dwordx2 s[40:41], s[0:1], 16
    s_load_dwordx2 s[38:39], s[0:1], 48
    s_load_dwordx2 s[28:29], s[0:1], 56
    s_load_dwordx2 s[32:33], s[0:1], 64
    v_lshrrev_b32 v14, 5, v0
    v_and_b32 v15, 31, v0
    s_lshr_b32 s61, s2, 3
    s_and_b32 s58, s2, 7
    s_lshr_b32 s59, s2, 5
    s_lshl3_add_u32 s56, s58, s59
    s_lshr_b32 s60, s2, 6
    s_lshl2_add_u32 s54, s58, s60
    s_and_b32 s55, s61, 7
    s_sub_u32 s53, s61, 20
    s_lshl_b32 s47, s7, 1
    s_add_u32 s58, s7, 9
    s_cmp_lt_u32 s7, 9
    s_cselect_b32 s47, s47, s58
    s_cselect_b32 s45, 4, 3
    s_cmp_eq_u32 s7, 15
    s_cselect_b32 s47, 26, s47
    s_lshr_b32 s58, s2, 5
    s_add_u32 s58, s58, s57
    s_add_u32 s97, s58, 1
    s_and_b32 s97, s97, 3
    s_add_u32 s97, s97, 1
    s_add_u32 s98, s58, 2
    s_and_b32 s98, s98, 3
    s_add_u32 s98, s98, 1
    s_add_u32 s99, s58, 3
    s_and_b32 s99, s99, 3
    s_add_u32 s99, s99, 1
    s_add_u32 s100, s58, 4
    s_and_b32 s100, s100, 3
    s_add_u32 s100, s100, 1
    s_mov_b32 s18, 0x02000000
    s_mov_b32 s19, 0x00020000
    s_mov_b32 s22, 0x00000000
    s_mov_b32 s23, 0x00020000
    s_mov_b32 s30, 0x00000500
    s_mov_b32 s31, 0x00020000
    s_mov_b32 s34, 0x00280000
    s_mov_b32 s35, 0x00020000
    s_waitcnt lgkmcnt(0)
    s_add_u32 s68, s16, 0x01cf0000
    s_addc_u32 s69, s17, 0
    s_load_dword s5, s[68:69], 0
    v_bfe_u32 v40, v0, 2, 2
    v_lshl_add_u32 v41, v14, 3, v40
    v_lshlrev_b32 v41, 7, v41
    v_lshrrev_b32 v40, 1, v40
    v_lshl_add_u32 v41, v40, 6, v41
    v_bfe_u32 v40, v0, 4, 1
    v_lshl_add_u32 v41, v40, 5, v41
    v_and_b32 v40, 3, v0
    v_lshl_add_u32 v40, v40, 3, v41
    s_mov_b32 s26, 0xffffc000
    s_add_u32 s27, s52, 16384
    v_mov_b32 v8, 0
    v_mov_b32 v4, 0
    v_mov_b32 v5, 0
    v_mov_b32 v6, 0
    v_mov_b32 v7, 0
    v_add_u32 v2, s27, v40
    v_xor_b32 v3, 64, v2
    v_and_b32 v40, 15, v0
    v_xor_b32 v40, v40, v14
    v_lshlrev_b32 v40, 4, v40
    v_lshl_add_u32 v40, v15, 8, v40
    s_mul_i32 s58, s4, 8256
    v_xor_b32 v9, s58, v40
    v_mov_b32 v10, 0xbeeff558
    v_mov_b32 v41, 0x3f803f80
    v_and_b32 v40, 14, v0
    v_cmp_eq_u32 vcc, 0, v40
    s_nop 1
    v_cndmask_b32 v16, 0, v41, vcc
    v_mov_b32 v17, v16
    v_cmp_eq_u32 vcc, 4, v40
    s_nop 1
    v_cndmask_b32 v18, 0, v41, vcc
    v_mov_b32 v19, v18
    v_and_b32 v40, 1, v0
    v_mul_u32_u24 v40, 0xaaaa, v40
    v_add_u32 v11, 0x4444, v40
    v_mov_b32 v20, 0
    v_mov_b32 v21, 0
    v_mov_b32 v22, 0
    v_mov_b32 v23, 0
    v_mov_b32 v24, 0
    v_mov_b32 v25, 0
    v_mov_b32 v26, 0
    v_mov_b32 v27, 0
    s_lshl_b32 s58, s6, 2
    s_add_u32 s58, s58, s4
    s_lshr_b32 s59, s58, 1
    s_mul_i32 s48, s59, 2560
    s_and_b32 s59, s58, 1
    s_lshl_b32 s59, s59, 8
    s_add_u32 s48, s48, s59
    s_mul_i32 s49, s58, 40960
    s_add_u32 s49, s49, 0x004fb000
    s_mul_i32 s50, s58, 110592
    s_add_u32 s50, s50, 0x00800000
    s_lshl_b32 s46, s7, 2
    s_cmp_eq_u32 s7, 15
    s_cselect_b32 s46, 48, s46
    s_lshl_b32 s64, s7, 8
    s_cmp_eq_u32 s7, 15
    s_cselect_b32 s64, 3072, s64
    s_cselect_b32 s12, s36, s24
    s_cselect_b32 s13, s37, s25
    s_cselect_b32 s63, 0, 384
    s_add_u32 s63, s63, 3456
    s_mul_i32 s14, s63, 640
    s_add_u32 s64, s64, 128
    s_lshl_b32 s43, s63, 7
    s_mul_i32 s42, s4, s63
    s_lshl_b32 s42, s42, 5
    s_add_u32 s42, s42, s64
    v_lshrrev_b32 v29, 7, v13
    v_mul_u32_u24 v28, s63, v29
    v_lshrrev_b32 v29, 2, v13
    v_xor_b32 v29, v29, v13
    v_and_b32 v29, 0x40, v29
    v_and_b32 v30, 0x30, v13
    v_add3_u32 v28, v28, v29, v30
    s_lshl_b32 s63, s63, 3
    s_sub_u32 s63, s63, 1024
    v_add_u32 v29, s63, v28
    v_add_u32 v30, s63, v29
    v_add_u32 v31, s63, v30
    s_waitcnt lgkmcnt(0)
    s_add_u32 s5, s5, 1
    s_setprio 2
    s_sub_u32 s58, s7, 10
    s_cmp_lt_u32 s58, 5
    s_cbranch_scc0 LA_n
    v_lshlrev_b32 v12, 1, v15
    v_xor_b32 v0, 1, v14
    v_add_u32 v0, s4, v0
    v_lshl_add_u32 v12, v0, 20, v12
    s_cmp_eq_u32 s7, 15
    s_cselect_b32 s22, 3456, 0
    s_movk_i32 s58, 3072
    buffer_load_short_d16_hi v0, v12, s[20:23], s58 offen offset:0
    buffer_load_short_d16_hi v1, v12, s[20:23], s58 offen offset:64
    s_barrier
    v_add_u32 v12, 49152, v9
    ds_read_b128 v[96:99], v12
    ds_read_b64_tr_b16 v[32:33], v2 offset:0
    ds_read_b64_tr_b16 v[34:35], v2 offset:512
    v_xor_b32 v12, 32, v12
    ds_read_b128 v[100:103], v12
    ds_read_b64_tr_b16 v[36:37], v2 offset:2048
    ds_read_b64_tr_b16 v[38:39], v2 offset:2560
    ds_read_b64_tr_b16 v[40:41], v3 offset:0
    ds_read_b64_tr_b16 v[42:43], v3 offset:512
    ds_read_b64_tr_b16 v[44:45], v3 offset:2048
    ds_read_b64_tr_b16 v[46:47], v3 offset:2560
    v_xor_b32 v12, 96, v12
    ds_read_b128 v[104:107], v12
    v_xor_b32 v12, 32, v12
    ds_read_b128 v[108:111], v12
    v_xor_b32 v12, 224, v12
    ds_read_b128 v[112:115], v12
    v_xor_b32 v12, 32, v12
    ds_read_b128 v[116:119], v12
    v_xor_b32 v12, 96, v12
    ds_read_b128 v[120:123], v12
    v_xor_b32 v12, 32, v12
    ds_read_b128 v[124:127], v12
    s_waitcnt lgkmcnt(10)
    v_mfma_f32_32x32x16_bf16 v[64:79], v[96:99], v[32:35], 0
    v_xor_b32 v2, 0x00001000, v2
    ds_read_b64_tr_b16 v[48:49], v2 offset:0
    ds_read_b64_tr_b16 v[50:51], v2 offset:512
    ds_read_b64_tr_b16 v[52:53], v2 offset:2048
    ds_read_b64_tr_b16 v[54:55], v2 offset:2560
    v_xor_b32 v3, 0x00001000, v3
    ds_read_b64_tr_b16 v[56:57], v3 offset:0
    ds_read_b64_tr_b16 v[58:59], v3 offset:512
    v_mfma_f32_32x32x16_bf16 v[64:79], v[100:103], v[36:39], v[64:79]
    v_smfmac_f32_16x16x64_bf16 v[20:23], v[16:19], v[32:39], v11
    ds_read_b64_tr_b16 v[60:61], v3 offset:2048
    ds_read_b64_tr_b16 v[62:63], v3 offset:2560
    s_waitcnt lgkmcnt(14)
    v_mfma_f32_32x32x16_bf16 v[80:95], v[96:99], v[40:43], 0
    v_xor_b32 v2, 0x00003000, v2
    ds_read_b64_tr_b16 v[32:33], v2 offset:0
    ds_read_b64_tr_b16 v[34:35], v2 offset:512
    v_mfma_f32_32x32x16_bf16 v[80:95], v[100:103], v[44:47], v[80:95]
    v_smfmac_f32_16x16x64_bf16 v[24:27], v[16:19], v[40:47], v11
    ds_read_b64_tr_b16 v[36:37], v2 offset:2048
    ds_read_b64_tr_b16 v[38:39], v2 offset:2560
    v_dot2c_f32_bf16 v8, v96, v96
    v_dot2c_f32_bf16 v8, v97, v97
    v_dot2c_f32_bf16 v8, v98, v98
    v_dot2c_f32_bf16 v8, v99, v99
    v_dot2c_f32_bf16 v8, v100, v100
    v_dot2c_f32_bf16 v8, v101, v101
    v_dot2c_f32_bf16 v8, v102, v102
    v_dot2c_f32_bf16 v8, v103, v103
    s_waitcnt lgkmcnt(15)
    v_dot2c_f32_bf16 v8, v104, v104
    v_dot2c_f32_bf16 v8, v105, v105
    v_dot2c_f32_bf16 v8, v106, v106
    v_dot2c_f32_bf16 v8, v107, v107
    v_dot2c_f32_bf16 v8, v108, v108
    v_dot2c_f32_bf16 v8, v109, v109
    v_dot2c_f32_bf16 v8, v110, v110
    v_dot2c_f32_bf16 v8, v111, v111
    v_dot2c_f32_bf16 v8, v112, v112
    v_dot2c_f32_bf16 v8, v113, v113
    v_dot2c_f32_bf16 v8, v114, v114
    v_dot2c_f32_bf16 v8, v115, v115
    s_waitcnt lgkmcnt(14)
    v_dot2c_f32_bf16 v8, v116, v116
    v_dot2c_f32_bf16 v8, v117, v117
    v_dot2c_f32_bf16 v8, v118, v118
    v_dot2c_f32_bf16 v8, v119, v119
    s_waitcnt lgkmcnt(13)
    v_dot2c_f32_bf16 v8, v120, v120
    v_dot2c_f32_bf16 v8, v121, v121
    v_dot2c_f32_bf16 v8, v122, v122
    v_dot2c_f32_bf16 v8, v123, v123
    s_waitcnt lgkmcnt(12)
    v_dot2c_f32_bf16 v8, v124, v124
    v_dot2c_f32_bf16 v8, v125, v125
    v_dot2c_f32_bf16 v8, v126, v126
    v_dot2c_f32_bf16 v8, v127, v127
    s_waitcnt lgkmcnt(8)
    v_mfma_f32_32x32x16_bf16 v[64:79], v[104:107], v[48:51], v[64:79]
    v_xor_b32 v3, 0x00003000, v3
    ds_read_b64_tr_b16 v[40:41], v3 offset:0
    ds_read_b64_tr_b16 v[42:43], v3 offset:512
    v_mfma_f32_32x32x16_bf16 v[64:79], v[108:111], v[52:55], v[64:79]
    ds_read_b64_tr_b16 v[44:45], v3 offset:2048
    ds_read_b64_tr_b16 v[46:47], v3 offset:2560
    v_smfmac_f32_16x16x64_bf16 v[4:7], v[16:19], v[96:103], v11
    s_waitcnt lgkmcnt(8)
    v_mfma_f32_32x32x16_bf16 v[80:95], v[104:107], v[56:59], v[80:95]
    v_xor_b32 v2, 0x00001000, v2
    ds_read_b64_tr_b16 v[48:49], v2 offset:0
    ds_read_b64_tr_b16 v[50:51], v2 offset:512
    v_smfmac_f32_16x16x64_bf16 v[4:7], v[16:19], v[104:111], v11
    v_mfma_f32_32x32x16_bf16 v[80:95], v[108:111], v[60:63], v[80:95]
    ds_read_b64_tr_b16 v[52:53], v2 offset:2048
    ds_read_b64_tr_b16 v[54:55], v2 offset:2560
    v_smfmac_f32_16x16x64_bf16 v[4:7], v[16:19], v[112:119], v11
    s_waitcnt lgkmcnt(8)
    v_mfma_f32_32x32x16_bf16 v[64:79], v[112:115], v[32:35], v[64:79]
    v_xor_b32 v3, 0x00001000, v3
    ds_read_b64_tr_b16 v[56:57], v3 offset:0
    ds_read_b64_tr_b16 v[58:59], v3 offset:512
    v_smfmac_f32_16x16x64_bf16 v[4:7], v[16:19], v[120:127], v11
    v_mfma_f32_32x32x16_bf16 v[64:79], v[116:119], v[36:39], v[64:79]
    ds_read_b64_tr_b16 v[60:61], v3 offset:2048
    ds_read_b64_tr_b16 v[62:63], v3 offset:2560
    s_waitcnt lgkmcnt(8)
    v_mfma_f32_32x32x16_bf16 v[80:95], v[112:115], v[40:43], v[80:95]
    v_mfma_f32_32x32x16_bf16 v[80:95], v[116:119], v[44:47], v[80:95]
    s_waitcnt lgkmcnt(0)
    s_barrier
    v_mfma_f32_32x32x16_bf16 v[64:79], v[120:123], v[48:51], v[64:79]
    v_xor_b32 v2, 0x00003000, v2
    ds_read_b64_tr_b16 v[32:33], v2 offset:16384
    ds_read_b64_tr_b16 v[34:35], v2 offset:16896
    v_add_u32 v12, 114688, v9
    ds_read_b128 v[128:131], v12
    v_xor_b32 v12, 32, v12
    ds_read_b128 v[132:135], v12
    v_mfma_f32_32x32x16_bf16 v[64:79], v[124:127], v[52:55], v[64:79]
    ds_read_b64_tr_b16 v[36:37], v2 offset:18432
    ds_read_b64_tr_b16 v[38:39], v2 offset:18944
    v_xor_b32 v12, 96, v12
    ds_read_b128 v[136:139], v12
    v_xor_b32 v12, 32, v12
    ds_read_b128 v[140:143], v12
    v_mfma_f32_32x32x16_bf16 v[80:95], v[120:123], v[56:59], v[80:95]
    v_xor_b32 v3, 0x00003000, v3
    ds_read_b64_tr_b16 v[40:41], v3 offset:16384
    ds_read_b64_tr_b16 v[42:43], v3 offset:16896
    v_xor_b32 v12, 224, v12
    ds_read_b128 v[144:147], v12
    v_xor_b32 v12, 32, v12
    ds_read_b128 v[148:151], v12
    v_mfma_f32_32x32x16_bf16 v[80:95], v[124:127], v[60:63], v[80:95]
    ds_read_b64_tr_b16 v[44:45], v3 offset:18432
    ds_read_b64_tr_b16 v[46:47], v3 offset:18944
    v_xor_b32 v12, 96, v12
    ds_read_b128 v[152:155], v12
    v_xor_b32 v12, 32, v12
    ds_read_b128 v[156:159], v12
    s_waitcnt lgkmcnt(13)
    v_dot2c_f32_bf16 v8, v128, v128
    v_dot2c_f32_bf16 v8, v129, v129
    v_dot2c_f32_bf16 v8, v130, v130
    v_dot2c_f32_bf16 v8, v131, v131
    s_waitcnt lgkmcnt(12)
    v_dot2c_f32_bf16 v8, v132, v132
    v_dot2c_f32_bf16 v8, v133, v133
    v_dot2c_f32_bf16 v8, v134, v134
    v_dot2c_f32_bf16 v8, v135, v135
    s_waitcnt lgkmcnt(9)
    v_dot2c_f32_bf16 v8, v136, v136
    v_dot2c_f32_bf16 v8, v137, v137
    v_dot2c_f32_bf16 v8, v138, v138
    v_dot2c_f32_bf16 v8, v139, v139
    s_waitcnt lgkmcnt(8)
    v_dot2c_f32_bf16 v8, v140, v140
    v_dot2c_f32_bf16 v8, v141, v141
    v_dot2c_f32_bf16 v8, v142, v142
    v_dot2c_f32_bf16 v8, v143, v143
    s_waitcnt lgkmcnt(5)
    v_dot2c_f32_bf16 v8, v144, v144
    v_dot2c_f32_bf16 v8, v145, v145
    v_dot2c_f32_bf16 v8, v146, v146
    v_dot2c_f32_bf16 v8, v147, v147
    s_waitcnt lgkmcnt(4)
    v_dot2c_f32_bf16 v8, v148, v148
    v_dot2c_f32_bf16 v8, v149, v149
    v_dot2c_f32_bf16 v8, v150, v150
    v_dot2c_f32_bf16 v8, v151, v151
    s_waitcnt lgkmcnt(1)
    v_dot2c_f32_bf16 v8, v152, v152
    v_dot2c_f32_bf16 v8, v153, v153
    v_dot2c_f32_bf16 v8, v154, v154
    v_dot2c_f32_bf16 v8, v155, v155
    s_waitcnt lgkmcnt(0)
    v_dot2c_f32_bf16 v8, v156, v156
    v_dot2c_f32_bf16 v8, v157, v157
    v_dot2c_f32_bf16 v8, v158, v158
    v_dot2c_f32_bf16 v8, v159, v159
    v_mfma_f32_32x32x16_bf16 v[64:79], v[128:131], v[32:35], v[64:79]
    v_xor_b32 v2, 0x00001000, v2
    ds_read_b64_tr_b16 v[48:49], v2 offset:16384
    ds_read_b64_tr_b16 v[50:51], v2 offset:16896
    ds_read_b64_tr_b16 v[52:53], v2 offset:18432
    ds_read_b64_tr_b16 v[54:55], v2 offset:18944
    v_xor_b32 v3, 0x00001000, v3
    ds_read_b64_tr_b16 v[56:57], v3 offset:16384
    ds_read_b64_tr_b16 v[58:59], v3 offset:16896
    v_mfma_f32_32x32x16_bf16 v[64:79], v[132:135], v[36:39], v[64:79]
    v_smfmac_f32_16x16x64_bf16 v[20:23], v[16:19], v[32:39], v11
    ds_read_b64_tr_b16 v[60:61], v3 offset:18432
    ds_read_b64_tr_b16 v[62:63], v3 offset:18944
    v_mfma_f32_32x32x16_bf16 v[80:95], v[128:131], v[40:43], v[80:95]
    v_xor_b32 v2, 0x00003000, v2
    ds_read_b64_tr_b16 v[32:33], v2 offset:16384
    ds_read_b64_tr_b16 v[34:35], v2 offset:16896
    v_mfma_f32_32x32x16_bf16 v[80:95], v[132:135], v[44:47], v[80:95]
    v_smfmac_f32_16x16x64_bf16 v[24:27], v[16:19], v[40:47], v11
    ds_read_b64_tr_b16 v[36:37], v2 offset:18432
    ds_read_b64_tr_b16 v[38:39], v2 offset:18944
    s_waitcnt lgkmcnt(8)
    v_mfma_f32_32x32x16_bf16 v[64:79], v[136:139], v[48:51], v[64:79]
    v_xor_b32 v3, 0x00003000, v3
    ds_read_b64_tr_b16 v[40:41], v3 offset:16384
    ds_read_b64_tr_b16 v[42:43], v3 offset:16896
    v_mfma_f32_32x32x16_bf16 v[64:79], v[140:143], v[52:55], v[64:79]
    ds_read_b64_tr_b16 v[44:45], v3 offset:18432
    ds_read_b64_tr_b16 v[46:47], v3 offset:18944
    v_smfmac_f32_16x16x64_bf16 v[4:7], v[16:19], v[128:135], v11
    s_waitcnt lgkmcnt(8)
    v_mfma_f32_32x32x16_bf16 v[80:95], v[136:139], v[56:59], v[80:95]
    v_xor_b32 v2, 0x00001000, v2
    ds_read_b64_tr_b16 v[48:49], v2 offset:16384
    ds_read_b64_tr_b16 v[50:51], v2 offset:16896
    v_smfmac_f32_16x16x64_bf16 v[4:7], v[16:19], v[136:143], v11
    v_mfma_f32_32x32x16_bf16 v[80:95], v[140:143], v[60:63], v[80:95]
    ds_read_b64_tr_b16 v[52:53], v2 offset:18432
    ds_read_b64_tr_b16 v[54:55], v2 offset:18944
    v_smfmac_f32_16x16x64_bf16 v[4:7], v[16:19], v[144:151], v11
    s_waitcnt lgkmcnt(8)
    v_mfma_f32_32x32x16_bf16 v[64:79], v[144:147], v[32:35], v[64:79]
    v_xor_b32 v3, 0x00001000, v3
    ds_read_b64_tr_b16 v[56:57], v3 offset:16384
    ds_read_b64_tr_b16 v[58:59], v3 offset:16896
    v_smfmac_f32_16x16x64_bf16 v[4:7], v[16:19], v[152:159], v11
    v_mfma_f32_32x32x16_bf16 v[64:79], v[148:151], v[36:39], v[64:79]
    ds_read_b64_tr_b16 v[60:61], v3 offset:18432
    ds_read_b64_tr_b16 v[62:63], v3 offset:18944
    s_waitcnt lgkmcnt(8)
    v_mfma_f32_32x32x16_bf16 v[80:95], v[144:147], v[40:43], v[80:95]
    v_mfma_f32_32x32x16_bf16 v[80:95], v[148:151], v[44:47], v[80:95]
    s_waitcnt lgkmcnt(0)
    s_barrier
    v_mfma_f32_32x32x16_bf16 v[64:79], v[152:155], v[48:51], v[64:79]
    v_xor_b32 v2, 0x00003000, v2
    v_add_u32 v2, 0xffff4000, v2
    ds_read_b64_tr_b16 v[32:33], v2 offset:0
    ds_read_b64_tr_b16 v[34:35], v2 offset:512
    v_add_u32 v12, 0, v9
    ds_read_b128 v[160:163], v12
    v_xor_b32 v12, 32, v12
    ds_read_b128 v[164:167], v12
    v_mfma_f32_32x32x16_bf16 v[64:79], v[156:159], v[52:55], v[64:79]
    ds_read_b64_tr_b16 v[36:37], v2 offset:2048
    ds_read_b64_tr_b16 v[38:39], v2 offset:2560
    v_xor_b32 v12, 96, v12
    ds_read_b128 v[168:171], v12
    v_xor_b32 v12, 32, v12
    ds_read_b128 v[172:175], v12
    v_mfma_f32_32x32x16_bf16 v[80:95], v[152:155], v[56:59], v[80:95]
    v_xor_b32 v3, 0x00003000, v3
    v_add_u32 v3, 0xffff4000, v3
    ds_read_b64_tr_b16 v[40:41], v3 offset:0
    ds_read_b64_tr_b16 v[42:43], v3 offset:512
    v_xor_b32 v12, 224, v12
    ds_read_b128 v[176:179], v12
    v_xor_b32 v12, 32, v12
    ds_read_b128 v[180:183], v12
    v_mfma_f32_32x32x16_bf16 v[80:95], v[156:159], v[60:63], v[80:95]
    ds_read_b64_tr_b16 v[44:45], v3 offset:2048
    ds_read_b64_tr_b16 v[46:47], v3 offset:2560
    v_xor_b32 v12, 96, v12
    ds_read_b128 v[184:187], v12
    v_xor_b32 v12, 32, v12
    ds_read_b128 v[188:191], v12
    s_waitcnt lgkmcnt(13)
    v_dot2c_f32_bf16 v8, v160, v160
    v_dot2c_f32_bf16 v8, v161, v161
    v_dot2c_f32_bf16 v8, v162, v162
    v_dot2c_f32_bf16 v8, v163, v163
    s_waitcnt lgkmcnt(12)
    v_dot2c_f32_bf16 v8, v164, v164
    v_dot2c_f32_bf16 v8, v165, v165
    v_dot2c_f32_bf16 v8, v166, v166
    v_dot2c_f32_bf16 v8, v167, v167
    s_waitcnt lgkmcnt(9)
    v_dot2c_f32_bf16 v8, v168, v168
    v_dot2c_f32_bf16 v8, v169, v169
    v_dot2c_f32_bf16 v8, v170, v170
    v_dot2c_f32_bf16 v8, v171, v171
    s_waitcnt lgkmcnt(8)
    v_dot2c_f32_bf16 v8, v172, v172
    v_dot2c_f32_bf16 v8, v173, v173
    v_dot2c_f32_bf16 v8, v174, v174
    v_dot2c_f32_bf16 v8, v175, v175
    s_waitcnt lgkmcnt(5)
    v_dot2c_f32_bf16 v8, v176, v176
    v_dot2c_f32_bf16 v8, v177, v177
    v_dot2c_f32_bf16 v8, v178, v178
    v_dot2c_f32_bf16 v8, v179, v179
    s_waitcnt lgkmcnt(4)
    v_dot2c_f32_bf16 v8, v180, v180
    v_dot2c_f32_bf16 v8, v181, v181
    v_dot2c_f32_bf16 v8, v182, v182
    v_dot2c_f32_bf16 v8, v183, v183
    s_waitcnt lgkmcnt(1)
    v_dot2c_f32_bf16 v8, v184, v184
    v_dot2c_f32_bf16 v8, v185, v185
    v_dot2c_f32_bf16 v8, v186, v186
    v_dot2c_f32_bf16 v8, v187, v187
    s_waitcnt lgkmcnt(0)
    v_dot2c_f32_bf16 v8, v188, v188
    v_dot2c_f32_bf16 v8, v189, v189
    v_dot2c_f32_bf16 v8, v190, v190
    v_dot2c_f32_bf16 v8, v191, v191
    v_mfma_f32_32x32x16_bf16 v[64:79], v[160:163], v[32:35], v[64:79]
    v_xor_b32 v2, 0x00001000, v2
    ds_read_b64_tr_b16 v[48:49], v2 offset:0
    ds_read_b64_tr_b16 v[50:51], v2 offset:512
    ds_read_b64_tr_b16 v[52:53], v2 offset:2048
    ds_read_b64_tr_b16 v[54:55], v2 offset:2560
    v_xor_b32 v3, 0x00001000, v3
    ds_read_b64_tr_b16 v[56:57], v3 offset:0
    ds_read_b64_tr_b16 v[58:59], v3 offset:512
    v_mfma_f32_32x32x16_bf16 v[64:79], v[164:167], v[36:39], v[64:79]
    v_smfmac_f32_16x16x64_bf16 v[20:23], v[16:19], v[32:39], v11
    ds_read_b64_tr_b16 v[60:61], v3 offset:2048
    ds_read_b64_tr_b16 v[62:63], v3 offset:2560
    v_mfma_f32_32x32x16_bf16 v[80:95], v[160:163], v[40:43], v[80:95]
    v_xor_b32 v2, 0x00003000, v2
    ds_read_b64_tr_b16 v[32:33], v2 offset:0
    ds_read_b64_tr_b16 v[34:35], v2 offset:512
    v_mfma_f32_32x32x16_bf16 v[80:95], v[164:167], v[44:47], v[80:95]
    v_smfmac_f32_16x16x64_bf16 v[24:27], v[16:19], v[40:47], v11
    ds_read_b64_tr_b16 v[36:37], v2 offset:2048
    ds_read_b64_tr_b16 v[38:39], v2 offset:2560
    s_waitcnt lgkmcnt(8)
    v_mfma_f32_32x32x16_bf16 v[64:79], v[168:171], v[48:51], v[64:79]
    v_xor_b32 v3, 0x00003000, v3
    ds_read_b64_tr_b16 v[40:41], v3 offset:0
    ds_read_b64_tr_b16 v[42:43], v3 offset:512
    v_mfma_f32_32x32x16_bf16 v[64:79], v[172:175], v[52:55], v[64:79]
    ds_read_b64_tr_b16 v[44:45], v3 offset:2048
    ds_read_b64_tr_b16 v[46:47], v3 offset:2560
    v_smfmac_f32_16x16x64_bf16 v[4:7], v[16:19], v[160:167], v11
    s_waitcnt lgkmcnt(8)
    v_mfma_f32_32x32x16_bf16 v[80:95], v[168:171], v[56:59], v[80:95]
    v_xor_b32 v2, 0x00001000, v2
    ds_read_b64_tr_b16 v[48:49], v2 offset:0
    ds_read_b64_tr_b16 v[50:51], v2 offset:512
    v_smfmac_f32_16x16x64_bf16 v[4:7], v[16:19], v[168:175], v11
    v_mfma_f32_32x32x16_bf16 v[80:95], v[172:175], v[60:63], v[80:95]
    ds_read_b64_tr_b16 v[52:53], v2 offset:2048
    ds_read_b64_tr_b16 v[54:55], v2 offset:2560
    v_smfmac_f32_16x16x64_bf16 v[4:7], v[16:19], v[176:183], v11
    s_waitcnt lgkmcnt(8)
    v_mfma_f32_32x32x16_bf16 v[64:79], v[176:179], v[32:35], v[64:79]
    v_xor_b32 v3, 0x00001000, v3
    ds_read_b64_tr_b16 v[56:57], v3 offset:0
    ds_read_b64_tr_b16 v[58:59], v3 offset:512
    v_smfmac_f32_16x16x64_bf16 v[4:7], v[16:19], v[184:191], v11
    v_mfma_f32_32x32x16_bf16 v[64:79], v[180:183], v[36:39], v[64:79]
    ds_read_b64_tr_b16 v[60:61], v3 offset:2048
    ds_read_b64_tr_b16 v[62:63], v3 offset:2560
    s_waitcnt lgkmcnt(8)
    v_mfma_f32_32x32x16_bf16 v[80:95], v[176:179], v[40:43], v[80:95]
    v_mfma_f32_32x32x16_bf16 v[80:95], v[180:183], v[44:47], v[80:95]
    s_waitcnt lgkmcnt(0)
    s_barrier
    v_mfma_f32_32x32x16_bf16 v[64:79], v[184:187], v[48:51], v[64:79]
    v_xor_b32 v2, 0x00003000, v2
    v_add_u32 v2, 0x0000c000, v2
    ds_read_b64_tr_b16 v[32:33], v2 offset:0
    ds_read_b64_tr_b16 v[34:35], v2 offset:512
    v_add_u32 v12, 49152, v9
    ds_read_b128 v[192:195], v12
    v_xor_b32 v12, 32, v12
    ds_read_b128 v[196:199], v12
    v_mfma_f32_32x32x16_bf16 v[64:79], v[188:191], v[52:55], v[64:79]
    ds_read_b64_tr_b16 v[36:37], v2 offset:2048
    ds_read_b64_tr_b16 v[38:39], v2 offset:2560
    v_xor_b32 v12, 96, v12
    ds_read_b128 v[200:203], v12
    v_xor_b32 v12, 32, v12
    ds_read_b128 v[204:207], v12
    v_mfma_f32_32x32x16_bf16 v[80:95], v[184:187], v[56:59], v[80:95]
    v_xor_b32 v3, 0x00003000, v3
    v_add_u32 v3, 0x0000c000, v3
    ds_read_b64_tr_b16 v[40:41], v3 offset:0
    ds_read_b64_tr_b16 v[42:43], v3 offset:512
    v_xor_b32 v12, 224, v12
    ds_read_b128 v[208:211], v12
    v_xor_b32 v12, 32, v12
    ds_read_b128 v[212:215], v12
    v_mfma_f32_32x32x16_bf16 v[80:95], v[188:191], v[60:63], v[80:95]
    ds_read_b64_tr_b16 v[44:45], v3 offset:2048
    ds_read_b64_tr_b16 v[46:47], v3 offset:2560
    v_xor_b32 v12, 96, v12
    ds_read_b128 v[216:219], v12
    v_xor_b32 v12, 32, v12
    ds_read_b128 v[220:223], v12
    s_waitcnt lgkmcnt(13)
    v_dot2c_f32_bf16 v8, v192, v192
    v_dot2c_f32_bf16 v8, v193, v193
    v_dot2c_f32_bf16 v8, v194, v194
    v_dot2c_f32_bf16 v8, v195, v195
    s_waitcnt lgkmcnt(12)
    v_dot2c_f32_bf16 v8, v196, v196
    v_dot2c_f32_bf16 v8, v197, v197
    v_dot2c_f32_bf16 v8, v198, v198
    v_dot2c_f32_bf16 v8, v199, v199
    s_waitcnt lgkmcnt(9)
    v_dot2c_f32_bf16 v8, v200, v200
    v_dot2c_f32_bf16 v8, v201, v201
    v_dot2c_f32_bf16 v8, v202, v202
    v_dot2c_f32_bf16 v8, v203, v203
    s_waitcnt lgkmcnt(8)
    v_dot2c_f32_bf16 v8, v204, v204
    v_dot2c_f32_bf16 v8, v205, v205
    v_dot2c_f32_bf16 v8, v206, v206
    v_dot2c_f32_bf16 v8, v207, v207
    s_waitcnt lgkmcnt(5)
    v_dot2c_f32_bf16 v8, v208, v208
    v_dot2c_f32_bf16 v8, v209, v209
    v_dot2c_f32_bf16 v8, v210, v210
    v_dot2c_f32_bf16 v8, v211, v211
    s_waitcnt lgkmcnt(4)
    v_dot2c_f32_bf16 v8, v212, v212
    v_dot2c_f32_bf16 v8, v213, v213
    v_dot2c_f32_bf16 v8, v214, v214
    v_dot2c_f32_bf16 v8, v215, v215
    s_waitcnt lgkmcnt(1)
    v_dot2c_f32_bf16 v8, v216, v216
    v_dot2c_f32_bf16 v8, v217, v217
    v_dot2c_f32_bf16 v8, v218, v218
    v_dot2c_f32_bf16 v8, v219, v219
    s_waitcnt lgkmcnt(0)
    v_dot2c_f32_bf16 v8, v220, v220
    v_dot2c_f32_bf16 v8, v221, v221
    v_dot2c_f32_bf16 v8, v222, v222
    v_dot2c_f32_bf16 v8, v223, v223
    v_mfma_f32_32x32x16_bf16 v[64:79], v[192:195], v[32:35], v[64:79]
    v_xor_b32 v2, 0x00001000, v2
    ds_read_b64_tr_b16 v[48:49], v2 offset:0
    ds_read_b64_tr_b16 v[50:51], v2 offset:512
    ds_read_b64_tr_b16 v[52:53], v2 offset:2048
    ds_read_b64_tr_b16 v[54:55], v2 offset:2560
    v_xor_b32 v3, 0x00001000, v3
    ds_read_b64_tr_b16 v[56:57], v3 offset:0
    ds_read_b64_tr_b16 v[58:59], v3 offset:512
    v_mfma_f32_32x32x16_bf16 v[64:79], v[196:199], v[36:39], v[64:79]
    v_smfmac_f32_16x16x64_bf16 v[20:23], v[16:19], v[32:39], v11
    ds_read_b64_tr_b16 v[60:61], v3 offset:2048
    ds_read_b64_tr_b16 v[62:63], v3 offset:2560
    v_mfma_f32_32x32x16_bf16 v[80:95], v[192:195], v[40:43], v[80:95]
    v_xor_b32 v2, 0x00003000, v2
    ds_read_b64_tr_b16 v[32:33], v2 offset:0
    ds_read_b64_tr_b16 v[34:35], v2 offset:512
    v_mfma_f32_32x32x16_bf16 v[80:95], v[196:199], v[44:47], v[80:95]
    v_smfmac_f32_16x16x64_bf16 v[24:27], v[16:19], v[40:47], v11
    ds_read_b64_tr_b16 v[36:37], v2 offset:2048
    ds_read_b64_tr_b16 v[38:39], v2 offset:2560
    s_waitcnt lgkmcnt(8)
    v_mfma_f32_32x32x16_bf16 v[64:79], v[200:203], v[48:51], v[64:79]
    v_xor_b32 v3, 0x00003000, v3
    ds_read_b64_tr_b16 v[40:41], v3 offset:0
    ds_read_b64_tr_b16 v[42:43], v3 offset:512
    v_mfma_f32_32x32x16_bf16 v[64:79], v[204:207], v[52:55], v[64:79]
    ds_read_b64_tr_b16 v[44:45], v3 offset:2048
    ds_read_b64_tr_b16 v[46:47], v3 offset:2560
    v_smfmac_f32_16x16x64_bf16 v[4:7], v[16:19], v[192:199], v11
    s_waitcnt lgkmcnt(8)
    v_mfma_f32_32x32x16_bf16 v[80:95], v[200:203], v[56:59], v[80:95]
    v_xor_b32 v2, 0x00001000, v2
    ds_read_b64_tr_b16 v[48:49], v2 offset:0
    ds_read_b64_tr_b16 v[50:51], v2 offset:512
    v_smfmac_f32_16x16x64_bf16 v[4:7], v[16:19], v[200:207], v11
    v_mfma_f32_32x32x16_bf16 v[80:95], v[204:207], v[60:63], v[80:95]
    ds_read_b64_tr_b16 v[52:53], v2 offset:2048
    ds_read_b64_tr_b16 v[54:55], v2 offset:2560
    v_smfmac_f32_16x16x64_bf16 v[4:7], v[16:19], v[208:215], v11
    s_waitcnt lgkmcnt(8)
    v_mfma_f32_32x32x16_bf16 v[64:79], v[208:211], v[32:35], v[64:79]
    v_xor_b32 v3, 0x00001000, v3
    ds_read_b64_tr_b16 v[56:57], v3 offset:0
    ds_read_b64_tr_b16 v[58:59], v3 offset:512
    v_smfmac_f32_16x16x64_bf16 v[4:7], v[16:19], v[216:223], v11
    v_mfma_f32_32x32x16_bf16 v[64:79], v[212:215], v[36:39], v[64:79]
    ds_read_b64_tr_b16 v[60:61], v3 offset:2048
    ds_read_b64_tr_b16 v[62:63], v3 offset:2560
    s_waitcnt lgkmcnt(8)
    v_mfma_f32_32x32x16_bf16 v[80:95], v[208:211], v[40:43], v[80:95]
    v_mfma_f32_32x32x16_bf16 v[80:95], v[212:215], v[44:47], v[80:95]
    s_waitcnt lgkmcnt(0)
    s_barrier
    v_mfma_f32_32x32x16_bf16 v[64:79], v[216:219], v[48:51], v[64:79]
    v_xor_b32 v2, 0x00003000, v2
    ds_read_b64_tr_b16 v[32:33], v2 offset:16384
    ds_read_b64_tr_b16 v[34:35], v2 offset:16896
    v_add_u32 v12, 114688, v9
    ds_read_b128 v[224:227], v12
    v_xor_b32 v12, 32, v12
    ds_read_b128 v[228:231], v12
    v_mfma_f32_32x32x16_bf16 v[64:79], v[220:223], v[52:55], v[64:79]
    ds_read_b64_tr_b16 v[36:37], v2 offset:18432
    ds_read_b64_tr_b16 v[38:39], v2 offset:18944
    v_xor_b32 v12, 96, v12
    ds_read_b128 v[232:235], v12
    v_xor_b32 v12, 32, v12
    ds_read_b128 v[236:239], v12
    v_mfma_f32_32x32x16_bf16 v[80:95], v[216:219], v[56:59], v[80:95]
    v_xor_b32 v3, 0x00003000, v3
    ds_read_b64_tr_b16 v[40:41], v3 offset:16384
    ds_read_b64_tr_b16 v[42:43], v3 offset:16896
    v_xor_b32 v12, 224, v12
    ds_read_b128 v[240:243], v12
    v_xor_b32 v12, 32, v12
    ds_read_b128 v[244:247], v12
    v_mfma_f32_32x32x16_bf16 v[80:95], v[220:223], v[60:63], v[80:95]
    ds_read_b64_tr_b16 v[44:45], v3 offset:18432
    ds_read_b64_tr_b16 v[46:47], v3 offset:18944
    v_xor_b32 v12, 96, v12
    ds_read_b128 v[248:251], v12
    v_xor_b32 v12, 32, v12
    ds_read_b128 v[252:255], v12
    s_waitcnt lgkmcnt(13)
    v_dot2c_f32_bf16 v8, v224, v224
    v_dot2c_f32_bf16 v8, v225, v225
    v_dot2c_f32_bf16 v8, v226, v226
    v_dot2c_f32_bf16 v8, v227, v227
    s_waitcnt lgkmcnt(12)
    v_dot2c_f32_bf16 v8, v228, v228
    v_dot2c_f32_bf16 v8, v229, v229
    v_dot2c_f32_bf16 v8, v230, v230
    v_dot2c_f32_bf16 v8, v231, v231
    s_waitcnt lgkmcnt(9)
    v_dot2c_f32_bf16 v8, v232, v232
    v_dot2c_f32_bf16 v8, v233, v233
    v_dot2c_f32_bf16 v8, v234, v234
    v_dot2c_f32_bf16 v8, v235, v235
    s_waitcnt lgkmcnt(8)
    v_dot2c_f32_bf16 v8, v236, v236
    v_dot2c_f32_bf16 v8, v237, v237
    v_dot2c_f32_bf16 v8, v238, v238
    v_dot2c_f32_bf16 v8, v239, v239
    s_waitcnt lgkmcnt(5)
    v_dot2c_f32_bf16 v8, v240, v240
    v_dot2c_f32_bf16 v8, v241, v241
    v_dot2c_f32_bf16 v8, v242, v242
    v_dot2c_f32_bf16 v8, v243, v243
    s_waitcnt lgkmcnt(4)
    v_dot2c_f32_bf16 v8, v244, v244
    v_dot2c_f32_bf16 v8, v245, v245
    v_dot2c_f32_bf16 v8, v246, v246
    v_dot2c_f32_bf16 v8, v247, v247
    s_waitcnt lgkmcnt(1)
    v_dot2c_f32_bf16 v8, v248, v248
    v_dot2c_f32_bf16 v8, v249, v249
    v_dot2c_f32_bf16 v8, v250, v250
    v_dot2c_f32_bf16 v8, v251, v251
    s_waitcnt lgkmcnt(0)
    v_dot2c_f32_bf16 v8, v252, v252
    v_dot2c_f32_bf16 v8, v253, v253
    v_dot2c_f32_bf16 v8, v254, v254
    v_dot2c_f32_bf16 v8, v255, v255
    s_waitcnt vmcnt(0)
    v_mfma_f32_32x32x16_bf16 v[64:79], v[224:227], v[32:35], v[64:79]
    v_xor_b32 v2, 0x00001000, v2
    ds_read_b64_tr_b16 v[48:49], v2 offset:16384
    ds_read_b64_tr_b16 v[50:51], v2 offset:16896
    ds_read_b64_tr_b16 v[52:53], v2 offset:18432
    ds_read_b64_tr_b16 v[54:55], v2 offset:18944
    v_xor_b32 v3, 0x00001000, v3
    ds_read_b64_tr_b16 v[56:57], v3 offset:16384
    ds_read_b64_tr_b16 v[58:59], v3 offset:16896
    v_mfma_f32_32x32x16_bf16 v[64:79], v[228:231], v[36:39], v[64:79]
    v_smfmac_f32_16x16x64_bf16 v[20:23], v[16:19], v[32:39], v11
    ds_read_b64_tr_b16 v[60:61], v3 offset:18432
    ds_read_b64_tr_b16 v[62:63], v3 offset:18944
    v_mfma_f32_32x32x16_bf16 v[80:95], v[224:227], v[40:43], v[80:95]
    v_xor_b32 v2, 0x00003000, v2
    ds_read_b64_tr_b16 v[32:33], v2 offset:16384
    ds_read_b64_tr_b16 v[34:35], v2 offset:16896
    v_mfma_f32_32x32x16_bf16 v[80:95], v[228:231], v[44:47], v[80:95]
    v_smfmac_f32_16x16x64_bf16 v[24:27], v[16:19], v[40:47], v11
    ds_read_b64_tr_b16 v[36:37], v2 offset:18432
    ds_read_b64_tr_b16 v[38:39], v2 offset:18944
    s_waitcnt lgkmcnt(8)
    v_mfma_f32_32x32x16_bf16 v[64:79], v[232:235], v[48:51], v[64:79]
    v_xor_b32 v3, 0x00003000, v3
    ds_read_b64_tr_b16 v[40:41], v3 offset:16384
    ds_read_b64_tr_b16 v[42:43], v3 offset:16896
    v_mfma_f32_32x32x16_bf16 v[64:79], v[236:239], v[52:55], v[64:79]
    ds_read_b64_tr_b16 v[44:45], v3 offset:18432
    ds_read_b64_tr_b16 v[46:47], v3 offset:18944
    v_smfmac_f32_16x16x64_bf16 v[4:7], v[16:19], v[224:231], v11
    s_waitcnt lgkmcnt(8)
    v_mfma_f32_32x32x16_bf16 v[80:95], v[232:235], v[56:59], v[80:95]
    v_xor_b32 v2, 0x00001000, v2
    ds_read_b64_tr_b16 v[48:49], v2 offset:16384
    ds_read_b64_tr_b16 v[50:51], v2 offset:16896
    v_smfmac_f32_16x16x64_bf16 v[4:7], v[16:19], v[232:239], v11
    v_mfma_f32_32x32x16_bf16 v[80:95], v[236:239], v[60:63], v[80:95]
    s_lshl2_add_u32 s58, s4, 147456
    v_add_u32 v12, s58, v13
    v_add_f32 v20, v20, v21
    ds_read_b64_tr_b16 v[52:53], v2 offset:18432
    ds_read_b64_tr_b16 v[54:55], v2 offset:18944
    v_smfmac_f32_16x16x64_bf16 v[4:7], v[16:19], v[240:247], v11
    s_waitcnt lgkmcnt(8)
    v_mfma_f32_32x32x16_bf16 v[64:79], v[240:243], v[32:35], v[64:79]
    v_add_f32 v20, v20, v0
    v_add_f32 v24, v24, v25
    v_add_f32 v24, v24, v1
    v_xor_b32 v3, 0x00001000, v3
    ds_read_b64_tr_b16 v[56:57], v3 offset:16384
    ds_read_b64_tr_b16 v[58:59], v3 offset:16896
    v_smfmac_f32_16x16x64_bf16 v[4:7], v[16:19], v[248:255], v11
    v_mfma_f32_32x32x16_bf16 v[64:79], v[244:247], v[36:39], v[64:79]
    ds_write2st64_b32 v12, v20, v24 offset0:0 offset1:4
    v_mov_b32 v20, 0
    v_mov_b32 v21, 0
    ds_read_b64_tr_b16 v[60:61], v3 offset:18432
    ds_read_b64_tr_b16 v[62:63], v3 offset:18944
    s_waitcnt lgkmcnt(9)
    v_mfma_f32_32x32x16_bf16 v[80:95], v[240:243], v[40:43], v[80:95]
    v_mov_b32 v24, 0
    v_mov_b32 v25, 0
    v_xor_b32 v2, 0x3000, v2
    v_mfma_f32_32x32x16_bf16 v[80:95], v[244:247], v[44:47], v[80:95]
    v_xor_b32 v3, 0x3000, v3
    s_waitcnt lgkmcnt(0)
    s_setprio 3
    s_barrier
    v_mfma_f32_32x32x16_bf16 v[64:79], v[248:251], v[48:51], v[64:79]
    v_mfma_f32_32x32x16_bf16 v[64:79], v[252:255], v[52:55], v[64:79]
    v_add_f32 v6, v4, v5
    v_mov_b32 v7, v8
    v_mfma_f32_32x32x16_bf16 v[80:95], v[248:251], v[56:59], v[80:95]
    v_mfma_f32_32x32x16_bf16 v[80:95], v[252:255], v[60:63], v[80:95]
    s_branch LA_1
LA_n:
    v_lshlrev_b32 v12, 1, v15
    v_xor_b32 v0, 1, v14
    v_add_u32 v0, s4, v0
    v_lshl_add_u32 v12, v0, 20, v12
    s_cmp_eq_u32 s7, 15
    s_cselect_b32 s22, 3456, 0
    s_movk_i32 s58, 3072
    buffer_load_short_d16_hi v0, v12, s[20:23], s58 offen offset:0
    buffer_load_short_d16_hi v1, v12, s[20:23], s58 offen offset:64
    s_barrier
    v_add_u32 v12, 49152, v9
    ds_read_b128 v[96:99], v12
    ds_read_b64_tr_b16 v[32:33], v2 offset:0
    ds_read_b64_tr_b16 v[34:35], v2 offset:512
    v_xor_b32 v12, 32, v12
    ds_read_b128 v[100:103], v12
    ds_read_b64_tr_b16 v[36:37], v2 offset:2048
    ds_read_b64_tr_b16 v[38:39], v2 offset:2560
    ds_read_b64_tr_b16 v[40:41], v3 offset:0
    ds_read_b64_tr_b16 v[42:43], v3 offset:512
    ds_read_b64_tr_b16 v[44:45], v3 offset:2048
    ds_read_b64_tr_b16 v[46:47], v3 offset:2560
    v_xor_b32 v12, 96, v12
    ds_read_b128 v[104:107], v12
    v_xor_b32 v12, 32, v12
    ds_read_b128 v[108:111], v12
    v_xor_b32 v12, 224, v12
    ds_read_b128 v[112:115], v12
    v_xor_b32 v12, 32, v12
    ds_read_b128 v[116:119], v12
    v_xor_b32 v12, 96, v12
    ds_read_b128 v[120:123], v12
    v_xor_b32 v12, 32, v12
    ds_read_b128 v[124:127], v12
    s_waitcnt lgkmcnt(10)
    v_mfma_f32_32x32x16_bf16 v[64:79], v[32:35], v[96:99], 0
    v_xor_b32 v2, 0x00001000, v2
    ds_read_b64_tr_b16 v[48:49], v2 offset:0
    ds_read_b64_tr_b16 v[50:51], v2 offset:512
    ds_read_b64_tr_b16 v[52:53], v2 offset:2048
    ds_read_b64_tr_b16 v[54:55], v2 offset:2560
    v_xor_b32 v3, 0x00001000, v3
    ds_read_b64_tr_b16 v[56:57], v3 offset:0
    ds_read_b64_tr_b16 v[58:59], v3 offset:512
    v_mfma_f32_32x32x16_bf16 v[64:79], v[36:39], v[100:103], v[64:79]
    v_smfmac_f32_16x16x64_bf16 v[20:23], v[16:19], v[32:39], v11
    ds_read_b64_tr_b16 v[60:61], v3 offset:2048
    ds_read_b64_tr_b16 v[62:63], v3 offset:2560
    s_waitcnt lgkmcnt(14)
    v_mfma_f32_32x32x16_bf16 v[80:95], v[40:43], v[96:99], 0
    v_xor_b32 v2, 0x00003000, v2
    ds_read_b64_tr_b16 v[32:33], v2 offset:0
    ds_read_b64_tr_b16 v[34:35], v2 offset:512
    v_mfma_f32_32x32x16_bf16 v[80:95], v[44:47], v[100:103], v[80:95]
    v_smfmac_f32_16x16x64_bf16 v[24:27], v[16:19], v[40:47], v11
    ds_read_b64_tr_b16 v[36:37], v2 offset:2048
    ds_read_b64_tr_b16 v[38:39], v2 offset:2560
    v_dot2c_f32_bf16 v8, v96, v96
    v_dot2c_f32_bf16 v8, v97, v97
    v_dot2c_f32_bf16 v8, v98, v98
    v_dot2c_f32_bf16 v8, v99, v99
    v_dot2c_f32_bf16 v8, v100, v100
    v_dot2c_f32_bf16 v8, v101, v101
    v_dot2c_f32_bf16 v8, v102, v102
    v_dot2c_f32_bf16 v8, v103, v103
    s_waitcnt lgkmcnt(15)
    v_dot2c_f32_bf16 v8, v104, v104
    v_dot2c_f32_bf16 v8, v105, v105
    v_dot2c_f32_bf16 v8, v106, v106
    v_dot2c_f32_bf16 v8, v107, v107
    v_dot2c_f32_bf16 v8, v108, v108
    v_dot2c_f32_bf16 v8, v109, v109
    v_dot2c_f32_bf16 v8, v110, v110
    v_dot2c_f32_bf16 v8, v111, v111
    v_dot2c_f32_bf16 v8, v112, v112
    v_dot2c_f32_bf16 v8, v113, v113
    v_dot2c_f32_bf16 v8, v114, v114
    v_dot2c_f32_bf16 v8, v115, v115
    s_waitcnt lgkmcnt(14)
    v_dot2c_f32_bf16 v8, v116, v116
    v_dot2c_f32_bf16 v8, v117, v117
    v_dot2c_f32_bf16 v8, v118, v118
    v_dot2c_f32_bf16 v8, v119, v119
    s_waitcnt lgkmcnt(13)
    v_dot2c_f32_bf16 v8, v120, v120
    v_dot2c_f32_bf16 v8, v121, v121
    v_dot2c_f32_bf16 v8, v122, v122
    v_dot2c_f32_bf16 v8, v123, v123
    s_waitcnt lgkmcnt(12)
    v_dot2c_f32_bf16 v8, v124, v124
    v_dot2c_f32_bf16 v8, v125, v125
    v_dot2c_f32_bf16 v8, v126, v126
    v_dot2c_f32_bf16 v8, v127, v127
    s_waitcnt lgkmcnt(8)
    v_mfma_f32_32x32x16_bf16 v[64:79], v[48:51], v[104:107], v[64:79]
    v_xor_b32 v3, 0x00003000, v3
    ds_read_b64_tr_b16 v[40:41], v3 offset:0
    ds_read_b64_tr_b16 v[42:43], v3 offset:512
    v_mfma_f32_32x32x16_bf16 v[64:79], v[52:55], v[108:111], v[64:79]
    ds_read_b64_tr_b16 v[44:45], v3 offset:2048
    ds_read_b64_tr_b16 v[46:47], v3 offset:2560
    v_smfmac_f32_16x16x64_bf16 v[4:7], v[16:19], v[96:103], v11
    s_waitcnt lgkmcnt(8)
    v_mfma_f32_32x32x16_bf16 v[80:95], v[56:59], v[104:107], v[80:95]
    v_xor_b32 v2, 0x00001000, v2
    ds_read_b64_tr_b16 v[48:49], v2 offset:0
    ds_read_b64_tr_b16 v[50:51], v2 offset:512
    v_smfmac_f32_16x16x64_bf16 v[4:7], v[16:19], v[104:111], v11
    v_mfma_f32_32x32x16_bf16 v[80:95], v[60:63], v[108:111], v[80:95]
    ds_read_b64_tr_b16 v[52:53], v2 offset:2048
    ds_read_b64_tr_b16 v[54:55], v2 offset:2560
    v_smfmac_f32_16x16x64_bf16 v[4:7], v[16:19], v[112:119], v11
    s_waitcnt lgkmcnt(8)
    v_mfma_f32_32x32x16_bf16 v[64:79], v[32:35], v[112:115], v[64:79]
    v_xor_b32 v3, 0x00001000, v3
    ds_read_b64_tr_b16 v[56:57], v3 offset:0
    ds_read_b64_tr_b16 v[58:59], v3 offset:512
    v_smfmac_f32_16x16x64_bf16 v[4:7], v[16:19], v[120:127], v11
    v_mfma_f32_32x32x16_bf16 v[64:79], v[36:39], v[116:119], v[64:79]
    ds_read_b64_tr_b16 v[60:61], v3 offset:2048
    ds_read_b64_tr_b16 v[62:63], v3 offset:2560
    s_waitcnt lgkmcnt(8)
    v_mfma_f32_32x32x16_bf16 v[80:95], v[40:43], v[112:115], v[80:95]
    v_mfma_f32_32x32x16_bf16 v[80:95], v[44:47], v[116:119], v[80:95]
    s_waitcnt lgkmcnt(0)
    s_barrier
    v_mfma_f32_32x32x16_bf16 v[64:79], v[48:51], v[120:123], v[64:79]
    v_xor_b32 v2, 0x00003000, v2
    ds_read_b64_tr_b16 v[32:33], v2 offset:16384
    ds_read_b64_tr_b16 v[34:35], v2 offset:16896
    v_add_u32 v12, 114688, v9
    ds_read_b128 v[128:131], v12
    v_xor_b32 v12, 32, v12
    ds_read_b128 v[132:135], v12
    v_mfma_f32_32x32x16_bf16 v[64:79], v[52:55], v[124:127], v[64:79]
    ds_read_b64_tr_b16 v[36:37], v2 offset:18432
    ds_read_b64_tr_b16 v[38:39], v2 offset:18944
    v_xor_b32 v12, 96, v12
    ds_read_b128 v[136:139], v12
    v_xor_b32 v12, 32, v12
    ds_read_b128 v[140:143], v12
    v_mfma_f32_32x32x16_bf16 v[80:95], v[56:59], v[120:123], v[80:95]
    v_xor_b32 v3, 0x00003000, v3
    ds_read_b64_tr_b16 v[40:41], v3 offset:16384
    ds_read_b64_tr_b16 v[42:43], v3 offset:16896
    v_xor_b32 v12, 224, v12
    ds_read_b128 v[144:147], v12
    v_xor_b32 v12, 32, v12
    ds_read_b128 v[148:151], v12
    v_mfma_f32_32x32x16_bf16 v[80:95], v[60:63], v[124:127], v[80:95]
    ds_read_b64_tr_b16 v[44:45], v3 offset:18432
    ds_read_b64_tr_b16 v[46:47], v3 offset:18944
    v_xor_b32 v12, 96, v12
    ds_read_b128 v[152:155], v12
    v_xor_b32 v12, 32, v12
    ds_read_b128 v[156:159], v12
    s_waitcnt lgkmcnt(13)
    v_dot2c_f32_bf16 v8, v128, v128
    v_dot2c_f32_bf16 v8, v129, v129
    v_dot2c_f32_bf16 v8, v130, v130
    v_dot2c_f32_bf16 v8, v131, v131
    s_waitcnt lgkmcnt(12)
    v_dot2c_f32_bf16 v8, v132, v132
    v_dot2c_f32_bf16 v8, v133, v133
    v_dot2c_f32_bf16 v8, v134, v134
    v_dot2c_f32_bf16 v8, v135, v135
    s_waitcnt lgkmcnt(9)
    v_dot2c_f32_bf16 v8, v136, v136
    v_dot2c_f32_bf16 v8, v137, v137
    v_dot2c_f32_bf16 v8, v138, v138
    v_dot2c_f32_bf16 v8, v139, v139
    s_waitcnt lgkmcnt(8)
    v_dot2c_f32_bf16 v8, v140, v140
    v_dot2c_f32_bf16 v8, v141, v141
    v_dot2c_f32_bf16 v8, v142, v142
    v_dot2c_f32_bf16 v8, v143, v143
    s_waitcnt lgkmcnt(5)
    v_dot2c_f32_bf16 v8, v144, v144
    v_dot2c_f32_bf16 v8, v145, v145
    v_dot2c_f32_bf16 v8, v146, v146
    v_dot2c_f32_bf16 v8, v147, v147
    s_waitcnt lgkmcnt(4)
    v_dot2c_f32_bf16 v8, v148, v148
    v_dot2c_f32_bf16 v8, v149, v149
    v_dot2c_f32_bf16 v8, v150, v150
    v_dot2c_f32_bf16 v8, v151, v151
    s_waitcnt lgkmcnt(1)
    v_dot2c_f32_bf16 v8, v152, v152
    v_dot2c_f32_bf16 v8, v153, v153
    v_dot2c_f32_bf16 v8, v154, v154
    v_dot2c_f32_bf16 v8, v155, v155
    s_waitcnt lgkmcnt(0)
    v_dot2c_f32_bf16 v8, v156, v156
    v_dot2c_f32_bf16 v8, v157, v157
    v_dot2c_f32_bf16 v8, v158, v158
    v_dot2c_f32_bf16 v8, v159, v159
    v_mfma_f32_32x32x16_bf16 v[64:79], v[32:35], v[128:131], v[64:79]
    v_xor_b32 v2, 0x00001000, v2
    ds_read_b64_tr_b16 v[48:49], v2 offset:16384
    ds_read_b64_tr_b16 v[50:51], v2 offset:16896
    ds_read_b64_tr_b16 v[52:53], v2 offset:18432
    ds_read_b64_tr_b16 v[54:55], v2 offset:18944
    v_xor_b32 v3, 0x00001000, v3
    ds_read_b64_tr_b16 v[56:57], v3 offset:16384
    ds_read_b64_tr_b16 v[58:59], v3 offset:16896
    v_mfma_f32_32x32x16_bf16 v[64:79], v[36:39], v[132:135], v[64:79]
    v_smfmac_f32_16x16x64_bf16 v[20:23], v[16:19], v[32:39], v11
    ds_read_b64_tr_b16 v[60:61], v3 offset:18432
    ds_read_b64_tr_b16 v[62:63], v3 offset:18944
    v_mfma_f32_32x32x16_bf16 v[80:95], v[40:43], v[128:131], v[80:95]
    v_xor_b32 v2, 0x00003000, v2
    ds_read_b64_tr_b16 v[32:33], v2 offset:16384
    ds_read_b64_tr_b16 v[34:35], v2 offset:16896
    v_mfma_f32_32x32x16_bf16 v[80:95], v[44:47], v[132:135], v[80:95]
    v_smfmac_f32_16x16x64_bf16 v[24:27], v[16:19], v[40:47], v11
    ds_read_b64_tr_b16 v[36:37], v2 offset:18432
    ds_read_b64_tr_b16 v[38:39], v2 offset:18944
    s_waitcnt lgkmcnt(8)
    v_mfma_f32_32x32x16_bf16 v[64:79], v[48:51], v[136:139], v[64:79]
    v_xor_b32 v3, 0x00003000, v3
    ds_read_b64_tr_b16 v[40:41], v3 offset:16384
    ds_read_b64_tr_b16 v[42:43], v3 offset:16896
    v_mfma_f32_32x32x16_bf16 v[64:79], v[52:55], v[140:143], v[64:79]
    ds_read_b64_tr_b16 v[44:45], v3 offset:18432
    ds_read_b64_tr_b16 v[46:47], v3 offset:18944
    v_smfmac_f32_16x16x64_bf16 v[4:7], v[16:19], v[128:135], v11
    s_waitcnt lgkmcnt(8)
    v_mfma_f32_32x32x16_bf16 v[80:95], v[56:59], v[136:139], v[80:95]
    v_xor_b32 v2, 0x00001000, v2
    ds_read_b64_tr_b16 v[48:49], v2 offset:16384
    ds_read_b64_tr_b16 v[50:51], v2 offset:16896
    v_smfmac_f32_16x16x64_bf16 v[4:7], v[16:19], v[136:143], v11
    v_mfma_f32_32x32x16_bf16 v[80:95], v[60:63], v[140:143], v[80:95]
    ds_read_b64_tr_b16 v[52:53], v2 offset:18432
    ds_read_b64_tr_b16 v[54:55], v2 offset:18944
    v_smfmac_f32_16x16x64_bf16 v[4:7], v[16:19], v[144:151], v11
    s_waitcnt lgkmcnt(8)
    v_mfma_f32_32x32x16_bf16 v[64:79], v[32:35], v[144:147], v[64:79]
    v_xor_b32 v3, 0x00001000, v3
    ds_read_b64_tr_b16 v[56:57], v3 offset:16384
    ds_read_b64_tr_b16 v[58:59], v3 offset:16896
    v_smfmac_f32_16x16x64_bf16 v[4:7], v[16:19], v[152:159], v11
    v_mfma_f32_32x32x16_bf16 v[64:79], v[36:39], v[148:151], v[64:79]
    ds_read_b64_tr_b16 v[60:61], v3 offset:18432
    ds_read_b64_tr_b16 v[62:63], v3 offset:18944
    s_waitcnt lgkmcnt(8)
    v_mfma_f32_32x32x16_bf16 v[80:95], v[40:43], v[144:147], v[80:95]
    v_mfma_f32_32x32x16_bf16 v[80:95], v[44:47], v[148:151], v[80:95]
    s_waitcnt lgkmcnt(0)
    s_barrier
    v_mfma_f32_32x32x16_bf16 v[64:79], v[48:51], v[152:155], v[64:79]
    v_xor_b32 v2, 0x00003000, v2
    v_add_u32 v2, 0xffff4000, v2
    ds_read_b64_tr_b16 v[32:33], v2 offset:0
    ds_read_b64_tr_b16 v[34:35], v2 offset:512
    v_add_u32 v12, 0, v9
    ds_read_b128 v[160:163], v12
    v_xor_b32 v12, 32, v12
    ds_read_b128 v[164:167], v12
    v_mfma_f32_32x32x16_bf16 v[64:79], v[52:55], v[156:159], v[64:79]
    ds_read_b64_tr_b16 v[36:37], v2 offset:2048
    ds_read_b64_tr_b16 v[38:39], v2 offset:2560
    v_xor_b32 v12, 96, v12
    ds_read_b128 v[168:171], v12
    v_xor_b32 v12, 32, v12
    ds_read_b128 v[172:175], v12
    v_mfma_f32_32x32x16_bf16 v[80:95], v[56:59], v[152:155], v[80:95]
    v_xor_b32 v3, 0x00003000, v3
    v_add_u32 v3, 0xffff4000, v3
    ds_read_b64_tr_b16 v[40:41], v3 offset:0
    ds_read_b64_tr_b16 v[42:43], v3 offset:512
    v_xor_b32 v12, 224, v12
    ds_read_b128 v[176:179], v12
    v_xor_b32 v12, 32, v12
    ds_read_b128 v[180:183], v12
    v_mfma_f32_32x32x16_bf16 v[80:95], v[60:63], v[156:159], v[80:95]
    ds_read_b64_tr_b16 v[44:45], v3 offset:2048
    ds_read_b64_tr_b16 v[46:47], v3 offset:2560
    v_xor_b32 v12, 96, v12
    ds_read_b128 v[184:187], v12
    v_xor_b32 v12, 32, v12
    ds_read_b128 v[188:191], v12
    s_waitcnt lgkmcnt(13)
    v_dot2c_f32_bf16 v8, v160, v160
    v_dot2c_f32_bf16 v8, v161, v161
    v_dot2c_f32_bf16 v8, v162, v162
    v_dot2c_f32_bf16 v8, v163, v163
    s_waitcnt lgkmcnt(12)
    v_dot2c_f32_bf16 v8, v164, v164
    v_dot2c_f32_bf16 v8, v165, v165
    v_dot2c_f32_bf16 v8, v166, v166
    v_dot2c_f32_bf16 v8, v167, v167
    s_waitcnt lgkmcnt(9)
    v_dot2c_f32_bf16 v8, v168, v168
    v_dot2c_f32_bf16 v8, v169, v169
    v_dot2c_f32_bf16 v8, v170, v170
    v_dot2c_f32_bf16 v8, v171, v171
    s_waitcnt lgkmcnt(8)
    v_dot2c_f32_bf16 v8, v172, v172
    v_dot2c_f32_bf16 v8, v173, v173
    v_dot2c_f32_bf16 v8, v174, v174
    v_dot2c_f32_bf16 v8, v175, v175
    s_waitcnt lgkmcnt(5)
    v_dot2c_f32_bf16 v8, v176, v176
    v_dot2c_f32_bf16 v8, v177, v177
    v_dot2c_f32_bf16 v8, v178, v178
    v_dot2c_f32_bf16 v8, v179, v179
    s_waitcnt lgkmcnt(4)
    v_dot2c_f32_bf16 v8, v180, v180
    v_dot2c_f32_bf16 v8, v181, v181
    v_dot2c_f32_bf16 v8, v182, v182
    v_dot2c_f32_bf16 v8, v183, v183
    s_waitcnt lgkmcnt(1)
    v_dot2c_f32_bf16 v8, v184, v184
    v_dot2c_f32_bf16 v8, v185, v185
    v_dot2c_f32_bf16 v8, v186, v186
    v_dot2c_f32_bf16 v8, v187, v187
    s_waitcnt lgkmcnt(0)
    v_dot2c_f32_bf16 v8, v188, v188
    v_dot2c_f32_bf16 v8, v189, v189
    v_dot2c_f32_bf16 v8, v190, v190
    v_dot2c_f32_bf16 v8, v191, v191
    v_mfma_f32_32x32x16_bf16 v[64:79], v[32:35], v[160:163], v[64:79]
    v_xor_b32 v2, 0x00001000, v2
    ds_read_b64_tr_b16 v[48:49], v2 offset:0
    ds_read_b64_tr_b16 v[50:51], v2 offset:512
    ds_read_b64_tr_b16 v[52:53], v2 offset:2048
    ds_read_b64_tr_b16 v[54:55], v2 offset:2560
    v_xor_b32 v3, 0x00001000, v3
    ds_read_b64_tr_b16 v[56:57], v3 offset:0
    ds_read_b64_tr_b16 v[58:59], v3 offset:512
    v_mfma_f32_32x32x16_bf16 v[64:79], v[36:39], v[164:167], v[64:79]
    v_smfmac_f32_16x16x64_bf16 v[20:23], v[16:19], v[32:39], v11
    ds_read_b64_tr_b16 v[60:61], v3 offset:2048
    ds_read_b64_tr_b16 v[62:63], v3 offset:2560
    v_mfma_f32_32x32x16_bf16 v[80:95], v[40:43], v[160:163], v[80:95]
    v_xor_b32 v2, 0x00003000, v2
    ds_read_b64_tr_b16 v[32:33], v2 offset:0
    ds_read_b64_tr_b16 v[34:35], v2 offset:512
    v_mfma_f32_32x32x16_bf16 v[80:95], v[44:47], v[164:167], v[80:95]
    v_smfmac_f32_16x16x64_bf16 v[24:27], v[16:19], v[40:47], v11
    ds_read_b64_tr_b16 v[36:37], v2 offset:2048
    ds_read_b64_tr_b16 v[38:39], v2 offset:2560
    s_waitcnt lgkmcnt(8)
    v_mfma_f32_32x32x16_bf16 v[64:79], v[48:51], v[168:171], v[64:79]
    v_xor_b32 v3, 0x00003000, v3
    ds_read_b64_tr_b16 v[40:41], v3 offset:0
    ds_read_b64_tr_b16 v[42:43], v3 offset:512
    v_mfma_f32_32x32x16_bf16 v[64:79], v[52:55], v[172:175], v[64:79]
    ds_read_b64_tr_b16 v[44:45], v3 offset:2048
    ds_read_b64_tr_b16 v[46:47], v3 offset:2560
    v_smfmac_f32_16x16x64_bf16 v[4:7], v[16:19], v[160:167], v11
    s_waitcnt lgkmcnt(8)
    v_mfma_f32_32x32x16_bf16 v[80:95], v[56:59], v[168:171], v[80:95]
    v_xor_b32 v2, 0x00001000, v2
    ds_read_b64_tr_b16 v[48:49], v2 offset:0
    ds_read_b64_tr_b16 v[50:51], v2 offset:512
    v_smfmac_f32_16x16x64_bf16 v[4:7], v[16:19], v[168:175], v11
    v_mfma_f32_32x32x16_bf16 v[80:95], v[60:63], v[172:175], v[80:95]
    ds_read_b64_tr_b16 v[52:53], v2 offset:2048
    ds_read_b64_tr_b16 v[54:55], v2 offset:2560
    v_smfmac_f32_16x16x64_bf16 v[4:7], v[16:19], v[176:183], v11
    s_waitcnt lgkmcnt(8)
    v_mfma_f32_32x32x16_bf16 v[64:79], v[32:35], v[176:179], v[64:79]
    v_xor_b32 v3, 0x00001000, v3
    ds_read_b64_tr_b16 v[56:57], v3 offset:0
    ds_read_b64_tr_b16 v[58:59], v3 offset:512
    v_smfmac_f32_16x16x64_bf16 v[4:7], v[16:19], v[184:191], v11
    v_mfma_f32_32x32x16_bf16 v[64:79], v[36:39], v[180:183], v[64:79]
    ds_read_b64_tr_b16 v[60:61], v3 offset:2048
    ds_read_b64_tr_b16 v[62:63], v3 offset:2560
    s_waitcnt lgkmcnt(8)
    v_mfma_f32_32x32x16_bf16 v[80:95], v[40:43], v[176:179], v[80:95]
    v_mfma_f32_32x32x16_bf16 v[80:95], v[44:47], v[180:183], v[80:95]
    s_waitcnt lgkmcnt(0)
    s_barrier
    v_mfma_f32_32x32x16_bf16 v[64:79], v[48:51], v[184:187], v[64:79]
    v_xor_b32 v2, 0x00003000, v2
    v_add_u32 v2, 0x0000c000, v2
    ds_read_b64_tr_b16 v[32:33], v2 offset:0
    ds_read_b64_tr_b16 v[34:35], v2 offset:512
    v_add_u32 v12, 49152, v9
    ds_read_b128 v[192:195], v12
    v_xor_b32 v12, 32, v12
    ds_read_b128 v[196:199], v12
    v_mfma_f32_32x32x16_bf16 v[64:79], v[52:55], v[188:191], v[64:79]
    ds_read_b64_tr_b16 v[36:37], v2 offset:2048
    ds_read_b64_tr_b16 v[38:39], v2 offset:2560
    v_xor_b32 v12, 96, v12
    ds_read_b128 v[200:203], v12
    v_xor_b32 v12, 32, v12
    ds_read_b128 v[204:207], v12
    v_mfma_f32_32x32x16_bf16 v[80:95], v[56:59], v[184:187], v[80:95]
    v_xor_b32 v3, 0x00003000, v3
    v_add_u32 v3, 0x0000c000, v3
    ds_read_b64_tr_b16 v[40:41], v3 offset:0
    ds_read_b64_tr_b16 v[42:43], v3 offset:512
    v_xor_b32 v12, 224, v12
    ds_read_b128 v[208:211], v12
    v_xor_b32 v12, 32, v12
    ds_read_b128 v[212:215], v12
    v_mfma_f32_32x32x16_bf16 v[80:95], v[60:63], v[188:191], v[80:95]
    ds_read_b64_tr_b16 v[44:45], v3 offset:2048
    ds_read_b64_tr_b16 v[46:47], v3 offset:2560
    v_xor_b32 v12, 96, v12
    ds_read_b128 v[216:219], v12
    v_xor_b32 v12, 32, v12
    ds_read_b128 v[220:223], v12
    s_waitcnt lgkmcnt(13)
    v_dot2c_f32_bf16 v8, v192, v192
    v_dot2c_f32_bf16 v8, v193, v193
    v_dot2c_f32_bf16 v8, v194, v194
    v_dot2c_f32_bf16 v8, v195, v195
    s_waitcnt lgkmcnt(12)
    v_dot2c_f32_bf16 v8, v196, v196
    v_dot2c_f32_bf16 v8, v197, v197
    v_dot2c_f32_bf16 v8, v198, v198
    v_dot2c_f32_bf16 v8, v199, v199
    s_waitcnt lgkmcnt(9)
    v_dot2c_f32_bf16 v8, v200, v200
    v_dot2c_f32_bf16 v8, v201, v201
    v_dot2c_f32_bf16 v8, v202, v202
    v_dot2c_f32_bf16 v8, v203, v203
    s_waitcnt lgkmcnt(8)
    v_dot2c_f32_bf16 v8, v204, v204
    v_dot2c_f32_bf16 v8, v205, v205
    v_dot2c_f32_bf16 v8, v206, v206
    v_dot2c_f32_bf16 v8, v207, v207
    s_waitcnt lgkmcnt(5)
    v_dot2c_f32_bf16 v8, v208, v208
    v_dot2c_f32_bf16 v8, v209, v209
    v_dot2c_f32_bf16 v8, v210, v210
    v_dot2c_f32_bf16 v8, v211, v211
    s_waitcnt lgkmcnt(4)
    v_dot2c_f32_bf16 v8, v212, v212
    v_dot2c_f32_bf16 v8, v213, v213
    v_dot2c_f32_bf16 v8, v214, v214
    v_dot2c_f32_bf16 v8, v215, v215
    s_waitcnt lgkmcnt(1)
    v_dot2c_f32_bf16 v8, v216, v216
    v_dot2c_f32_bf16 v8, v217, v217
    v_dot2c_f32_bf16 v8, v218, v218
    v_dot2c_f32_bf16 v8, v219, v219
    s_waitcnt lgkmcnt(0)
    v_dot2c_f32_bf16 v8, v220, v220
    v_dot2c_f32_bf16 v8, v221, v221
    v_dot2c_f32_bf16 v8, v222, v222
    v_dot2c_f32_bf16 v8, v223, v223
    v_mfma_f32_32x32x16_bf16 v[64:79], v[32:35], v[192:195], v[64:79]
    v_xor_b32 v2, 0x00001000, v2
    ds_read_b64_tr_b16 v[48:49], v2 offset:0
    ds_read_b64_tr_b16 v[50:51], v2 offset:512
    ds_read_b64_tr_b16 v[52:53], v2 offset:2048
    ds_read_b64_tr_b16 v[54:55], v2 offset:2560
    v_xor_b32 v3, 0x00001000, v3
    ds_read_b64_tr_b16 v[56:57], v3 offset:0
    ds_read_b64_tr_b16 v[58:59], v3 offset:512
    v_mfma_f32_32x32x16_bf16 v[64:79], v[36:39], v[196:199], v[64:79]
    v_smfmac_f32_16x16x64_bf16 v[20:23], v[16:19], v[32:39], v11
    ds_read_b64_tr_b16 v[60:61], v3 offset:2048
    ds_read_b64_tr_b16 v[62:63], v3 offset:2560
    v_mfma_f32_32x32x16_bf16 v[80:95], v[40:43], v[192:195], v[80:95]
    v_xor_b32 v2, 0x00003000, v2
    ds_read_b64_tr_b16 v[32:33], v2 offset:0
    ds_read_b64_tr_b16 v[34:35], v2 offset:512
    v_mfma_f32_32x32x16_bf16 v[80:95], v[44:47], v[196:199], v[80:95]
    v_smfmac_f32_16x16x64_bf16 v[24:27], v[16:19], v[40:47], v11
    ds_read_b64_tr_b16 v[36:37], v2 offset:2048
    ds_read_b64_tr_b16 v[38:39], v2 offset:2560
    s_waitcnt lgkmcnt(8)
    v_mfma_f32_32x32x16_bf16 v[64:79], v[48:51], v[200:203], v[64:79]
    v_xor_b32 v3, 0x00003000, v3
    ds_read_b64_tr_b16 v[40:41], v3 offset:0
    ds_read_b64_tr_b16 v[42:43], v3 offset:512
    v_mfma_f32_32x32x16_bf16 v[64:79], v[52:55], v[204:207], v[64:79]
    ds_read_b64_tr_b16 v[44:45], v3 offset:2048
    ds_read_b64_tr_b16 v[46:47], v3 offset:2560
    v_smfmac_f32_16x16x64_bf16 v[4:7], v[16:19], v[192:199], v11
    s_waitcnt lgkmcnt(8)
    v_mfma_f32_32x32x16_bf16 v[80:95], v[56:59], v[200:203], v[80:95]
    v_xor_b32 v2, 0x00001000, v2
    ds_read_b64_tr_b16 v[48:49], v2 offset:0
    ds_read_b64_tr_b16 v[50:51], v2 offset:512
    v_smfmac_f32_16x16x64_bf16 v[4:7], v[16:19], v[200:207], v11
    v_mfma_f32_32x32x16_bf16 v[80:95], v[60:63], v[204:207], v[80:95]
    ds_read_b64_tr_b16 v[52:53], v2 offset:2048
    ds_read_b64_tr_b16 v[54:55], v2 offset:2560
    v_smfmac_f32_16x16x64_bf16 v[4:7], v[16:19], v[208:215], v11
    s_waitcnt lgkmcnt(8)
    v_mfma_f32_32x32x16_bf16 v[64:79], v[32:35], v[208:211], v[64:79]
    v_xor_b32 v3, 0x00001000, v3
    ds_read_b64_tr_b16 v[56:57], v3 offset:0
    ds_read_b64_tr_b16 v[58:59], v3 offset:512
    v_smfmac_f32_16x16x64_bf16 v[4:7], v[16:19], v[216:223], v11
    v_mfma_f32_32x32x16_bf16 v[64:79], v[36:39], v[212:215], v[64:79]
    ds_read_b64_tr_b16 v[60:61], v3 offset:2048
    ds_read_b64_tr_b16 v[62:63], v3 offset:2560
    s_waitcnt lgkmcnt(8)
    v_mfma_f32_32x32x16_bf16 v[80:95], v[40:43], v[208:211], v[80:95]
    v_mfma_f32_32x32x16_bf16 v[80:95], v[44:47], v[212:215], v[80:95]
    s_waitcnt lgkmcnt(0)
    s_barrier
    v_mfma_f32_32x32x16_bf16 v[64:79], v[48:51], v[216:219], v[64:79]
    v_xor_b32 v2, 0x00003000, v2
    ds_read_b64_tr_b16 v[32:33], v2 offset:16384
    ds_read_b64_tr_b16 v[34:35], v2 offset:16896
    v_add_u32 v12, 114688, v9
    ds_read_b128 v[224:227], v12
    v_xor_b32 v12, 32, v12
    ds_read_b128 v[228:231], v12
    v_mfma_f32_32x32x16_bf16 v[64:79], v[52:55], v[220:223], v[64:79]
    ds_read_b64_tr_b16 v[36:37], v2 offset:18432
    ds_read_b64_tr_b16 v[38:39], v2 offset:18944
    v_xor_b32 v12, 96, v12
    ds_read_b128 v[232:235], v12
    v_xor_b32 v12, 32, v12
    ds_read_b128 v[236:239], v12
    v_mfma_f32_32x32x16_bf16 v[80:95], v[56:59], v[216:219], v[80:95]
    v_xor_b32 v3, 0x00003000, v3
    ds_read_b64_tr_b16 v[40:41], v3 offset:16384
    ds_read_b64_tr_b16 v[42:43], v3 offset:16896
    v_xor_b32 v12, 224, v12
    ds_read_b128 v[240:243], v12
    v_xor_b32 v12, 32, v12
    ds_read_b128 v[244:247], v12
    v_mfma_f32_32x32x16_bf16 v[80:95], v[60:63], v[220:223], v[80:95]
    ds_read_b64_tr_b16 v[44:45], v3 offset:18432
    ds_read_b64_tr_b16 v[46:47], v3 offset:18944
    v_xor_b32 v12, 96, v12
    ds_read_b128 v[248:251], v12
    v_xor_b32 v12, 32, v12
    ds_read_b128 v[252:255], v12
    s_waitcnt lgkmcnt(13)
    v_dot2c_f32_bf16 v8, v224, v224
    v_dot2c_f32_bf16 v8, v225, v225
    v_dot2c_f32_bf16 v8, v226, v226
    v_dot2c_f32_bf16 v8, v227, v227
    s_waitcnt lgkmcnt(12)
    v_dot2c_f32_bf16 v8, v228, v228
    v_dot2c_f32_bf16 v8, v229, v229
    v_dot2c_f32_bf16 v8, v230, v230
    v_dot2c_f32_bf16 v8, v231, v231
    s_waitcnt lgkmcnt(9)
    v_dot2c_f32_bf16 v8, v232, v232
    v_dot2c_f32_bf16 v8, v233, v233
    v_dot2c_f32_bf16 v8, v234, v234
    v_dot2c_f32_bf16 v8, v235, v235
    s_waitcnt lgkmcnt(8)
    v_dot2c_f32_bf16 v8, v236, v236
    v_dot2c_f32_bf16 v8, v237, v237
    v_dot2c_f32_bf16 v8, v238, v238
    v_dot2c_f32_bf16 v8, v239, v239
    s_waitcnt lgkmcnt(5)
    v_dot2c_f32_bf16 v8, v240, v240
    v_dot2c_f32_bf16 v8, v241, v241
    v_dot2c_f32_bf16 v8, v242, v242
    v_dot2c_f32_bf16 v8, v243, v243
    s_waitcnt lgkmcnt(4)
    v_dot2c_f32_bf16 v8, v244, v244
    v_dot2c_f32_bf16 v8, v245, v245
    v_dot2c_f32_bf16 v8, v246, v246
    v_dot2c_f32_bf16 v8, v247, v247
    s_waitcnt lgkmcnt(1)
    v_dot2c_f32_bf16 v8, v248, v248
    v_dot2c_f32_bf16 v8, v249, v249
    v_dot2c_f32_bf16 v8, v250, v250
    v_dot2c_f32_bf16 v8, v251, v251
    s_waitcnt lgkmcnt(0)
    v_dot2c_f32_bf16 v8, v252, v252
    v_dot2c_f32_bf16 v8, v253, v253
    v_dot2c_f32_bf16 v8, v254, v254
    v_dot2c_f32_bf16 v8, v255, v255
    s_waitcnt vmcnt(0)
    v_mfma_f32_32x32x16_bf16 v[64:79], v[32:35], v[224:227], v[64:79]
    v_xor_b32 v2, 0x00001000, v2
    ds_read_b64_tr_b16 v[48:49], v2 offset:16384
    ds_read_b64_tr_b16 v[50:51], v2 offset:16896
    ds_read_b64_tr_b16 v[52:53], v2 offset:18432
    ds_read_b64_tr_b16 v[54:55], v2 offset:18944
    v_xor_b32 v3, 0x00001000, v3
    ds_read_b64_tr_b16 v[56:57], v3 offset:16384
    ds_read_b64_tr_b16 v[58:59], v3 offset:16896
    v_mfma_f32_32x32x16_bf16 v[64:79], v[36:39], v[228:231], v[64:79]
    v_smfmac_f32_16x16x64_bf16 v[20:23], v[16:19], v[32:39], v11
    ds_read_b64_tr_b16 v[60:61], v3 offset:18432
    ds_read_b64_tr_b16 v[62:63], v3 offset:18944
    v_mfma_f32_32x32x16_bf16 v[80:95], v[40:43], v[224:227], v[80:95]
    v_xor_b32 v2, 0x00003000, v2
    ds_read_b64_tr_b16 v[32:33], v2 offset:16384
    ds_read_b64_tr_b16 v[34:35], v2 offset:16896
    v_mfma_f32_32x32x16_bf16 v[80:95], v[44:47], v[228:231], v[80:95]
    v_smfmac_f32_16x16x64_bf16 v[24:27], v[16:19], v[40:47], v11
    ds_read_b64_tr_b16 v[36:37], v2 offset:18432
    ds_read_b64_tr_b16 v[38:39], v2 offset:18944
    s_waitcnt lgkmcnt(8)
    v_mfma_f32_32x32x16_bf16 v[64:79], v[48:51], v[232:235], v[64:79]
    v_xor_b32 v3, 0x00003000, v3
    ds_read_b64_tr_b16 v[40:41], v3 offset:16384
    ds_read_b64_tr_b16 v[42:43], v3 offset:16896
    v_mfma_f32_32x32x16_bf16 v[64:79], v[52:55], v[236:239], v[64:79]
    ds_read_b64_tr_b16 v[44:45], v3 offset:18432
    ds_read_b64_tr_b16 v[46:47], v3 offset:18944
    v_smfmac_f32_16x16x64_bf16 v[4:7], v[16:19], v[224:231], v11
    s_waitcnt lgkmcnt(8)
    v_mfma_f32_32x32x16_bf16 v[80:95], v[56:59], v[232:235], v[80:95]
    v_xor_b32 v2, 0x00001000, v2
    ds_read_b64_tr_b16 v[48:49], v2 offset:16384
    ds_read_b64_tr_b16 v[50:51], v2 offset:16896
    v_smfmac_f32_16x16x64_bf16 v[4:7], v[16:19], v[232:239], v11
    v_mfma_f32_32x32x16_bf16 v[80:95], v[60:63], v[236:239], v[80:95]
    s_lshl2_add_u32 s58, s4, 147456
    v_add_u32 v12, s58, v13
    v_add_f32 v20, v20, v21
    ds_read_b64_tr_b16 v[52:53], v2 offset:18432
    ds_read_b64_tr_b16 v[54:55], v2 offset:18944
    v_smfmac_f32_16x16x64_bf16 v[4:7], v[16:19], v[240:247], v11
    s_waitcnt lgkmcnt(8)
    v_mfma_f32_32x32x16_bf16 v[64:79], v[32:35], v[240:243], v[64:79]
    v_add_f32 v20, v20, v0
    v_add_f32 v24, v24, v25
    v_add_f32 v24, v24, v1
    v_xor_b32 v3, 0x00001000, v3
    ds_read_b64_tr_b16 v[56:57], v3 offset:16384
    ds_read_b64_tr_b16 v[58:59], v3 offset:16896
    v_smfmac_f32_16x16x64_bf16 v[4:7], v[16:19], v[248:255], v11
    v_mfma_f32_32x32x16_bf16 v[64:79], v[36:39], v[244:247], v[64:79]
    ds_write2st64_b32 v12, v20, v24 offset0:0 offset1:4
    v_mov_b32 v20, 0
    v_mov_b32 v21, 0
    ds_read_b64_tr_b16 v[60:61], v3 offset:18432
    ds_read_b64_tr_b16 v[62:63], v3 offset:18944
    s_waitcnt lgkmcnt(9)
    v_mfma_f32_32x32x16_bf16 v[80:95], v[40:43], v[240:243], v[80:95]
    v_mov_b32 v24, 0
    v_mov_b32 v25, 0
    v_xor_b32 v2, 0x3000, v2
    v_mfma_f32_32x32x16_bf16 v[80:95], v[44:47], v[244:247], v[80:95]
    v_xor_b32 v3, 0x3000, v3
    s_waitcnt lgkmcnt(0)
    s_setprio 3
    s_barrier
    v_mfma_f32_32x32x16_bf16 v[64:79], v[48:51], v[248:251], v[64:79]
    v_mfma_f32_32x32x16_bf16 v[64:79], v[52:55], v[252:255], v[64:79]
    v_add_f32 v6, v4, v5
    v_mov_b32 v7, v8
    v_mfma_f32_32x32x16_bf16 v[80:95], v[56:59], v[248:251], v[80:95]
    v_mfma_f32_32x32x16_bf16 v[80:95], v[60:63], v[252:255], v[80:95]
LA_1:
    s_mov_b32 s44, 1
    s_cmp_eq_u32 s7, 15
    s_cbranch_scc1 LH1h
    s_sub_u32 s58, s7, 10
    s_cmp_lt_u32 s58, 5
    s_cbranch_scc0 LH1q
    v_add_u32 v12, 147456, v13
    ds_read_b128 v[32:35], v12 offset:0
    ds_read_b128 v[36:39], v12 offset:1024
    s_setprio 0
    s_mov_b32 m0, s52
    s_mul_i32 s58, s43, s100
    s_add_u32 s58, s58, s42
    buffer_load_dwordx4 v28, s[12:15], s58 offen offset:0 lds
    buffer_load_dwordx4 v29, s[12:15], s58 offen offset:1024 lds
    buffer_load_dwordx4 v30, s[12:15], s58 offen offset:2048 lds
    buffer_load_dwordx4 v31, s[12:15], s58 offen offset:3072 lds
    s_mov_b32 s12, s36
    s_mov_b32 s13, s37
    s_mov_b32 s14, 2211840
    s_movk_i32 s63, 3456
    s_lshl_b32 s64, s47, 7
    s_lshl_b32 s43, s63, 7
    s_mul_i32 s42, s4, s63
    s_lshl_b32 s42, s42, 5
    s_add_u32 s42, s42, s64
    v_lshrrev_b32 v29, 7, v13
    v_mul_u32_u24 v28, s63, v29
    v_lshrrev_b32 v29, 2, v13
    v_xor_b32 v29, v29, v13
    v_and_b32 v29, 0x40, v29
    v_and_b32 v30, 0x30, v13
    v_add3_u32 v28, v28, v29, v30
    s_lshl_b32 s63, s63, 3
    s_sub_u32 s63, s63, 1024
    v_add_u32 v29, s63, v28
    v_add_u32 v30, s63, v29
    v_add_u32 v31, s63, v30
    s_add_u32 m0, s27, 0
    s_mul_i32 s58, s43, s96
    s_add_u32 s58, s58, s42
    buffer_load_dwordx4 v28, s[12:15], s58 offen offset:0 lds
    buffer_load_dwordx4 v29, s[12:15], s58 offen offset:1024 lds
    v_permlane32_swap_b32 v6, v7
    v_add_f32 v6, v6, v7
    v_mul_f32 v6, 0x3acccccd, v6
    v_mov_b32 v7, v6
    s_nop 1
    v_permlane32_swap_b32 v6, v7
    v_fma_f32 v7, -v6, v6, v7
    v_max_f32 v7, 0, v7
    buffer_load_dwordx4 v30, s[12:15], s58 offen offset:2048 lds
    v_cvt_pk_bf16_f32 v40, v7, v7
    v_and_b32 v40, 0xffff0000, v40
    v_add_f32 v40, 0x3727c5ac, v40
    v_cvt_pk_bf16_f32 v40, v40, v40
    v_and_b32 v40, 0xffff0000, v40
    v_sqrt_f32 v40, v40
    s_nop 0
    v_cvt_pk_bf16_f32 v40, v40, v40
    v_and_b32 v40, 0xffff0000, v40
    buffer_load_dwordx4 v31, s[12:15], s58 offen offset:3072 lds
    v_rcp_f32 v41, v40
    s_lshl_b32 s62, s4, 7
    s_add_u32 s62, s62, 149504
    v_lshl_add_u32 v44, v15, 2, s62
    ds_write_b32 v44, v41
    s_cmp_lt_u32 s7, 5
    s_cselect_b32 s62, 0x3ea52b5c, 1.0
    v_mul_f32 v8, s62, v41
    v_mul_f32 v7, v7, v41
    s_add_u32 m0, s27, 16384
    s_mul_i32 s58, s43, s97
    s_add_u32 s58, s58, s42
    buffer_load_dwordx4 v28, s[12:15], s58 offen offset:0 lds
    v_mul_f32 v7, v7, v41
    v_cvt_pk_bf16_f32 v7, v7, v7
    v_and_b32 v7, 0xffff0000, v7
    v_add_f32 v7, 0x3727c5ac, v7
    v_cvt_pk_bf16_f32 v7, v7, v7
    v_and_b32 v7, 0xffff0000, v7
    buffer_load_dwordx4 v29, s[12:15], s58 offen offset:1024 lds
    v_sqrt_f32 v7, v7
    s_nop 0
    v_cvt_pk_bf16_f32 v7, v7, v7
    v_and_b32 v7, 0xffff0000, v7
    v_mul_f32 v40, v40, v7
    v_rcp_f32 v9, v40
    v_sub_f32 v41, 0, v6
    v_mul_f32 v9, v10, v9
    buffer_load_dwordx4 v30, s[12:15], s58 offen offset:2048 lds
    v_cmp_eq_u32 vcc, 0, v14
    s_nop 1
    v_cndmask_b32 v41, v40, v41, vcc
    v_cvt_pk_bf16_f32 v6, v41, v41
    v_and_b32 v40, 0xffff0000, v6
    v_sub_f32 v41, v41, v40
    v_cvt_pk_bf16_f32 v7, v41, 0
    s_lshl_b32 s62, s4, 10
    s_add_u32 s62, s62, 151552
    v_add_u32 v12, s62, v13
    ds_write_b128 v12, v[6:9]
    buffer_load_dwordx4 v31, s[12:15], s58 offen offset:3072 lds
    s_waitcnt lgkmcnt(3)
    v_add_f32 v32, v32, v33
    v_add_f32 v34, v34, v35
    v_add_f32 v32, v32, v34
    v_cvt_pk_bf16_f32 v35, v32, 0
    v_lshlrev_b32 v33, 16, v35
    v_sub_f32 v33, v32, v33
    v_cvt_pk_bf16_f32 v34, v32, v33
    s_waitcnt lgkmcnt(2)
    v_add_f32 v36, v36, v37
    s_add_u32 m0, s27, 32768
    s_mul_i32 s58, s43, s98
    s_add_u32 s58, s58, s42
    buffer_load_dwordx4 v28, s[12:15], s58 offen offset:0 lds
    v_add_f32 v38, v38, v39
    v_add_f32 v36, v36, v38
    v_cvt_pk_bf16_f32 v39, v36, 0
    v_lshlrev_b32 v37, 16, v39
    v_sub_f32 v37, v36, v37
    v_cvt_pk_bf16_f32 v38, v36, v37
    buffer_load_dwordx4 v29, s[12:15], s58 offen offset:1024 lds
    s_setprio 3
    v_mfma_f32_32x32x8_bf16 v[64:79], v[6:7], v[34:35], v[64:79]
    v_mfma_f32_32x32x8_bf16 v[80:95], v[6:7], v[38:39], v[80:95]
    s_setprio 0
    buffer_load_dwordx4 v30, s[12:15], s58 offen offset:2048 lds
    s_lshl_b32 s62, s4, 7
    s_add_u32 s62, s62, 149504
    v_lshl_add_u32 v46, v14, 4, s62
    v_mul_u32_u24 v44, 9728, v14
    v_add_u32 v44, v44, v13
    v_lshl_add_u32 v44, s46, 9, v44
    v_add_u32 v45, 20480, v44
    ds_read_b128 v[32:35], v46 offset:0
    ds_read_b128 v[36:39], v46 offset:64
    buffer_load_dwordx4 v31, s[12:15], s58 offen offset:3072 lds
    s_waitcnt lgkmcnt(1)
    v_mul_f32 v64, v32, v64
    v_mul_f32 v65, v33, v65
    v_mul_f32 v66, v34, v66
    v_mul_f32 v67, v35, v67
    s_waitcnt lgkmcnt(0)
    v_mul_f32 v72, v36, v72
    v_mul_f32 v73, v37, v73
    v_mul_f32 v74, v38, v74
    v_mul_f32 v75, v39, v75
    v_cvt_pk_bf16_f32 v40, v64, v72
    v_cvt_pk_bf16_f32 v41, v65, v73
    v_cvt_pk_bf16_f32 v42, v66, v74
    v_cvt_pk_bf16_f32 v43, v67, v75
    buffer_store_dwordx4 v[40:43], v44, s[16:19], s49 offen offset:0 sc1
    ds_read_b128 v[32:35], v46 offset:32
    ds_read_b128 v[36:39], v46 offset:96
    s_waitcnt vmcnt(13) lgkmcnt(0)
    s_barrier
    s_add_u32 m0, s27, 49152
    s_mul_i32 s58, s43, s99
    s_add_u32 s58, s58, s42
    buffer_load_dwordx4 v28, s[12:15], s58 offen offset:0 lds
    v_mul_f32 v68, v32, v68
    v_mul_f32 v69, v33, v69
    v_mul_f32 v70, v34, v70
    v_mul_f32 v71, v35, v71
    v_mul_f32 v76, v36, v76
    v_mul_f32 v77, v37, v77
    buffer_load_dwordx4 v29, s[12:15], s58 offen offset:1024 lds
    v_mul_f32 v78, v38, v78
    v_mul_f32 v79, v39, v79
    v_cvt_pk_bf16_f32 v40, v68, v76
    v_cvt_pk_bf16_f32 v41, v69, v77
    v_cvt_pk_bf16_f32 v42, v70, v78
    v_cvt_pk_bf16_f32 v43, v71, v79
    buffer_store_dwordx4 v[40:43], v45, s[16:19], s49 offen offset:0 sc1
    buffer_load_dwordx4 v30, s[12:15], s58 offen offset:2048 lds
    ds_read_b128 v[32:35], v46 offset:0
    ds_read_b128 v[36:39], v46 offset:64
    s_waitcnt lgkmcnt(1)
    v_mul_f32 v80, v32, v80
    v_mul_f32 v81, v33, v81
    v_mul_f32 v82, v34, v82
    v_mul_f32 v83, v35, v83
    s_waitcnt lgkmcnt(0)
    v_mul_f32 v88, v36, v88
    v_mul_f32 v89, v37, v89
    buffer_load_dwordx4 v31, s[12:15], s58 offen offset:3072 lds
    v_mul_f32 v90, v38, v90
    v_mul_f32 v91, v39, v91
    v_cvt_pk_bf16_f32 v40, v80, v88
    v_cvt_pk_bf16_f32 v41, v81, v89
    v_cvt_pk_bf16_f32 v42, v82, v90
    v_cvt_pk_bf16_f32 v43, v83, v91
    buffer_store_dwordx4 v[40:43], v44, s[16:19], s49 offen offset:512 sc1
    ds_read_b128 v[32:35], v46 offset:32
    ds_read_b128 v[36:39], v46 offset:96
    s_waitcnt lgkmcnt(1)
    v_mul_f32 v84, v32, v84
    v_mul_f32 v85, v33, v85
    v_mul_f32 v86, v34, v86
    v_mul_f32 v87, v35, v87
    s_waitcnt lgkmcnt(0)
    v_mul_f32 v92, v36, v92
    v_mul_f32 v93, v37, v93
    v_mul_f32 v94, v38, v94
    v_mul_f32 v95, v39, v95
    v_cvt_pk_bf16_f32 v40, v84, v92
    v_cvt_pk_bf16_f32 v41, v85, v93
    v_cvt_pk_bf16_f32 v42, v86, v94
    v_cvt_pk_bf16_f32 v43, v87, v95
    buffer_store_dwordx4 v[40:43], v45, s[16:19], s49 offen offset:512 sc1
    v_lshlrev_b32 v12, 1, v15
    v_xor_b32 v0, 1, v14
    v_add_u32 v0, s4, v0
    v_lshl_add_u32 v12, v0, 20, v12
    s_movk_i32 s22, 3456
    s_lshl_b32 s58, s47, 7
    buffer_load_short_d16_hi v0, v12, s[20:23], s58 offen offset:0
    buffer_load_short_d16_hi v1, v12, s[20:23], s58 offen offset:64
    s_waitcnt vmcnt(10) lgkmcnt(0)
    s_barrier
    s_branch LA_2
LH1h:
    v_add_u32 v12, 147456, v13
    ds_read_b128 v[32:35], v12 offset:0
    ds_read_b128 v[36:39], v12 offset:1024
    s_setprio 0
    s_mov_b32 m0, s52
    s_mul_i32 s58, s43, s100
    s_add_u32 s58, s58, s42
    buffer_load_dwordx4 v28, s[12:15], s58 offen offset:0 lds
    buffer_load_dwordx4 v29, s[12:15], s58 offen offset:1024 lds
    buffer_load_dwordx4 v30, s[12:15], s58 offen offset:2048 lds
    buffer_load_dwordx4 v31, s[12:15], s58 offen offset:3072 lds
    s_mov_b32 s12, s36
    s_mov_b32 s13, s37
    s_mov_b32 s14, 2211840
    s_movk_i32 s63, 3456
    s_lshl_b32 s64, s47, 7
    s_lshl_b32 s43, s63, 7
    s_mul_i32 s42, s4, s63
    s_lshl_b32 s42, s42, 5
    s_add_u32 s42, s42, s64
    v_lshrrev_b32 v29, 7, v13
    v_mul_u32_u24 v28, s63, v29
    v_lshrrev_b32 v29, 2, v13
    v_xor_b32 v29, v29, v13
    v_and_b32 v29, 0x40, v29
    v_and_b32 v30, 0x30, v13
    v_add3_u32 v28, v28, v29, v30
    s_lshl_b32 s63, s63, 3
    s_sub_u32 s63, s63, 1024
    v_add_u32 v29, s63, v28
    v_add_u32 v30, s63, v29
    v_add_u32 v31, s63, v30
    s_add_u32 m0, s27, 0
    s_mul_i32 s58, s43, s96
    s_add_u32 s58, s58, s42
    buffer_load_dwordx4 v28, s[12:15], s58 offen offset:0 lds
    buffer_load_dwordx4 v29, s[12:15], s58 offen offset:1024 lds
    v_permlane32_swap_b32 v6, v7
    v_add_f32 v6, v6, v7
    v_mul_f32 v6, 0x3acccccd, v6
    v_mov_b32 v7, v6
    s_nop 1
    v_permlane32_swap_b32 v6, v7
    v_fma_f32 v7, -v6, v6, v7
    v_max_f32 v7, 0, v7
    buffer_load_dwordx4 v30, s[12:15], s58 offen offset:2048 lds
    v_cvt_pk_bf16_f32 v40, v7, v7
    v_and_b32 v40, 0xffff0000, v40
    v_add_f32 v40, 0x3727c5ac, v40
    v_cvt_pk_bf16_f32 v40, v40, v40
    v_and_b32 v40, 0xffff0000, v40
    v_sqrt_f32 v40, v40
    s_nop 0
    v_cvt_pk_bf16_f32 v40, v40, v40
    v_and_b32 v40, 0xffff0000, v40
    buffer_load_dwordx4 v31, s[12:15], s58 offen offset:3072 lds
    v_rcp_f32 v41, v40
    s_cmp_lt_u32 s7, 5
    s_cselect_b32 s62, 0x3ea52b5c, 1.0
    v_mul_f32 v8, s62, v41
    v_mul_f32 v7, v7, v41
    v_mul_f32 v7, v7, v41
    v_cvt_pk_bf16_f32 v7, v7, v7
    v_and_b32 v7, 0xffff0000, v7
    s_add_u32 m0, s27, 16384
    s_mul_i32 s58, s43, s97
    s_add_u32 s58, s58, s42
    buffer_load_dwordx4 v28, s[12:15], s58 offen offset:0 lds
    v_add_f32 v7, 0x3727c5ac, v7
    v_cvt_pk_bf16_f32 v7, v7, v7
    v_and_b32 v7, 0xffff0000, v7
    v_sqrt_f32 v7, v7
    s_nop 0
    v_cvt_pk_bf16_f32 v7, v7, v7
    buffer_load_dwordx4 v29, s[12:15], s58 offen offset:1024 lds
    v_and_b32 v7, 0xffff0000, v7
    v_mul_f32 v40, v40, v7
    v_rcp_f32 v9, v40
    v_sub_f32 v41, 0, v6
    v_mul_f32 v9, v10, v9
    v_cmp_eq_u32 vcc, 0, v14
    s_nop 1
    v_cndmask_b32 v41, v40, v41, vcc
    v_cvt_pk_bf16_f32 v6, v41, v41
    buffer_load_dwordx4 v30, s[12:15], s58 offen offset:2048 lds
    v_and_b32 v40, 0xffff0000, v6
    v_sub_f32 v41, v41, v40
    v_cvt_pk_bf16_f32 v7, v41, 0
    s_lshl_b32 s62, s4, 10
    s_add_u32 s62, s62, 151552
    v_add_u32 v12, s62, v13
    ds_write_b128 v12, v[6:9]
    s_waitcnt lgkmcnt(2)
    v_add_f32 v32, v32, v33
    v_add_f32 v34, v34, v35
    buffer_load_dwordx4 v31, s[12:15], s58 offen offset:3072 lds
    v_add_f32 v32, v32, v34
    v_cvt_pk_bf16_f32 v35, v32, 0
    v_lshlrev_b32 v33, 16, v35
    v_sub_f32 v33, v32, v33
    v_cvt_pk_bf16_f32 v34, v32, v33
    s_waitcnt lgkmcnt(1)
    v_add_f32 v36, v36, v37
    v_add_f32 v38, v38, v39
    v_add_f32 v36, v36, v38
    s_add_u32 m0, s27, 32768
    s_mul_i32 s58, s43, s98
    s_add_u32 s58, s58, s42
    buffer_load_dwordx4 v28, s[12:15], s58 offen offset:0 lds
    v_cvt_pk_bf16_f32 v39, v36, 0
    v_lshlrev_b32 v37, 16, v39
    v_sub_f32 v37, v36, v37
    v_cvt_pk_bf16_f32 v38, v36, v37
    s_setprio 3
    v_mfma_f32_32x32x8_bf16 v[64:79], v[34:35], v[6:7], v[64:79]
    v_mfma_f32_32x32x8_bf16 v[80:95], v[38:39], v[6:7], v[80:95]
    s_setprio 0
    buffer_load_dwordx4 v29, s[12:15], s58 offen offset:1024 lds
    s_nop 8
    v_mul_f32 v64, v9, v64
    v_mul_f32 v65, v9, v65
    v_mul_f32 v66, v9, v66
    v_mul_f32 v67, v9, v67
    v_mul_f32 v68, v9, v68
    v_mul_f32 v69, v9, v69
    v_mul_f32 v70, v9, v70
    v_mul_f32 v71, v9, v71
    buffer_load_dwordx4 v30, s[12:15], s58 offen offset:2048 lds
    v_fmaak_f32 v32, v64, v64, 0x409d30fc
    v_fmaak_f32 v33, v65, v65, 0x409d30fc
    v_fmaak_f32 v34, v66, v66, 0x409d30fc
    v_fmaak_f32 v35, v67, v67, 0x409d30fc
    v_fmaak_f32 v36, v68, v68, 0x409d30fc
    v_fmaak_f32 v37, v69, v69, 0x409d30fc
    v_fmaak_f32 v38, v70, v70, 0x409d30fc
    v_fmaak_f32 v39, v71, v71, 0x409d30fc
    buffer_load_dwordx4 v31, s[12:15], s58 offen offset:3072 lds
    v_mul_f32 v32, v32, v64
    v_mul_f32 v33, v33, v65
    v_mul_f32 v34, v34, v66
    v_mul_f32 v35, v35, v67
    v_mul_f32 v36, v36, v68
    v_mul_f32 v37, v37, v69
    v_mul_f32 v38, v38, v70
    v_mul_f32 v39, v39, v71
    v_exp_f32 v32, v32
    v_exp_f32 v33, v33
    s_waitcnt vmcnt(12) lgkmcnt(0)
    s_barrier
    s_add_u32 m0, s27, 49152
    s_mul_i32 s58, s43, s99
    s_add_u32 s58, s58, s42
    buffer_load_dwordx4 v28, s[12:15], s58 offen offset:0 lds
    v_exp_f32 v34, v34
    v_exp_f32 v35, v35
    v_exp_f32 v36, v36
    v_exp_f32 v37, v37
    buffer_load_dwordx4 v29, s[12:15], s58 offen offset:1024 lds
    v_exp_f32 v38, v38
    v_exp_f32 v39, v39
    v_fma_f32 v32, v32, v10, v10
    v_fma_f32 v33, v33, v10, v10
    v_fma_f32 v34, v34, v10, v10
    v_fma_f32 v35, v35, v10, v10
    v_fma_f32 v36, v36, v10, v10
    buffer_load_dwordx4 v30, s[12:15], s58 offen offset:2048 lds
    v_fma_f32 v37, v37, v10, v10
    v_fma_f32 v38, v38, v10, v10
    v_fma_f32 v39, v39, v10, v10
    v_rcp_f32 v32, v32
    v_rcp_f32 v33, v33
    v_rcp_f32 v34, v34
    buffer_load_dwordx4 v31, s[12:15], s58 offen offset:3072 lds
    v_rcp_f32 v35, v35
    v_rcp_f32 v36, v36
    v_rcp_f32 v37, v37
    v_rcp_f32 v38, v38
    v_rcp_f32 v39, v39
    v_mul_f32 v64, v64, v32
    v_mul_f32 v65, v65, v33
    v_mul_f32 v66, v66, v34
    v_mul_f32 v67, v67, v35
    v_mul_f32 v68, v68, v36
    v_mul_f32 v69, v69, v37
    v_mul_f32 v70, v70, v38
    v_mul_f32 v71, v71, v39
    v_cvt_pk_bf16_f32 v40, v64, v65
    v_cvt_pk_bf16_f32 v41, v66, v67
    v_cvt_pk_bf16_f32 v42, v68, v69
    v_cvt_pk_bf16_f32 v43, v70, v71
    s_lshl_b32 s62, s46, 11
    s_add_u32 s62, s62, s50
    buffer_store_dwordx4 v[40:43], v13, s[16:19], s62 offen offset:0 sc1
    v_mul_f32 v72, v9, v72
    v_mul_f32 v73, v9, v73
    v_mul_f32 v74, v9, v74
    v_mul_f32 v75, v9, v75
    v_mul_f32 v76, v9, v76
    v_mul_f32 v77, v9, v77
    v_mul_f32 v78, v9, v78
    v_mul_f32 v79, v9, v79
    v_fmaak_f32 v32, v72, v72, 0x409d30fc
    v_fmaak_f32 v33, v73, v73, 0x409d30fc
    v_fmaak_f32 v34, v74, v74, 0x409d30fc
    v_fmaak_f32 v35, v75, v75, 0x409d30fc
    v_fmaak_f32 v36, v76, v76, 0x409d30fc
    v_fmaak_f32 v37, v77, v77, 0x409d30fc
    v_fmaak_f32 v38, v78, v78, 0x409d30fc
    v_fmaak_f32 v39, v79, v79, 0x409d30fc
    v_mul_f32 v32, v32, v72
    v_mul_f32 v33, v33, v73
    v_mul_f32 v34, v34, v74
    v_mul_f32 v35, v35, v75
    v_mul_f32 v36, v36, v76
    v_mul_f32 v37, v37, v77
    v_mul_f32 v38, v38, v78
    v_mul_f32 v39, v39, v79
    v_exp_f32 v32, v32
    v_exp_f32 v33, v33
    v_exp_f32 v34, v34
    v_exp_f32 v35, v35
    v_exp_f32 v36, v36
    v_exp_f32 v37, v37
    v_exp_f32 v38, v38
    v_exp_f32 v39, v39
    v_fma_f32 v32, v32, v10, v10
    v_fma_f32 v33, v33, v10, v10
    v_fma_f32 v34, v34, v10, v10
    v_fma_f32 v35, v35, v10, v10
    v_fma_f32 v36, v36, v10, v10
    v_fma_f32 v37, v37, v10, v10
    v_fma_f32 v38, v38, v10, v10
    v_fma_f32 v39, v39, v10, v10
    v_rcp_f32 v32, v32
    v_rcp_f32 v33, v33
    v_rcp_f32 v34, v34
    v_rcp_f32 v35, v35
    v_rcp_f32 v36, v36
    v_rcp_f32 v37, v37
    v_rcp_f32 v38, v38
    v_rcp_f32 v39, v39
    v_mul_f32 v72, v72, v32
    v_mul_f32 v73, v73, v33
    v_mul_f32 v74, v74, v34
    v_mul_f32 v75, v75, v35
    v_mul_f32 v76, v76, v36
    v_mul_f32 v77, v77, v37
    v_mul_f32 v78, v78, v38
    v_mul_f32 v79, v79, v39
    v_cvt_pk_bf16_f32 v44, v72, v73
    v_cvt_pk_bf16_f32 v45, v74, v75
    v_cvt_pk_bf16_f32 v46, v76, v77
    v_cvt_pk_bf16_f32 v47, v78, v79
    s_lshl_b32 s62, s46, 11
    s_add_u32 s62, s62, s50
    buffer_store_dwordx4 v[44:47], v13, s[16:19], s62 offen offset:1024 sc1
    v_mul_f32 v80, v9, v80
    v_mul_f32 v81, v9, v81
    v_mul_f32 v82, v9, v82
    v_mul_f32 v83, v9, v83
    v_mul_f32 v84, v9, v84
    v_mul_f32 v85, v9, v85
    v_mul_f32 v86, v9, v86
    v_mul_f32 v87, v9, v87
    v_fmaak_f32 v32, v80, v80, 0x409d30fc
    v_fmaak_f32 v33, v81, v81, 0x409d30fc
    v_fmaak_f32 v34, v82, v82, 0x409d30fc
    v_fmaak_f32 v35, v83, v83, 0x409d30fc
    v_fmaak_f32 v36, v84, v84, 0x409d30fc
    v_fmaak_f32 v37, v85, v85, 0x409d30fc
    v_fmaak_f32 v38, v86, v86, 0x409d30fc
    v_fmaak_f32 v39, v87, v87, 0x409d30fc
    v_mul_f32 v32, v32, v80
    v_mul_f32 v33, v33, v81
    v_mul_f32 v34, v34, v82
    v_mul_f32 v35, v35, v83
    v_mul_f32 v36, v36, v84
    v_mul_f32 v37, v37, v85
    v_mul_f32 v38, v38, v86
    v_mul_f32 v39, v39, v87
    v_exp_f32 v32, v32
    v_exp_f32 v33, v33
    v_exp_f32 v34, v34
    v_exp_f32 v35, v35
    v_exp_f32 v36, v36
    v_exp_f32 v37, v37
    v_exp_f32 v38, v38
    v_exp_f32 v39, v39
    v_fma_f32 v32, v32, v10, v10
    v_fma_f32 v33, v33, v10, v10
    v_fma_f32 v34, v34, v10, v10
    v_fma_f32 v35, v35, v10, v10
    v_fma_f32 v36, v36, v10, v10
    v_fma_f32 v37, v37, v10, v10
    v_fma_f32 v38, v38, v10, v10
    v_fma_f32 v39, v39, v10, v10
    v_rcp_f32 v32, v32
    v_rcp_f32 v33, v33
    v_rcp_f32 v34, v34
    v_rcp_f32 v35, v35
    v_rcp_f32 v36, v36
    v_rcp_f32 v37, v37
    v_rcp_f32 v38, v38
    v_rcp_f32 v39, v39
    v_mul_f32 v80, v80, v32
    v_mul_f32 v81, v81, v33
    v_mul_f32 v82, v82, v34
    v_mul_f32 v83, v83, v35
    v_mul_f32 v84, v84, v36
    v_mul_f32 v85, v85, v37
    v_mul_f32 v86, v86, v38
    v_mul_f32 v87, v87, v39
    v_cvt_pk_bf16_f32 v40, v80, v81
    v_cvt_pk_bf16_f32 v41, v82, v83
    v_cvt_pk_bf16_f32 v42, v84, v85
    v_cvt_pk_bf16_f32 v43, v86, v87
    s_lshl_b32 s62, s46, 11
    s_add_u32 s62, s62, s50
    buffer_store_dwordx4 v[40:43], v13, s[16:19], s62 offen offset:2048 sc1
    v_mul_f32 v88, v9, v88
    v_mul_f32 v89, v9, v89
    v_mul_f32 v90, v9, v90
    v_mul_f32 v91, v9, v91
    v_mul_f32 v92, v9, v92
    v_mul_f32 v93, v9, v93
    v_mul_f32 v94, v9, v94
    v_mul_f32 v95, v9, v95
    v_fmaak_f32 v32, v88, v88, 0x409d30fc
    v_fmaak_f32 v33, v89, v89, 0x409d30fc
    v_fmaak_f32 v34, v90, v90, 0x409d30fc
    v_fmaak_f32 v35, v91, v91, 0x409d30fc
    v_fmaak_f32 v36, v92, v92, 0x409d30fc
    v_fmaak_f32 v37, v93, v93, 0x409d30fc
    v_fmaak_f32 v38, v94, v94, 0x409d30fc
    v_fmaak_f32 v39, v95, v95, 0x409d30fc
    v_mul_f32 v32, v32, v88
    v_mul_f32 v33, v33, v89
    v_mul_f32 v34, v34, v90
    v_mul_f32 v35, v35, v91
    v_mul_f32 v36, v36, v92
    v_mul_f32 v37, v37, v93
    v_mul_f32 v38, v38, v94
    v_mul_f32 v39, v39, v95
    v_exp_f32 v32, v32
    v_exp_f32 v33, v33
    v_exp_f32 v34, v34
    v_exp_f32 v35, v35
    v_exp_f32 v36, v36
    v_exp_f32 v37, v37
    v_exp_f32 v38, v38
    v_exp_f32 v39, v39
    v_fma_f32 v32, v32, v10, v10
    v_fma_f32 v33, v33, v10, v10
    v_fma_f32 v34, v34, v10, v10
    v_fma_f32 v35, v35, v10, v10
    v_fma_f32 v36, v36, v10, v10
    v_fma_f32 v37, v37, v10, v10
    v_fma_f32 v38, v38, v10, v10
    v_fma_f32 v39, v39, v10, v10
    v_rcp_f32 v32, v32
    v_rcp_f32 v33, v33
    v_rcp_f32 v34, v34
    v_rcp_f32 v35, v35
    v_rcp_f32 v36, v36
    v_rcp_f32 v37, v37
    v_rcp_f32 v38, v38
    v_rcp_f32 v39, v39
    v_mul_f32 v88, v88, v32
    v_mul_f32 v89, v89, v33
    v_mul_f32 v90, v90, v34
    v_mul_f32 v91, v91, v35
    v_mul_f32 v92, v92, v36
    v_mul_f32 v93, v93, v37
    v_mul_f32 v94, v94, v38
    v_mul_f32 v95, v95, v39
    v_cvt_pk_bf16_f32 v44, v88, v89
    v_cvt_pk_bf16_f32 v45, v90, v91
    v_cvt_pk_bf16_f32 v46, v92, v93
    v_cvt_pk_bf16_f32 v47, v94, v95
    s_lshl_b32 s62, s46, 11
    s_add_u32 s62, s62, s50
    buffer_store_dwordx4 v[44:47], v13, s[16:19], s62 offen offset:3072 sc1
    v_lshlrev_b32 v12, 1, v15
    v_xor_b32 v0, 1, v14
    v_add_u32 v0, s4, v0
    v_lshl_add_u32 v12, v0, 20, v12
    s_movk_i32 s22, 3456
    s_lshl_b32 s58, s47, 7
    buffer_load_short_d16_hi v0, v12, s[20:23], s58 offen offset:0
    buffer_load_short_d16_hi v1, v12, s[20:23], s58 offen offset:64
    s_waitcnt vmcnt(10) lgkmcnt(0)
    s_barrier
    s_branch LA_2
LH1q:
    v_add_u32 v12, 147456, v13
    ds_read_b128 v[32:35], v12 offset:0
    ds_read_b128 v[36:39], v12 offset:1024
    s_setprio 0
    s_mov_b32 m0, s52
    s_mul_i32 s58, s43, s100
    s_add_u32 s58, s58, s42
    buffer_load_dwordx4 v28, s[12:15], s58 offen offset:0 lds
    buffer_load_dwordx4 v29, s[12:15], s58 offen offset:1024 lds
    buffer_load_dwordx4 v30, s[12:15], s58 offen offset:2048 lds
    buffer_load_dwordx4 v31, s[12:15], s58 offen offset:3072 lds
    s_mov_b32 s12, s36
    s_mov_b32 s13, s37
    s_mov_b32 s14, 2211840
    s_movk_i32 s63, 3456
    s_lshl_b32 s64, s47, 7
    s_lshl_b32 s43, s63, 7
    s_mul_i32 s42, s4, s63
    s_lshl_b32 s42, s42, 5
    s_add_u32 s42, s42, s64
    v_lshrrev_b32 v29, 7, v13
    v_mul_u32_u24 v28, s63, v29
    v_lshrrev_b32 v29, 2, v13
    v_xor_b32 v29, v29, v13
    v_and_b32 v29, 0x40, v29
    v_and_b32 v30, 0x30, v13
    v_add3_u32 v28, v28, v29, v30
    s_lshl_b32 s63, s63, 3
    s_sub_u32 s63, s63, 1024
    v_add_u32 v29, s63, v28
    v_add_u32 v30, s63, v29
    v_add_u32 v31, s63, v30
    s_add_u32 m0, s27, 0
    s_mul_i32 s58, s43, s96
    s_add_u32 s58, s58, s42
    buffer_load_dwordx4 v28, s[12:15], s58 offen offset:0 lds
    buffer_load_dwordx4 v29, s[12:15], s58 offen offset:1024 lds
    v_permlane32_swap_b32 v6, v7
    v_add_f32 v6, v6, v7
    v_mul_f32 v6, 0x3acccccd, v6
    v_mov_b32 v7, v6
    s_nop 1
    v_permlane32_swap_b32 v6, v7
    v_fma_f32 v7, -v6, v6, v7
    v_max_f32 v7, 0, v7
    buffer_load_dwordx4 v30, s[12:15], s58 offen offset:2048 lds
    v_cvt_pk_bf16_f32 v40, v7, v7
    v_and_b32 v40, 0xffff0000, v40
    v_add_f32 v40, 0x3727c5ac, v40
    v_cvt_pk_bf16_f32 v40, v40, v40
    v_and_b32 v40, 0xffff0000, v40
    v_sqrt_f32 v40, v40
    s_nop 0
    v_cvt_pk_bf16_f32 v40, v40, v40
    v_and_b32 v40, 0xffff0000, v40
    buffer_load_dwordx4 v31, s[12:15], s58 offen offset:3072 lds
    v_rcp_f32 v41, v40
    s_cmp_lt_u32 s7, 5
    s_cselect_b32 s62, 0x3ea52b5c, 1.0
    v_mul_f32 v8, s62, v41
    v_mul_f32 v7, v7, v41
    v_mul_f32 v7, v7, v41
    v_cvt_pk_bf16_f32 v7, v7, v7
    v_and_b32 v7, 0xffff0000, v7
    s_add_u32 m0, s27, 16384
    s_mul_i32 s58, s43, s97
    s_add_u32 s58, s58, s42
    buffer_load_dwordx4 v28, s[12:15], s58 offen offset:0 lds
    v_add_f32 v7, 0x3727c5ac, v7
    v_cvt_pk_bf16_f32 v7, v7, v7
    v_and_b32 v7, 0xffff0000, v7
    v_sqrt_f32 v7, v7
    s_nop 0
    v_cvt_pk_bf16_f32 v7, v7, v7
    buffer_load_dwordx4 v29, s[12:15], s58 offen offset:1024 lds
    v_and_b32 v7, 0xffff0000, v7
    v_mul_f32 v40, v40, v7
    v_rcp_f32 v9, v40
    v_sub_f32 v41, 0, v6
    v_mul_f32 v9, v10, v9
    v_cmp_eq_u32 vcc, 0, v14
    s_nop 1
    v_cndmask_b32 v41, v40, v41, vcc
    v_cvt_pk_bf16_f32 v6, v41, v41
    buffer_load_dwordx4 v30, s[12:15], s58 offen offset:2048 lds
    v_and_b32 v40, 0xffff0000, v6
    v_sub_f32 v41, v41, v40
    v_cvt_pk_bf16_f32 v7, v41, 0
    s_lshl_b32 s62, s4, 10
    s_add_u32 s62, s62, 151552
    v_add_u32 v12, s62, v13
    ds_write_b128 v12, v[6:9]
    s_waitcnt lgkmcnt(2)
    v_add_f32 v32, v32, v33
    v_add_f32 v34, v34, v35
    buffer_load_dwordx4 v31, s[12:15], s58 offen offset:3072 lds
    v_add_f32 v32, v32, v34
    v_cvt_pk_bf16_f32 v35, v32, 0
    v_lshlrev_b32 v33, 16, v35
    v_sub_f32 v33, v32, v33
    v_cvt_pk_bf16_f32 v34, v32, v33
    s_waitcnt lgkmcnt(1)
    v_add_f32 v36, v36, v37
    v_add_f32 v38, v38, v39
    v_add_f32 v36, v36, v38
    s_add_u32 m0, s27, 32768
    s_mul_i32 s58, s43, s98
    s_add_u32 s58, s58, s42
    buffer_load_dwordx4 v28, s[12:15], s58 offen offset:0 lds
    v_cvt_pk_bf16_f32 v39, v36, 0
    v_lshlrev_b32 v37, 16, v39
    v_sub_f32 v37, v36, v37
    v_cvt_pk_bf16_f32 v38, v36, v37
    s_setprio 3
    v_mfma_f32_32x32x8_bf16 v[64:79], v[34:35], v[6:7], v[64:79]
    v_mfma_f32_32x32x8_bf16 v[80:95], v[38:39], v[6:7], v[80:95]
    s_setprio 0
    buffer_load_dwordx4 v29, s[12:15], s58 offen offset:1024 lds
    v_bfe_u32 v32, v13, 8, 1
    v_lshl_add_u32 v32, v32, 1, v14
    v_lshl_add_u32 v32, s46, 3, v32
    v_and_b32 v33, 0xf0, v13
    v_lshl_add_u32 v33, v32, 9, v33
    v_mul_u32_u24 v32, 13108, v32
    v_lshrrev_b32 v34, 16, v32
    v_mul_u32_u24 v34, 79360, v34
    buffer_load_dwordx4 v30, s[12:15], s58 offen offset:2048 lds
    v_add_u32 v34, v34, v33
    v_add_u32 v32, 52432, v32
    v_mul_f32 v64, v8, v64
    v_mul_f32 v65, v8, v65
    v_mul_f32 v66, v8, v66
    v_mul_f32 v67, v8, v67
    v_mul_f32 v68, v8, v68
    v_mul_f32 v69, v8, v69
    buffer_load_dwordx4 v31, s[12:15], s58 offen offset:3072 lds
    v_mul_f32 v70, v8, v70
    v_mul_f32 v71, v8, v71
    v_cvt_pk_bf16_f32 v40, v64, v65
    v_cvt_pk_bf16_f32 v42, v68, v69
    v_cvt_pk_bf16_f32 v41, v66, v67
    v_cvt_pk_bf16_f32 v43, v70, v71
    v_permlane16_swap_b32 v40, v42
    s_nop 0
    v_permlane16_swap_b32 v41, v43
    buffer_store_dwordx4 v[40:43], v34, s[16:19], s48 offen offset:0 sc1
    v_lshrrev_b32 v35, 16, v32
    s_waitcnt vmcnt(13) lgkmcnt(0)
    s_barrier
    s_add_u32 m0, s27, 49152
    s_mul_i32 s58, s43, s99
    s_add_u32 s58, s58, s42
    buffer_load_dwordx4 v28, s[12:15], s58 offen offset:0 lds
    v_mul_u32_u24 v35, 79360, v35
    v_add_u32 v35, v35, v33
    v_add_u32 v32, 52432, v32
    v_add_u32 v33, 4096, v33
    v_mul_f32 v72, v8, v72
    v_mul_f32 v73, v8, v73
    buffer_load_dwordx4 v29, s[12:15], s58 offen offset:1024 lds
    v_mul_f32 v74, v8, v74
    v_mul_f32 v75, v8, v75
    v_mul_f32 v76, v8, v76
    v_mul_f32 v77, v8, v77
    v_mul_f32 v78, v8, v78
    v_mul_f32 v79, v8, v79
    v_cvt_pk_bf16_f32 v44, v72, v73
    v_cvt_pk_bf16_f32 v46, v76, v77
    buffer_load_dwordx4 v30, s[12:15], s58 offen offset:2048 lds
    v_cvt_pk_bf16_f32 v45, v74, v75
    v_cvt_pk_bf16_f32 v47, v78, v79
    v_permlane16_swap_b32 v44, v46
    s_nop 0
    v_permlane16_swap_b32 v45, v47
    buffer_store_dwordx4 v[44:47], v35, s[16:19], s48 offen offset:2048 sc1
    v_lshrrev_b32 v34, 16, v32
    buffer_load_dwordx4 v31, s[12:15], s58 offen offset:3072 lds
    v_mul_u32_u24 v34, 79360, v34
    v_add_u32 v34, v34, v33
    v_add_u32 v32, 52432, v32
    v_mul_f32 v80, v8, v80
    v_mul_f32 v81, v8, v81
    v_mul_f32 v82, v8, v82
    v_mul_f32 v83, v8, v83
    v_mul_f32 v84, v8, v84
    v_mul_f32 v85, v8, v85
    v_mul_f32 v86, v8, v86
    v_mul_f32 v87, v8, v87
    v_cvt_pk_bf16_f32 v40, v80, v81
    v_cvt_pk_bf16_f32 v42, v84, v85
    v_cvt_pk_bf16_f32 v41, v82, v83
    v_cvt_pk_bf16_f32 v43, v86, v87
    v_permlane16_swap_b32 v40, v42
    s_nop 0
    v_permlane16_swap_b32 v41, v43
    buffer_store_dwordx4 v[40:43], v34, s[16:19], s48 offen offset:0 sc1
    v_lshrrev_b32 v35, 16, v32
    v_mul_u32_u24 v35, 79360, v35
    v_add_u32 v35, v35, v33
    v_mul_f32 v88, v8, v88
    v_mul_f32 v89, v8, v89
    v_mul_f32 v90, v8, v90
    v_mul_f32 v91, v8, v91
    v_mul_f32 v92, v8, v92
    v_mul_f32 v93, v8, v93
    v_mul_f32 v94, v8, v94
    v_mul_f32 v95, v8, v95
    v_cvt_pk_bf16_f32 v44, v88, v89
    v_cvt_pk_bf16_f32 v46, v92, v93
    v_cvt_pk_bf16_f32 v45, v90, v91
    v_cvt_pk_bf16_f32 v47, v94, v95
    v_permlane16_swap_b32 v44, v46
    s_nop 0
    v_permlane16_swap_b32 v45, v47
    buffer_store_dwordx4 v[44:47], v35, s[16:19], s48 offen offset:2048 sc1
    v_lshlrev_b32 v12, 1, v15
    v_xor_b32 v0, 1, v14
    v_add_u32 v0, s4, v0
    v_lshl_add_u32 v12, v0, 20, v12
    s_movk_i32 s22, 3456
    s_lshl_b32 s58, s47, 7
    buffer_load_short_d16_hi v0, v12, s[20:23], s58 offen offset:0
    buffer_load_short_d16_hi v1, v12, s[20:23], s58 offen offset:64
    s_waitcnt vmcnt(10) lgkmcnt(0)
    s_barrier
LA_2:
    s_mov_b32 s44, 2
    s_branch LC
LA_3:
    s_mov_b32 s44, 3
    s_lshl_b32 s46, s47, 1
    s_cmp_eq_u32 s45, 4
    s_cbranch_scc1 LA_h3
    v_add_u32 v12, 147456, v13
    ds_read_b128 v[32:35], v12 offset:0
    ds_read_b128 v[36:39], v12 offset:1024
    s_waitcnt lgkmcnt(1)
    v_add_f32 v32, v32, v33
    v_add_f32 v34, v34, v35
    v_add_f32 v32, v32, v34
    v_cvt_pk_bf16_f32 v35, v32, 0
    v_lshlrev_b32 v33, 16, v35
    v_sub_f32 v33, v32, v33
    v_cvt_pk_bf16_f32 v34, v32, v33
    s_waitcnt lgkmcnt(0)
    v_add_f32 v36, v36, v37
    v_add_f32 v38, v38, v39
    v_add_f32 v36, v36, v38
    v_cvt_pk_bf16_f32 v39, v36, 0
    v_lshlrev_b32 v37, 16, v39
    v_sub_f32 v37, v36, v37
    v_cvt_pk_bf16_f32 v38, v36, v37
    v_mfma_f32_32x32x8_bf16 v[64:79], v[34:35], v[6:7], v[64:79]
    s_nop 0
    v_mfma_f32_32x32x8_bf16 v[80:95], v[38:39], v[6:7], v[80:95]
    s_nop 9
    v_mul_f32 v64, v9, v64
    v_mul_f32 v65, v9, v65
    v_mul_f32 v66, v9, v66
    v_mul_f32 v67, v9, v67
    v_mul_f32 v68, v9, v68
    v_mul_f32 v69, v9, v69
    v_mul_f32 v70, v9, v70
    v_mul_f32 v71, v9, v71
    v_fmaak_f32 v32, v64, v64, 0x409d30fc
    v_fmaak_f32 v33, v65, v65, 0x409d30fc
    v_fmaak_f32 v34, v66, v66, 0x409d30fc
    v_fmaak_f32 v35, v67, v67, 0x409d30fc
    v_fmaak_f32 v36, v68, v68, 0x409d30fc
    v_fmaak_f32 v37, v69, v69, 0x409d30fc
    v_fmaak_f32 v38, v70, v70, 0x409d30fc
    v_fmaak_f32 v39, v71, v71, 0x409d30fc
    v_mul_f32 v32, v32, v64
    v_mul_f32 v33, v33, v65
    v_mul_f32 v34, v34, v66
    v_mul_f32 v35, v35, v67
    v_mul_f32 v36, v36, v68
    v_mul_f32 v37, v37, v69
    v_mul_f32 v38, v38, v70
    v_mul_f32 v39, v39, v71
    v_exp_f32 v32, v32
    v_exp_f32 v33, v33
    v_exp_f32 v34, v34
    v_exp_f32 v35, v35
    v_exp_f32 v36, v36
    v_exp_f32 v37, v37
    v_exp_f32 v38, v38
    v_exp_f32 v39, v39
    v_fma_f32 v32, v32, v10, v10
    v_fma_f32 v33, v33, v10, v10
    v_fma_f32 v34, v34, v10, v10
    v_fma_f32 v35, v35, v10, v10
    v_fma_f32 v36, v36, v10, v10
    v_fma_f32 v37, v37, v10, v10
    v_fma_f32 v38, v38, v10, v10
    v_fma_f32 v39, v39, v10, v10
    v_rcp_f32 v32, v32
    v_rcp_f32 v33, v33
    v_rcp_f32 v34, v34
    v_rcp_f32 v35, v35
    v_rcp_f32 v36, v36
    v_rcp_f32 v37, v37
    v_rcp_f32 v38, v38
    v_rcp_f32 v39, v39
    v_mul_f32 v64, v64, v32
    v_mul_f32 v65, v65, v33
    v_mul_f32 v66, v66, v34
    v_mul_f32 v67, v67, v35
    v_mul_f32 v68, v68, v36
    v_mul_f32 v69, v69, v37
    v_mul_f32 v70, v70, v38
    v_mul_f32 v71, v71, v39
    v_cvt_pk_bf16_f32 v40, v64, v65
    v_cvt_pk_bf16_f32 v41, v66, v67
    v_cvt_pk_bf16_f32 v42, v68, v69
    v_cvt_pk_bf16_f32 v43, v70, v71
    s_lshl_b32 s62, s46, 11
    s_add_u32 s62, s62, s50
    buffer_store_dwordx4 v[40:43], v13, s[16:19], s62 offen offset:0 sc1
    v_mul_f32 v72, v9, v72
    v_mul_f32 v73, v9, v73
    v_mul_f32 v74, v9, v74
    v_mul_f32 v75, v9, v75
    v_mul_f32 v76, v9, v76
    v_mul_f32 v77, v9, v77
    v_mul_f32 v78, v9, v78
    v_mul_f32 v79, v9, v79
    v_fmaak_f32 v32, v72, v72, 0x409d30fc
    v_fmaak_f32 v33, v73, v73, 0x409d30fc
    v_fmaak_f32 v34, v74, v74, 0x409d30fc
    v_fmaak_f32 v35, v75, v75, 0x409d30fc
    v_fmaak_f32 v36, v76, v76, 0x409d30fc
    v_fmaak_f32 v37, v77, v77, 0x409d30fc
    v_fmaak_f32 v38, v78, v78, 0x409d30fc
    v_fmaak_f32 v39, v79, v79, 0x409d30fc
    v_mul_f32 v32, v32, v72
    v_mul_f32 v33, v33, v73
    v_mul_f32 v34, v34, v74
    v_mul_f32 v35, v35, v75
    v_mul_f32 v36, v36, v76
    v_mul_f32 v37, v37, v77
    v_mul_f32 v38, v38, v78
    v_mul_f32 v39, v39, v79
    v_exp_f32 v32, v32
    v_exp_f32 v33, v33
    v_exp_f32 v34, v34
    v_exp_f32 v35, v35
    v_exp_f32 v36, v36
    v_exp_f32 v37, v37
    v_exp_f32 v38, v38
    v_exp_f32 v39, v39
    v_fma_f32 v32, v32, v10, v10
    v_fma_f32 v33, v33, v10, v10
    v_fma_f32 v34, v34, v10, v10
    v_fma_f32 v35, v35, v10, v10
    v_fma_f32 v36, v36, v10, v10
    v_fma_f32 v37, v37, v10, v10
    v_fma_f32 v38, v38, v10, v10
    v_fma_f32 v39, v39, v10, v10
    v_rcp_f32 v32, v32
    v_rcp_f32 v33, v33
    v_rcp_f32 v34, v34
    v_rcp_f32 v35, v35
    v_rcp_f32 v36, v36
    v_rcp_f32 v37, v37
    v_rcp_f32 v38, v38
    v_rcp_f32 v39, v39
    v_mul_f32 v72, v72, v32
    v_mul_f32 v73, v73, v33
    v_mul_f32 v74, v74, v34
    v_mul_f32 v75, v75, v35
    v_mul_f32 v76, v76, v36
    v_mul_f32 v77, v77, v37
    v_mul_f32 v78, v78, v38
    v_mul_f32 v79, v79, v39
    v_cvt_pk_bf16_f32 v44, v72, v73
    v_cvt_pk_bf16_f32 v45, v74, v75
    v_cvt_pk_bf16_f32 v46, v76, v77
    v_cvt_pk_bf16_f32 v47, v78, v79
    s_lshl_b32 s62, s46, 11
    s_add_u32 s62, s62, s50
    buffer_store_dwordx4 v[44:47], v13, s[16:19], s62 offen offset:1024 sc1
    v_mul_f32 v80, v9, v80
    v_mul_f32 v81, v9, v81
    v_mul_f32 v82, v9, v82
    v_mul_f32 v83, v9, v83
    v_mul_f32 v84, v9, v84
    v_mul_f32 v85, v9, v85
    v_mul_f32 v86, v9, v86
    v_mul_f32 v87, v9, v87
    v_fmaak_f32 v32, v80, v80, 0x409d30fc
    v_fmaak_f32 v33, v81, v81, 0x409d30fc
    v_fmaak_f32 v34, v82, v82, 0x409d30fc
    v_fmaak_f32 v35, v83, v83, 0x409d30fc
    v_fmaak_f32 v36, v84, v84, 0x409d30fc
    v_fmaak_f32 v37, v85, v85, 0x409d30fc
    v_fmaak_f32 v38, v86, v86, 0x409d30fc
    v_fmaak_f32 v39, v87, v87, 0x409d30fc
    v_mul_f32 v32, v32, v80
    v_mul_f32 v33, v33, v81
    v_mul_f32 v34, v34, v82
    v_mul_f32 v35, v35, v83
    v_mul_f32 v36, v36, v84
    v_mul_f32 v37, v37, v85
    v_mul_f32 v38, v38, v86
    v_mul_f32 v39, v39, v87
    v_exp_f32 v32, v32
    v_exp_f32 v33, v33
    v_exp_f32 v34, v34
    v_exp_f32 v35, v35
    v_exp_f32 v36, v36
    v_exp_f32 v37, v37
    v_exp_f32 v38, v38
    v_exp_f32 v39, v39
    v_fma_f32 v32, v32, v10, v10
    v_fma_f32 v33, v33, v10, v10
    v_fma_f32 v34, v34, v10, v10
    v_fma_f32 v35, v35, v10, v10
    v_fma_f32 v36, v36, v10, v10
    v_fma_f32 v37, v37, v10, v10
    v_fma_f32 v38, v38, v10, v10
    v_fma_f32 v39, v39, v10, v10
    v_rcp_f32 v32, v32
    v_rcp_f32 v33, v33
    v_rcp_f32 v34, v34
    v_rcp_f32 v35, v35
    v_rcp_f32 v36, v36
    v_rcp_f32 v37, v37
    v_rcp_f32 v38, v38
    v_rcp_f32 v39, v39
    v_mul_f32 v80, v80, v32
    v_mul_f32 v81, v81, v33
    v_mul_f32 v82, v82, v34
    v_mul_f32 v83, v83, v35
    v_mul_f32 v84, v84, v36
    v_mul_f32 v85, v85, v37
    v_mul_f32 v86, v86, v38
    v_mul_f32 v87, v87, v39
    v_cvt_pk_bf16_f32 v40, v80, v81
    v_cvt_pk_bf16_f32 v41, v82, v83
    v_cvt_pk_bf16_f32 v42, v84, v85
    v_cvt_pk_bf16_f32 v43, v86, v87
    s_lshl_b32 s62, s46, 11
    s_add_u32 s62, s62, s50
    buffer_store_dwordx4 v[40:43], v13, s[16:19], s62 offen offset:2048 sc1
    v_mul_f32 v88, v9, v88
    v_mul_f32 v89, v9, v89
    v_mul_f32 v90, v9, v90
    v_mul_f32 v91, v9, v91
    v_mul_f32 v92, v9, v92
    v_mul_f32 v93, v9, v93
    v_mul_f32 v94, v9, v94
    v_mul_f32 v95, v9, v95
    v_fmaak_f32 v32, v88, v88, 0x409d30fc
    v_fmaak_f32 v33, v89, v89, 0x409d30fc
    v_fmaak_f32 v34, v90, v90, 0x409d30fc
    v_fmaak_f32 v35, v91, v91, 0x409d30fc
    v_fmaak_f32 v36, v92, v92, 0x409d30fc
    v_fmaak_f32 v37, v93, v93, 0x409d30fc
    v_fmaak_f32 v38, v94, v94, 0x409d30fc
    v_fmaak_f32 v39, v95, v95, 0x409d30fc
    v_mul_f32 v32, v32, v88
    v_mul_f32 v33, v33, v89
    v_mul_f32 v34, v34, v90
    v_mul_f32 v35, v35, v91
    v_mul_f32 v36, v36, v92
    v_mul_f32 v37, v37, v93
    v_mul_f32 v38, v38, v94
    v_mul_f32 v39, v39, v95
    v_exp_f32 v32, v32
    v_exp_f32 v33, v33
    v_exp_f32 v34, v34
    v_exp_f32 v35, v35
    v_exp_f32 v36, v36
    v_exp_f32 v37, v37
    v_exp_f32 v38, v38
    v_exp_f32 v39, v39
    v_fma_f32 v32, v32, v10, v10
    v_fma_f32 v33, v33, v10, v10
    v_fma_f32 v34, v34, v10, v10
    v_fma_f32 v35, v35, v10, v10
    v_fma_f32 v36, v36, v10, v10
    v_fma_f32 v37, v37, v10, v10
    v_fma_f32 v38, v38, v10, v10
    v_fma_f32 v39, v39, v10, v10
    v_rcp_f32 v32, v32
    v_rcp_f32 v33, v33
    v_rcp_f32 v34, v34
    v_rcp_f32 v35, v35
    v_rcp_f32 v36, v36
    v_rcp_f32 v37, v37
    v_rcp_f32 v38, v38
    v_rcp_f32 v39, v39
    v_mul_f32 v88, v88, v32
    v_mul_f32 v89, v89, v33
    v_mul_f32 v90, v90, v34
    v_mul_f32 v91, v91, v35
    v_mul_f32 v92, v92, v36
    v_mul_f32 v93, v93, v37
    v_mul_f32 v94, v94, v38
    v_mul_f32 v95, v95, v39
    v_cvt_pk_bf16_f32 v44, v88, v89
    v_cvt_pk_bf16_f32 v45, v90, v91
    v_cvt_pk_bf16_f32 v46, v92, v93
    v_cvt_pk_bf16_f32 v47, v94, v95
    s_lshl_b32 s62, s46, 11
    s_add_u32 s62, s62, s50
    buffer_store_dwordx4 v[44:47], v13, s[16:19], s62 offen offset:3072 sc1
    s_barrier
    s_branch LA_att
LA_h3:
    v_add_u32 v12, 147456, v13
    ds_read_b128 v[32:35], v12 offset:0
    ds_read_b128 v[36:39], v12 offset:1024
    s_setprio 0
    s_add_u32 s42, s42, 128
    s_mov_b32 m0, s52
    s_mul_i32 s58, s43, s100
    s_add_u32 s58, s58, s42
    buffer_load_dwordx4 v28, s[12:15], s58 offen offset:0 lds
    buffer_load_dwordx4 v29, s[12:15], s58 offen offset:1024 lds
    buffer_load_dwordx4 v30, s[12:15], s58 offen offset:2048 lds
    buffer_load_dwordx4 v31, s[12:15], s58 offen offset:3072 lds
    s_waitcnt lgkmcnt(1)
    v_add_f32 v32, v32, v33
    v_add_f32 v34, v34, v35
    v_add_f32 v32, v32, v34
    v_cvt_pk_bf16_f32 v35, v32, 0
    v_lshlrev_b32 v33, 16, v35
    v_sub_f32 v33, v32, v33
    v_cvt_pk_bf16_f32 v34, v32, v33
    s_waitcnt lgkmcnt(0)
    v_add_f32 v36, v36, v37
    v_add_f32 v38, v38, v39
    v_add_f32 v36, v36, v38
    v_cvt_pk_bf16_f32 v39, v36, 0
    v_lshlrev_b32 v37, 16, v39
    v_sub_f32 v37, v36, v37
    v_cvt_pk_bf16_f32 v38, v36, v37
    s_setprio 3
    v_mfma_f32_32x32x8_bf16 v[64:79], v[34:35], v[6:7], v[64:79]
    v_mfma_f32_32x32x8_bf16 v[80:95], v[38:39], v[6:7], v[80:95]
    s_setprio 0
    s_nop 9
    v_mul_f32 v64, v9, v64
    v_mul_f32 v65, v9, v65
    v_mul_f32 v66, v9, v66
    v_mul_f32 v67, v9, v67
    v_mul_f32 v68, v9, v68
    v_mul_f32 v69, v9, v69
    v_mul_f32 v70, v9, v70
    v_mul_f32 v71, v9, v71
    v_fmaak_f32 v32, v64, v64, 0x409d30fc
    v_fmaak_f32 v33, v65, v65, 0x409d30fc
    v_fmaak_f32 v34, v66, v66, 0x409d30fc
    v_lshrrev_b32 v101, 6, v13
    v_min_u32 v101, 5, v101
    v_and_b32 v102, 1, v101
    v_mul_u32_u24 v102, 19, v102
    v_lshrrev_b32 v101, 1, v101
    v_mul_u32_u24 v100, 640, v101
    s_mul_i32 s61, s54, 20
    s_add_u32 s61, s61, 640
    v_add3_u32 v100, v100, v102, s61
    v_lshrrev_b32 v100, 7, v100
    v_bfe_u32 v102, v13, 4, 2
    v_lshl_add_u32 v100, v100, 4, v102
    v_and_b32 v103, 0xfffffffd, v100
    s_lshl_b32 s61, s55, 1
    s_sub_u32 s61, s61, 240
    v_add_u32 v103, s61, v103
    v_cmp_eq_u32 vcc, 2, v101
    s_nop 1
    v_cndmask_b32 v100, v100, v103, vcc
    v_lshlrev_b32 v100, 7, v100
    s_mov_b32 s61, 0x01cc0000
    buffer_load_dwordx4 v[96:99], v100, s[16:19], s61 offen sc1
    v_fmaak_f32 v35, v67, v67, 0x409d30fc
    v_fmaak_f32 v36, v68, v68, 0x409d30fc
    v_fmaak_f32 v37, v69, v69, 0x409d30fc
    v_fmaak_f32 v38, v70, v70, 0x409d30fc
    v_fmaak_f32 v39, v71, v71, 0x409d30fc
    v_mul_f32 v32, v32, v64
    v_mul_f32 v33, v33, v65
    v_mul_f32 v34, v34, v66
    v_mul_f32 v35, v35, v67
    v_mul_f32 v36, v36, v68
    v_mul_f32 v37, v37, v69
    v_mul_f32 v38, v38, v70
    v_mul_f32 v39, v39, v71
    v_exp_f32 v32, v32
    v_exp_f32 v33, v33
    v_exp_f32 v34, v34
    v_exp_f32 v35, v35
    v_exp_f32 v36, v36
    v_exp_f32 v37, v37
    v_exp_f32 v38, v38
    v_exp_f32 v39, v39
    v_fma_f32 v32, v32, v10, v10
    v_fma_f32 v33, v33, v10, v10
    v_fma_f32 v34, v34, v10, v10
    v_fma_f32 v35, v35, v10, v10
    v_fma_f32 v36, v36, v10, v10
    v_fma_f32 v37, v37, v10, v10
    v_fma_f32 v38, v38, v10, v10
    v_fma_f32 v39, v39, v10, v10
    v_rcp_f32 v32, v32
    v_rcp_f32 v33, v33
    v_rcp_f32 v34, v34
    v_rcp_f32 v35, v35
    v_rcp_f32 v36, v36
    v_rcp_f32 v37, v37
    v_rcp_f32 v38, v38
    v_rcp_f32 v39, v39
    v_mul_f32 v64, v64, v32
    v_mul_f32 v65, v65, v33
    v_mul_f32 v66, v66, v34
    v_mul_f32 v67, v67, v35
    v_mul_f32 v68, v68, v36
    v_mul_f32 v69, v69, v37
    v_mul_f32 v70, v70, v38
    v_mul_f32 v71, v71, v39
    v_cvt_pk_bf16_f32 v168, v64, v65
    v_cvt_pk_bf16_f32 v169, v66, v67
    v_cvt_pk_bf16_f32 v170, v68, v69
    v_cvt_pk_bf16_f32 v171, v70, v71
    v_mul_f32 v72, v9, v72
    v_mul_f32 v73, v9, v73
    v_mul_f32 v74, v9, v74
    v_mul_f32 v75, v9, v75
    v_mul_f32 v76, v9, v76
    v_mul_f32 v77, v9, v77
    v_mul_f32 v78, v9, v78
    v_mul_f32 v79, v9, v79
    v_fmaak_f32 v32, v72, v72, 0x409d30fc
    v_fmaak_f32 v33, v73, v73, 0x409d30fc
    v_fmaak_f32 v34, v74, v74, 0x409d30fc
    v_fmaak_f32 v35, v75, v75, 0x409d30fc
    v_fmaak_f32 v36, v76, v76, 0x409d30fc
    v_fmaak_f32 v37, v77, v77, 0x409d30fc
    v_fmaak_f32 v38, v78, v78, 0x409d30fc
    s_mul_i32 s66, s4, 5120
    s_mul_i32 s67, s54, 81920
    s_mul_i32 s64, s4, 3072
    s_mul_i32 s65, s55, 10240
    s_add_u32 s65, s65, s67
    s_add_u32 s65, s65, s64
    s_add_u32 s67, s67, s66
    s_add_u32 s67, s67, 0x00280000
    s_mul_i32 s68, s54, 320
    s_add_u32 s68, s68, 0x00500000
    s_lshl_b32 s58, s66, 5
    s_add_u32 s68, s68, s58
    s_mul_i32 s26, s4, 5376
    v_cmp_le_u32 vcc, 320, v13
    v_mov_b32 v221, 9920
    s_nop 0
    v_cndmask_b32 v220, 0, v221, vcc
    v_add_u32 v220, v220, v13
    v_add_u32 v221, 19808, v220
    v_add_u32 v222, 39616, v220
    v_add_u32 v223, 59424, v220
    v_and_b32 v104, 7, v15
    v_mul_u32_u24 v104, 672, v104
    s_add_u32 s58, s26, 126080
    v_add_u32 v104, s58, v104
    v_mov_b32 v108, 0x3f803f80
    v_mov_b32 v109, 0x3f803f80
    v_mov_b32 v110, 0x3f803f80
    v_mov_b32 v111, 0x3f803f80
    ds_write_b128 v104, v[108:111] offset:0
    s_mov_b32 s44, 0
    s_waitcnt vmcnt(1) lgkmcnt(0)
    s_barrier
    s_waitcnt vmcnt(0)
    v_xor_b32 v96, s5, v96
    v_xor_b32 v97, s5, v97
    v_xor_b32 v98, s5, v98
    v_xor_b32 v99, s5, v99
    v_or3_b32 v96, v96, v97, v98
    v_or_b32 v96, v96, v99
    v_cmp_ne_u32 vcc, 0, v96
    s_nop 0
    s_cmp_eq_u64 vcc, 0
    s_cbranch_scc0 LH3n
    s_add_u32 m0, s64, 151552
    s_nop 0
    buffer_load_dwordx4 v13, s[16:19], s65 offen offset:0 sc1 lds
    v_fmaak_f32 v39, v79, v79, 0x409d30fc
    v_mul_f32 v32, v32, v72
    v_mul_f32 v33, v33, v73
    v_mul_f32 v34, v34, v74
    v_mul_f32 v35, v35, v75
    v_mul_f32 v36, v36, v76
    v_mul_f32 v37, v37, v77
    v_mul_f32 v38, v38, v78
    buffer_load_dwordx4 v13, s[16:19], s65 offen offset:1024 sc1 lds
    v_mul_f32 v39, v39, v79
    v_exp_f32 v32, v32
    v_exp_f32 v33, v33
    v_exp_f32 v34, v34
    v_exp_f32 v35, v35
    buffer_load_dwordx4 v13, s[16:19], s65 offen offset:2048 sc1 lds
    v_exp_f32 v36, v36
    v_exp_f32 v37, v37
    v_exp_f32 v38, v38
    v_exp_f32 v39, v39
    v_fma_f32 v32, v32, v10, v10
    s_add_u32 m0, s66, 84480
    s_nop 0
    buffer_load_dwordx4 v13, s[16:19], s67 offen offset:0 sc1 lds
    v_fma_f32 v33, v33, v10, v10
    v_fma_f32 v34, v34, v10, v10
    v_fma_f32 v35, v35, v10, v10
    v_fma_f32 v36, v36, v10, v10
    v_fma_f32 v37, v37, v10, v10
    v_fma_f32 v38, v38, v10, v10
    v_fma_f32 v39, v39, v10, v10
    v_rcp_f32 v32, v32
    buffer_load_dwordx4 v13, s[16:19], s67 offen offset:1024 sc1 lds
    v_rcp_f32 v33, v33
    v_rcp_f32 v34, v34
    v_rcp_f32 v35, v35
    v_rcp_f32 v36, v36
    v_rcp_f32 v37, v37
    buffer_load_dwordx4 v13, s[16:19], s67 offen offset:2048 sc1 lds
    v_rcp_f32 v38, v38
    v_rcp_f32 v39, v39
    v_mul_f32 v72, v72, v32
    v_mul_f32 v73, v73, v33
    v_mul_f32 v74, v74, v34
    v_mul_f32 v75, v75, v35
    v_mul_f32 v76, v76, v36
    buffer_load_dwordx4 v13, s[16:19], s67 offen offset:3072 sc1 lds
    v_mul_f32 v77, v77, v37
    v_mul_f32 v78, v78, v38
    v_mul_f32 v79, v79, v39
    v_cvt_pk_bf16_f32 v172, v72, v73
    v_cvt_pk_bf16_f32 v173, v74, v75
    v_cvt_pk_bf16_f32 v174, v76, v77
    v_cvt_pk_bf16_f32 v175, v78, v79
    v_mul_f32 v80, v9, v80
    s_add_u32 m0, s66, 88576
    s_add_u32 s67, s67, 4096
    buffer_load_dwordx4 v13, s[16:19], s67 offen offset:0 sc1 lds
    v_mul_f32 v81, v9, v81
    v_mul_f32 v82, v9, v82
    v_mul_f32 v83, v9, v83
    v_mul_f32 v84, v9, v84
    v_mul_f32 v85, v9, v85
    v_mul_f32 v86, v9, v86
    v_mul_f32 v87, v9, v87
    s_add_u32 s67, s67, 16384
    s_add_u32 m0, s26, 125440
    s_mov_b32 exec_hi, 0xff
    buffer_load_dwordx4 v220, s[16:19], s68 offen offset:0 sc1 lds
    buffer_load_dwordx4 v221, s[16:19], s68 offen offset:672 sc1 lds
    buffer_load_dwordx4 v222, s[16:19], s68 offen offset:1344 sc1 lds
    buffer_load_dwordx4 v223, s[16:19], s68 offen offset:2016 sc1 lds
    s_mov_b32 exec_hi, -1
    s_add_u32 s68, s68, 81920
    s_add_u32 m0, s26, 128128
    s_mov_b32 exec_hi, 0xff
    buffer_load_dwordx4 v220, s[16:19], s68 offen offset:0 sc1 lds
    buffer_load_dwordx4 v221, s[16:19], s68 offen offset:672 sc1 lds
    buffer_load_dwordx4 v222, s[16:19], s68 offen offset:1344 sc1 lds
    buffer_load_dwordx4 v223, s[16:19], s68 offen offset:2016 sc1 lds
    s_mov_b32 exec_hi, -1
    s_add_u32 s68, s68, 573440
    v_fmaak_f32 v32, v80, v80, 0x409d30fc
    v_fmaak_f32 v33, v81, v81, 0x409d30fc
    v_fmaak_f32 v34, v82, v82, 0x409d30fc
    v_fmaak_f32 v35, v83, v83, 0x409d30fc
    v_fmaak_f32 v36, v84, v84, 0x409d30fc
    v_fmaak_f32 v37, v85, v85, 0x409d30fc
    v_fmaak_f32 v38, v86, v86, 0x409d30fc
    v_fmaak_f32 v39, v87, v87, 0x409d30fc
    v_mul_f32 v32, v32, v80
    v_mul_f32 v33, v33, v81
    v_mul_f32 v34, v34, v82
    v_mul_f32 v35, v35, v83
    v_mul_f32 v36, v36, v84
    v_mul_f32 v37, v37, v85
    v_mul_f32 v38, v38, v86
    v_mul_f32 v39, v39, v87
    v_exp_f32 v32, v32
    v_exp_f32 v33, v33
    v_exp_f32 v34, v34
    v_exp_f32 v35, v35
    v_exp_f32 v36, v36
    v_exp_f32 v37, v37
    v_exp_f32 v38, v38
    v_exp_f32 v39, v39
    v_fma_f32 v32, v32, v10, v10
    v_fma_f32 v33, v33, v10, v10
    v_fma_f32 v34, v34, v10, v10
    v_fma_f32 v35, v35, v10, v10
    v_fma_f32 v36, v36, v10, v10
    v_fma_f32 v37, v37, v10, v10
    v_fma_f32 v38, v38, v10, v10
    v_fma_f32 v39, v39, v10, v10
    v_rcp_f32 v32, v32
    v_rcp_f32 v33, v33
    v_rcp_f32 v34, v34
    v_rcp_f32 v35, v35
    v_rcp_f32 v36, v36
    v_rcp_f32 v37, v37
    v_rcp_f32 v38, v38
    v_rcp_f32 v39, v39
    v_mul_f32 v80, v80, v32
    v_mul_f32 v81, v81, v33
    v_mul_f32 v82, v82, v34
    v_mul_f32 v83, v83, v35
    v_mul_f32 v84, v84, v36
    v_mul_f32 v85, v85, v37
    v_mul_f32 v86, v86, v38
    v_mul_f32 v87, v87, v39
    v_cvt_pk_bf16_f32 v176, v80, v81
    v_cvt_pk_bf16_f32 v177, v82, v83
    v_cvt_pk_bf16_f32 v178, v84, v85
    v_cvt_pk_bf16_f32 v179, v86, v87
    v_mul_f32 v88, v9, v88
    v_mul_f32 v89, v9, v89
    v_mul_f32 v90, v9, v90
    v_mul_f32 v91, v9, v91
    v_mul_f32 v92, v9, v92
    v_mul_f32 v93, v9, v93
    v_mul_f32 v94, v9, v94
    v_mul_f32 v95, v9, v95
    v_fmaak_f32 v32, v88, v88, 0x409d30fc
    v_fmaak_f32 v33, v89, v89, 0x409d30fc
    v_fmaak_f32 v34, v90, v90, 0x409d30fc
    v_fmaak_f32 v35, v91, v91, 0x409d30fc
    v_fmaak_f32 v36, v92, v92, 0x409d30fc
    v_fmaak_f32 v37, v93, v93, 0x409d30fc
    v_fmaak_f32 v38, v94, v94, 0x409d30fc
    v_fmaak_f32 v39, v95, v95, 0x409d30fc
    v_mul_f32 v32, v32, v88
    v_mul_f32 v33, v33, v89
    v_mul_f32 v34, v34, v90
    v_mul_f32 v35, v35, v91
    v_mul_f32 v36, v36, v92
    v_mul_f32 v37, v37, v93
    v_mul_f32 v38, v38, v94
    v_mul_f32 v39, v39, v95
    v_exp_f32 v32, v32
    v_exp_f32 v33, v33
    v_exp_f32 v34, v34
    v_exp_f32 v35, v35
    v_exp_f32 v36, v36
    v_exp_f32 v37, v37
    v_exp_f32 v38, v38
    v_exp_f32 v39, v39
    v_fma_f32 v32, v32, v10, v10
    v_fma_f32 v33, v33, v10, v10
    v_fma_f32 v34, v34, v10, v10
    v_fma_f32 v35, v35, v10, v10
    v_fma_f32 v36, v36, v10, v10
    v_fma_f32 v37, v37, v10, v10
    v_fma_f32 v38, v38, v10, v10
    v_fma_f32 v39, v39, v10, v10
    v_rcp_f32 v32, v32
    v_rcp_f32 v33, v33
    v_rcp_f32 v34, v34
    v_rcp_f32 v35, v35
    v_rcp_f32 v36, v36
    v_rcp_f32 v37, v37
    v_rcp_f32 v38, v38
    v_rcp_f32 v39, v39
    v_mul_f32 v88, v88, v32
    v_mul_f32 v89, v89, v33
    v_mul_f32 v90, v90, v34
    v_mul_f32 v91, v91, v35
    v_mul_f32 v92, v92, v36
    v_mul_f32 v93, v93, v37
    v_mul_f32 v94, v94, v38
    v_mul_f32 v95, v95, v39
    v_cvt_pk_bf16_f32 v180, v88, v89
    v_cvt_pk_bf16_f32 v181, v90, v91
    v_cvt_pk_bf16_f32 v182, v92, v93
    v_cvt_pk_bf16_f32 v183, v94, v95
    s_branch LH3z
LH3n:
    buffer_load_dwordx4 v[96:99], v100, s[16:19], s61 offen sc1
    v_fmaak_f32 v39, v79, v79, 0x409d30fc
    v_mul_f32 v32, v32, v72
    v_mul_f32 v33, v33, v73
    v_mul_f32 v34, v34, v74
    v_mul_f32 v35, v35, v75
    v_mul_f32 v36, v36, v76
    v_mul_f32 v37, v37, v77
    v_mul_f32 v38, v38, v78
    v_mul_f32 v39, v39, v79
    v_exp_f32 v32, v32
    v_exp_f32 v33, v33
    v_exp_f32 v34, v34
    v_exp_f32 v35, v35
    v_exp_f32 v36, v36
    v_exp_f32 v37, v37
    v_exp_f32 v38, v38
    v_exp_f32 v39, v39
    v_fma_f32 v32, v32, v10, v10
    v_fma_f32 v33, v33, v10, v10
    v_fma_f32 v34, v34, v10, v10
    v_fma_f32 v35, v35, v10, v10
    v_fma_f32 v36, v36, v10, v10
    v_fma_f32 v37, v37, v10, v10
    v_fma_f32 v38, v38, v10, v10
    v_fma_f32 v39, v39, v10, v10
    v_rcp_f32 v32, v32
    v_rcp_f32 v33, v33
    v_rcp_f32 v34, v34
    v_rcp_f32 v35, v35
    v_rcp_f32 v36, v36
    v_rcp_f32 v37, v37
    v_rcp_f32 v38, v38
    v_rcp_f32 v39, v39
    v_mul_f32 v72, v72, v32
    v_mul_f32 v73, v73, v33
    v_mul_f32 v74, v74, v34
    v_mul_f32 v75, v75, v35
    v_mul_f32 v76, v76, v36
    v_mul_f32 v77, v77, v37
    v_mul_f32 v78, v78, v38
    v_mul_f32 v79, v79, v39
    v_cvt_pk_bf16_f32 v172, v72, v73
    v_cvt_pk_bf16_f32 v173, v74, v75
    v_cvt_pk_bf16_f32 v174, v76, v77
    v_cvt_pk_bf16_f32 v175, v78, v79
    v_mul_f32 v80, v9, v80
    v_mul_f32 v81, v9, v81
    v_mul_f32 v82, v9, v82
    v_mul_f32 v83, v9, v83
    v_mul_f32 v84, v9, v84
    v_mul_f32 v85, v9, v85
    v_mul_f32 v86, v9, v86
    v_mul_f32 v87, v9, v87
    v_fmaak_f32 v32, v80, v80, 0x409d30fc
    v_fmaak_f32 v33, v81, v81, 0x409d30fc
    s_cmp_lg_u32 s44, 0
    s_cbranch_scc1 LH3s1
    s_waitcnt vmcnt(0)
    v_xor_b32 v96, s5, v96
    v_xor_b32 v97, s5, v97
    v_xor_b32 v98, s5, v98
    v_xor_b32 v99, s5, v99
    v_or3_b32 v96, v96, v97, v98
    v_or_b32 v96, v96, v99
    v_cmp_ne_u32 vcc, 0, v96
    s_nop 0
    s_cmp_eq_u64 vcc, 0
    s_cbranch_scc1 LH3y1
    buffer_load_dwordx4 v[96:99], v100, s[16:19], s61 offen sc1
    s_branch LH3s1
LH3y1:
    s_add_u32 m0, s64, 151552
    s_nop 0
    buffer_load_dwordx4 v13, s[16:19], s65 offen offset:0 sc1 lds
    buffer_load_dwordx4 v13, s[16:19], s65 offen offset:1024 sc1 lds
    buffer_load_dwordx4 v13, s[16:19], s65 offen offset:2048 sc1 lds
    s_add_u32 m0, s66, 84480
    s_nop 0
    buffer_load_dwordx4 v13, s[16:19], s67 offen offset:0 sc1 lds
    buffer_load_dwordx4 v13, s[16:19], s67 offen offset:1024 sc1 lds
    buffer_load_dwordx4 v13, s[16:19], s67 offen offset:2048 sc1 lds
    buffer_load_dwordx4 v13, s[16:19], s67 offen offset:3072 sc1 lds
    s_add_u32 m0, s66, 88576
    s_add_u32 s67, s67, 4096
    buffer_load_dwordx4 v13, s[16:19], s67 offen offset:0 sc1 lds
    s_add_u32 s67, s67, 16384
    s_add_u32 m0, s26, 125440
    s_mov_b32 exec_hi, 0xff
    buffer_load_dwordx4 v220, s[16:19], s68 offen offset:0 sc1 lds
    buffer_load_dwordx4 v221, s[16:19], s68 offen offset:672 sc1 lds
    buffer_load_dwordx4 v222, s[16:19], s68 offen offset:1344 sc1 lds
    buffer_load_dwordx4 v223, s[16:19], s68 offen offset:2016 sc1 lds
    s_mov_b32 exec_hi, -1
    s_add_u32 s68, s68, 81920
    s_add_u32 m0, s26, 128128
    s_mov_b32 exec_hi, 0xff
    buffer_load_dwordx4 v220, s[16:19], s68 offen offset:0 sc1 lds
    buffer_load_dwordx4 v221, s[16:19], s68 offen offset:672 sc1 lds
    buffer_load_dwordx4 v222, s[16:19], s68 offen offset:1344 sc1 lds
    buffer_load_dwordx4 v223, s[16:19], s68 offen offset:2016 sc1 lds
    s_mov_b32 exec_hi, -1
    s_add_u32 s68, s68, 573440
    s_mov_b32 s44, 3
LH3s1:
    v_fmaak_f32 v34, v82, v82, 0x409d30fc
    v_fmaak_f32 v35, v83, v83, 0x409d30fc
    v_fmaak_f32 v36, v84, v84, 0x409d30fc
    v_fmaak_f32 v37, v85, v85, 0x409d30fc
    v_fmaak_f32 v38, v86, v86, 0x409d30fc
    v_fmaak_f32 v39, v87, v87, 0x409d30fc
    v_mul_f32 v32, v32, v80
    v_mul_f32 v33, v33, v81
    v_mul_f32 v34, v34, v82
    v_mul_f32 v35, v35, v83
    v_mul_f32 v36, v36, v84
    v_mul_f32 v37, v37, v85
    v_mul_f32 v38, v38, v86
    v_mul_f32 v39, v39, v87
    v_exp_f32 v32, v32
    v_exp_f32 v33, v33
    v_exp_f32 v34, v34
    v_exp_f32 v35, v35
    v_exp_f32 v36, v36
    v_exp_f32 v37, v37
    v_exp_f32 v38, v38
    v_exp_f32 v39, v39
    v_fma_f32 v32, v32, v10, v10
    v_fma_f32 v33, v33, v10, v10
    v_fma_f32 v34, v34, v10, v10
    v_fma_f32 v35, v35, v10, v10
    v_fma_f32 v36, v36, v10, v10
    v_fma_f32 v37, v37, v10, v10
    v_fma_f32 v38, v38, v10, v10
    v_fma_f32 v39, v39, v10, v10
    v_rcp_f32 v32, v32
    v_rcp_f32 v33, v33
    v_rcp_f32 v34, v34
    v_rcp_f32 v35, v35
    v_rcp_f32 v36, v36
    v_rcp_f32 v37, v37
    v_rcp_f32 v38, v38
    v_rcp_f32 v39, v39
    v_mul_f32 v80, v80, v32
    v_mul_f32 v81, v81, v33
    v_mul_f32 v82, v82, v34
    v_mul_f32 v83, v83, v35
    v_mul_f32 v84, v84, v36
    v_mul_f32 v85, v85, v37
    v_mul_f32 v86, v86, v38
    v_mul_f32 v87, v87, v39
    v_cvt_pk_bf16_f32 v176, v80, v81
    v_cvt_pk_bf16_f32 v177, v82, v83
    v_cvt_pk_bf16_f32 v178, v84, v85
    v_cvt_pk_bf16_f32 v179, v86, v87
    v_mul_f32 v88, v9, v88
    v_mul_f32 v89, v9, v89
    v_mul_f32 v90, v9, v90
    v_mul_f32 v91, v9, v91
    v_mul_f32 v92, v9, v92
    s_cmp_lg_u32 s44, 0
    s_cbranch_scc1 LH3s2
    s_waitcnt vmcnt(0)
    v_xor_b32 v96, s5, v96
    v_xor_b32 v97, s5, v97
    v_xor_b32 v98, s5, v98
    v_xor_b32 v99, s5, v99
    v_or3_b32 v96, v96, v97, v98
    v_or_b32 v96, v96, v99
    v_cmp_ne_u32 vcc, 0, v96
    s_nop 0
    s_cmp_eq_u64 vcc, 0
    s_cbranch_scc1 LH3y2
    buffer_load_dwordx4 v[96:99], v100, s[16:19], s61 offen sc1
    s_branch LH3s2
LH3y2:
    s_add_u32 m0, s64, 151552
    s_nop 0
    buffer_load_dwordx4 v13, s[16:19], s65 offen offset:0 sc1 lds
    buffer_load_dwordx4 v13, s[16:19], s65 offen offset:1024 sc1 lds
    buffer_load_dwordx4 v13, s[16:19], s65 offen offset:2048 sc1 lds
    s_add_u32 m0, s66, 84480
    s_nop 0
    buffer_load_dwordx4 v13, s[16:19], s67 offen offset:0 sc1 lds
    buffer_load_dwordx4 v13, s[16:19], s67 offen offset:1024 sc1 lds
    buffer_load_dwordx4 v13, s[16:19], s67 offen offset:2048 sc1 lds
    buffer_load_dwordx4 v13, s[16:19], s67 offen offset:3072 sc1 lds
    s_add_u32 m0, s66, 88576
    s_add_u32 s67, s67, 4096
    buffer_load_dwordx4 v13, s[16:19], s67 offen offset:0 sc1 lds
    s_add_u32 s67, s67, 16384
    s_add_u32 m0, s26, 125440
    s_mov_b32 exec_hi, 0xff
    buffer_load_dwordx4 v220, s[16:19], s68 offen offset:0 sc1 lds
    buffer_load_dwordx4 v221, s[16:19], s68 offen offset:672 sc1 lds
    buffer_load_dwordx4 v222, s[16:19], s68 offen offset:1344 sc1 lds
    buffer_load_dwordx4 v223, s[16:19], s68 offen offset:2016 sc1 lds
    s_mov_b32 exec_hi, -1
    s_add_u32 s68, s68, 81920
    s_add_u32 m0, s26, 128128
    s_mov_b32 exec_hi, 0xff
    buffer_load_dwordx4 v220, s[16:19], s68 offen offset:0 sc1 lds
    buffer_load_dwordx4 v221, s[16:19], s68 offen offset:672 sc1 lds
    buffer_load_dwordx4 v222, s[16:19], s68 offen offset:1344 sc1 lds
    buffer_load_dwordx4 v223, s[16:19], s68 offen offset:2016 sc1 lds
    s_mov_b32 exec_hi, -1
    s_add_u32 s68, s68, 573440
    s_mov_b32 s44, 3
LH3s2:
    v_mul_f32 v93, v9, v93
    v_mul_f32 v94, v9, v94
    v_mul_f32 v95, v9, v95
    v_fmaak_f32 v32, v88, v88, 0x409d30fc
    v_fmaak_f32 v33, v89, v89, 0x409d30fc
    v_fmaak_f32 v34, v90, v90, 0x409d30fc
    v_fmaak_f32 v35, v91, v91, 0x409d30fc
    v_fmaak_f32 v36, v92, v92, 0x409d30fc
    v_fmaak_f32 v37, v93, v93, 0x409d30fc
    v_fmaak_f32 v38, v94, v94, 0x409d30fc
    v_fmaak_f32 v39, v95, v95, 0x409d30fc
    v_mul_f32 v32, v32, v88
    v_mul_f32 v33, v33, v89
    v_mul_f32 v34, v34, v90
    v_mul_f32 v35, v35, v91
    v_mul_f32 v36, v36, v92
    v_mul_f32 v37, v37, v93
    v_mul_f32 v38, v38, v94
    v_mul_f32 v39, v39, v95
    v_exp_f32 v32, v32
    v_exp_f32 v33, v33
    v_exp_f32 v34, v34
    v_exp_f32 v35, v35
    v_exp_f32 v36, v36
    v_exp_f32 v37, v37
    v_exp_f32 v38, v38
    v_exp_f32 v39, v39
    v_fma_f32 v32, v32, v10, v10
    v_fma_f32 v33, v33, v10, v10
    v_fma_f32 v34, v34, v10, v10
    v_fma_f32 v35, v35, v10, v10
    v_fma_f32 v36, v36, v10, v10
    v_fma_f32 v37, v37, v10, v10
    v_fma_f32 v38, v38, v10, v10
    v_fma_f32 v39, v39, v10, v10
    v_rcp_f32 v32, v32
    v_rcp_f32 v33, v33
    v_rcp_f32 v34, v34
    v_rcp_f32 v35, v35
    v_rcp_f32 v36, v36
    v_rcp_f32 v37, v37
    v_rcp_f32 v38, v38
    v_rcp_f32 v39, v39
    v_mul_f32 v88, v88, v32
    v_mul_f32 v89, v89, v33
    v_mul_f32 v90, v90, v34
    v_mul_f32 v91, v91, v35
    v_mul_f32 v92, v92, v36
    v_mul_f32 v93, v93, v37
    v_mul_f32 v94, v94, v38
    v_mul_f32 v95, v95, v39
    v_cvt_pk_bf16_f32 v180, v88, v89
    v_cvt_pk_bf16_f32 v181, v90, v91
    v_cvt_pk_bf16_f32 v182, v92, v93
    v_cvt_pk_bf16_f32 v183, v94, v95
    s_cmp_lg_u32 s44, 0
    s_cbranch_scc1 LH3z
    s_waitcnt vmcnt(0)
    s_mov_b32 s60, 100000
LH3p:
    v_xor_b32 v96, s5, v96
    v_xor_b32 v97, s5, v97
    v_xor_b32 v98, s5, v98
    v_xor_b32 v99, s5, v99
    v_or3_b32 v96, v96, v97, v98
    v_or_b32 v96, v96, v99
    v_cmp_ne_u32 vcc, 0, v96
    s_nop 0
    s_cmp_eq_u64 vcc, 0
    s_cbranch_scc1 LH3p_x
    s_sleep 1
    buffer_load_dwordx4 v[96:99], v100, s[16:19], s61 offen sc1
    s_sub_u32 s60, s60, 1
    s_waitcnt vmcnt(0)
    s_cbranch_scc0 LH3p
LH3p_x:
    s_add_u32 m0, s64, 151552
    s_nop 0
    buffer_load_dwordx4 v13, s[16:19], s65 offen offset:0 sc1 lds
    buffer_load_dwordx4 v13, s[16:19], s65 offen offset:1024 sc1 lds
    buffer_load_dwordx4 v13, s[16:19], s65 offen offset:2048 sc1 lds
    s_add_u32 m0, s66, 84480
    s_nop 0
    buffer_load_dwordx4 v13, s[16:19], s67 offen offset:0 sc1 lds
    buffer_load_dwordx4 v13, s[16:19], s67 offen offset:1024 sc1 lds
    buffer_load_dwordx4 v13, s[16:19], s67 offen offset:2048 sc1 lds
    buffer_load_dwordx4 v13, s[16:19], s67 offen offset:3072 sc1 lds
    s_add_u32 m0, s66, 88576
    s_add_u32 s67, s67, 4096
    buffer_load_dwordx4 v13, s[16:19], s67 offen offset:0 sc1 lds
    s_add_u32 s67, s67, 16384
    s_add_u32 m0, s26, 125440
    s_mov_b32 exec_hi, 0xff
    buffer_load_dwordx4 v220, s[16:19], s68 offen offset:0 sc1 lds
    buffer_load_dwordx4 v221, s[16:19], s68 offen offset:672 sc1 lds
    buffer_load_dwordx4 v222, s[16:19], s68 offen offset:1344 sc1 lds
    buffer_load_dwordx4 v223, s[16:19], s68 offen offset:2016 sc1 lds
    s_mov_b32 exec_hi, -1
    s_add_u32 s68, s68, 81920
    s_add_u32 m0, s26, 128128
    s_mov_b32 exec_hi, 0xff
    buffer_load_dwordx4 v220, s[16:19], s68 offen offset:0 sc1 lds
    buffer_load_dwordx4 v221, s[16:19], s68 offen offset:672 sc1 lds
    buffer_load_dwordx4 v222, s[16:19], s68 offen offset:1344 sc1 lds
    buffer_load_dwordx4 v223, s[16:19], s68 offen offset:2016 sc1 lds
    s_mov_b32 exec_hi, -1
    s_add_u32 s68, s68, 573440
LH3z:
    s_lshl_b32 s62, s46, 11
    s_add_u32 s62, s62, s50
    buffer_store_dwordx4 v[168:171], v13, s[16:19], s62 offen offset:0 sc1
    buffer_store_dwordx4 v[172:175], v13, s[16:19], s62 offen offset:1024 sc1
    buffer_store_dwordx4 v[176:179], v13, s[16:19], s62 offen offset:2048 sc1
    buffer_store_dwordx4 v[180:183], v13, s[16:19], s62 offen offset:3072 sc1
    s_waitcnt vmcnt(4)
    s_barrier
    s_setprio 3
LA_att:
    v_lshrrev_b32 v2, 4, v15
    v_lshlrev_b32 v2, 3, v2
    v_and_b32 v3, 15, v15
    v_lshl_add_u32 v4, v3, 4, v2
    v_lshlrev_b32 v153, 3, v15
    v_add_u32 v153, 84480, v153
    v_lshl_add_u32 v155, v14, 2, v153
    v_add_u32 v155, 2048, v155
    v_lshl_add_u32 v153, v14, 10, v153
    v_add_u32 v154, 256, v153
    s_mul_i32 s58, s4, 2560
    s_add_u32 s58, s58, 151552
    v_add_u32 v4, s58, v4
    v_lshl_add_u32 v5, v14, 2, v4
    v_lshl_add_u32 v4, v14, 10, v4
    v_mul_u32_u24 v156, 320, v14
    v_lshl_add_u32 v156, v15, 4, v156
    v_mov_b32 v2, 640
    v_cmp_gt_u32 vcc, 20, v15
    s_nop 1
    v_cndmask_b32 v156, v2, v156, vcc
    v_mov_b32 v2, 0x011fffff
    v_lshrrev_b32 v2, v15, v2
    v_and_b32 v157, 1, v2
    s_mov_b32 s58, 0xfffeea00
    v_add_u32 v156, 0x30000, v156
    v_mad_i32_i24 v156, v157, s58, v156
    v_mov_b32 v152, 0xdddddddd
    v_mov_b32 v129, 0x3f803f80
    v_mov_b32 v135, 0x3f803f80
    v_mov_b32 v117, 0
    v_mov_b32 v123, 0
    v_mov_b32 v144, 0
    v_mov_b32 v145, 0
    v_mov_b32 v146, 0
    v_mov_b32 v147, 0
    v_mov_b32 v148, 0
    v_mov_b32 v149, 0
    v_mov_b32 v150, 0
    v_mov_b32 v151, 0
    v_mfma_f32_32x32x8_bf16 v[80:95], v[144:145], v[144:145], 0
    v_mfma_f32_32x32x8_bf16 v[96:111], v[144:145], v[144:145], 0
    v_mfma_f32_32x32x8_bf16 v[64:79], v[144:145], v[144:145], 0
    s_setprio 2
    ds_read2st64_b64 v[124:127], v153 offset0:0 offset1:1
    ds_read_b32 v128, v155 offset:0
    ds_read_b64 v[112:113], v4 offset:0
    ds_read_b64 v[114:115], v4 offset:512
    ds_read_b32 v116, v5 offset:2048
    ds_read_b64 v[118:119], v4 offset:256
    ds_read_b64 v[120:121], v4 offset:768
    ds_read_b32 v122, v5 offset:2304
    ds_read2st64_b64 v[130:133], v154 offset0:0 offset1:1
    ds_read_b32 v134, v155 offset:256
    ds_read_b128 v[136:139], v156 offset:0
    ds_read_b128 v[140:143], v156 offset:672
    s_waitcnt lgkmcnt(8)
    v_mfma_f32_32x32x16_bf16 v[16:31], v[124:127], v[112:115], 0
    s_waitcnt lgkmcnt(7)
    v_mfma_f32_32x32x8_bf16 v[16:31], v[128:129], v[116:117], v[16:31]
    s_waitcnt lgkmcnt(5)
    v_mfma_f32_32x32x16_bf16 v[32:47], v[124:127], v[118:121], 0
    s_waitcnt lgkmcnt(4)
    v_mfma_f32_32x32x8_bf16 v[32:47], v[128:129], v[122:123], v[32:47]
    s_nop 7
    v_max3_f32 v2, v16, v17, v16
    v_max3_f32 v2, v18, v19, v2
    v_max3_f32 v2, v20, v21, v2
    v_max3_f32 v2, v22, v23, v2
    v_max3_f32 v2, v24, v25, v2
    v_max3_f32 v2, v26, v27, v2
    v_max3_f32 v2, v28, v29, v2
    v_max3_f32 v2, v30, v31, v2
    v_mov_b32 v3, v2
    s_nop 1
    v_permlane32_swap_b32 v2, v3
    v_max_f32 v2, v2, v3
    v_sub_f32 v2, 0, v2
    v_cvt_pk_bf16_f32 v8, v2, v2
    v_and_b32 v8, 0xffff0000, v8
    v_sub_f32 v8, v2, v8
    v_cvt_pk_bf16_f32 v9, v2, v8
    v_and_b32 v10, 0xffff0000, v9
    v_sub_f32 v8, v8, v10
    v_cvt_pk_bf16_f32 v8, v8, 0
    v_cmp_eq_u32 vcc, 0, v14
    s_nop 1
    v_cndmask_b32 v117, v8, v9, vcc
    v_max3_f32 v4, v32, v33, v32
    v_max3_f32 v4, v34, v35, v4
    v_max3_f32 v4, v36, v37, v4
    v_max3_f32 v4, v38, v39, v4
    v_max3_f32 v4, v40, v41, v4
    v_max3_f32 v4, v42, v43, v4
    v_max3_f32 v4, v44, v45, v4
    v_max3_f32 v4, v46, v47, v4
    v_mov_b32 v5, v4
    s_nop 1
    v_permlane32_swap_b32 v4, v5
    v_max_f32 v4, v4, v5
    v_sub_f32 v4, 0, v4
    v_cvt_pk_bf16_f32 v8, v4, v4
    v_and_b32 v8, 0xffff0000, v8
    v_sub_f32 v8, v4, v8
    v_cvt_pk_bf16_f32 v9, v4, v8
    v_and_b32 v10, 0xffff0000, v9
    v_sub_f32 v8, v8, v10
    v_cvt_pk_bf16_f32 v8, v8, 0
    v_cmp_eq_u32 vcc, 0, v14
    s_nop 1
    v_cndmask_b32 v123, v8, v9, vcc
    v_mfma_f32_32x32x16_bf16 v[16:31], v[124:127], v[112:115], 0
    v_mfma_f32_32x32x8_bf16 v[16:31], v[128:129], v[116:117], v[16:31]
    v_mfma_f32_32x32x16_bf16 v[32:47], v[124:127], v[118:121], 0
    v_mfma_f32_32x32x8_bf16 v[32:47], v[128:129], v[122:123], v[32:47]
    s_lshl2_add_u32 s58, s55, s4
    s_mul_i32 s51, s58, 81920
    s_add_u32 s51, s51, 0x01400000
    s_lshl_b32 s52, s54, 10
    s_add_u32 s52, s52, s51
    s_add_u32 s43, s52, 40960
    s_lshl_b32 s58, s54, 8
    s_add_u32 s51, s51, s58
    s_add_u32 s51, s51, 32768
    v_bfe_u32 v159, v13, 8, 1
    v_mul_u32_u24 v159, 40704, v159
    v_add_u32 v159, v159, v13
    v_lshl_add_u32 v159, v14, 30, v159
    s_lshl_b32 s67, s55, 2
    s_add_u32 s67, s67, s4
    s_lshl_b32 s67, s67, 5
    s_add_u32 s67, s67, s54
    s_lshl_b32 s67, s67, 7
    s_add_u32 s67, s67, 0x01c80000
    s_lshl_b32 s58, s6, 2
    s_add_u32 s58, s58, s4
    s_lshl_b32 s58, s58, 4
    s_add_u32 s58, s58, s7
    s_lshl_b32 s58, s58, 6
    s_and_b32 s59, s3, 4
    s_add_u32 s58, s58, s59
    s_lshl_b32 s58, s58, 1
    s_add_u32 s58, s58, 0x01c00000
    s_mov_b32 s68, s58
    v_lshlrev_b32 v162, 21, v13
    v_mov_b32 v160, s5
    v_mov_b32 v161, s5
    s_mov_b32 s60, 0
    s_mov_b32 s64, 20480
    s_mov_b32 s65, 0xfffe1600
    s_waitcnt lgkmcnt(0)
.p2align 6
LA_loop:
    v_smfmac_f32_32x32x32_bf16 v[96:111], v[144:147], v[64:71], v152
    ds_read2st64_b64 v[124:127], v153 offset0:5 offset1:6
    v_exp_f32 v16, v16
    v_exp_f32 v17, v17
    v_smfmac_f32_32x32x32_bf16 v[96:111], v[148:151], v[72:79], v152
    ds_read_b32 v128, v155 offset:2560
    s_waitcnt lgkmcnt(2)
    v_exp_f32 v18, v18
    v_exp_f32 v19, v19
    v_mfma_f32_32x32x16_bf16 v[48:63], v[130:133], v[112:115], 0
    v_exp_f32 v20, v20
    v_exp_f32 v21, v21
    v_exp_f32 v22, v22
    v_mfma_f32_32x32x8_bf16 v[48:63], v[134:135], v[116:117], v[48:63]
    v_exp_f32 v23, v23
    v_exp_f32 v24, v24
    v_exp_f32 v25, v25
    v_exp_f32 v26, v26
    v_exp_f32 v27, v27
    v_exp_f32 v28, v28
    v_exp_f32 v29, v29
    v_exp_f32 v30, v30
    v_exp_f32 v31, v31
    v_smfmac_f32_32x32x32_bf16 v[80:95], v[136:139], v[16:23], v152
    ds_read_b128 v[144:147], v156 offset:1344
    v_exp_f32 v32, v32
    v_exp_f32 v33, v33
    v_smfmac_f32_32x32x32_bf16 v[80:95], v[140:143], v[24:31], v152
    ds_read_b128 v[148:151], v156 offset:2016
    v_exp_f32 v34, v34
    v_exp_f32 v35, v35
    v_mfma_f32_32x32x16_bf16 v[64:79], v[130:133], v[118:121], 0
    v_exp_f32 v36, v36
    v_exp_f32 v37, v37
    v_exp_f32 v38, v38
    v_mfma_f32_32x32x8_bf16 v[64:79], v[134:135], v[122:123], v[64:79]
    v_exp_f32 v39, v39
    v_exp_f32 v40, v40
    v_exp_f32 v41, v41
    v_exp_f32 v42, v42
    v_exp_f32 v43, v43
    v_exp_f32 v44, v44
    v_exp_f32 v45, v45
    v_exp_f32 v46, v46
    v_exp_f32 v47, v47
    v_smfmac_f32_32x32x32_bf16 v[96:111], v[136:139], v[32:39], v152
    ds_read2st64_b64 v[130:133], v154 offset0:5 offset1:6
    v_exp_f32 v48, v48
    v_exp_f32 v49, v49
    v_smfmac_f32_32x32x32_bf16 v[96:111], v[140:143], v[40:47], v152
    ds_read_b32 v134, v155 offset:2816
    s_waitcnt lgkmcnt(2)
    v_exp_f32 v50, v50
    v_exp_f32 v51, v51
    v_mfma_f32_32x32x16_bf16 v[16:31], v[124:127], v[112:115], 0
    v_exp_f32 v52, v52
    v_exp_f32 v53, v53
    v_exp_f32 v54, v54
    v_mfma_f32_32x32x8_bf16 v[16:31], v[128:129], v[116:117], v[16:31]
    v_exp_f32 v55, v55
    v_exp_f32 v56, v56
    v_exp_f32 v57, v57
    v_exp_f32 v58, v58
    v_exp_f32 v59, v59
    v_exp_f32 v60, v60
    v_exp_f32 v61, v61
    v_exp_f32 v62, v62
    v_exp_f32 v63, v63
    v_smfmac_f32_32x32x32_bf16 v[80:95], v[144:147], v[48:55], v152
    ds_read_b128 v[136:139], v156 offset:2688
    v_exp_f32 v64, v64
    v_exp_f32 v65, v65
    v_smfmac_f32_32x32x32_bf16 v[80:95], v[148:151], v[56:63], v152
    ds_read_b128 v[140:143], v156 offset:3360
    v_exp_f32 v66, v66
    v_exp_f32 v67, v67
    v_mfma_f32_32x32x16_bf16 v[32:47], v[124:127], v[118:121], 0
    v_exp_f32 v68, v68
    v_exp_f32 v69, v69
    v_exp_f32 v70, v70
    v_mfma_f32_32x32x8_bf16 v[32:47], v[128:129], v[122:123], v[32:47]
    v_exp_f32 v71, v71
    v_exp_f32 v72, v72
    v_exp_f32 v73, v73
    v_exp_f32 v74, v74
    v_exp_f32 v75, v75
    v_exp_f32 v76, v76
    v_exp_f32 v77, v77
    v_exp_f32 v78, v78
    v_exp_f32 v79, v79
    v_smfmac_f32_32x32x32_bf16 v[96:111], v[144:147], v[64:71], v152
    ds_read2st64_b64 v[124:127], v153 offset0:10 offset1:11
    v_exp_f32 v16, v16
    v_exp_f32 v17, v17
    v_smfmac_f32_32x32x32_bf16 v[96:111], v[148:151], v[72:79], v152
    ds_read_b32 v128, v155 offset:5120
    s_waitcnt lgkmcnt(2)
    v_exp_f32 v18, v18
    v_exp_f32 v19, v19
    v_mfma_f32_32x32x16_bf16 v[48:63], v[130:133], v[112:115], 0
    v_exp_f32 v20, v20
    v_exp_f32 v21, v21
    v_exp_f32 v22, v22
    v_mfma_f32_32x32x8_bf16 v[48:63], v[134:135], v[116:117], v[48:63]
    v_exp_f32 v23, v23
    v_exp_f32 v24, v24
    v_exp_f32 v25, v25
    v_exp_f32 v26, v26
    v_exp_f32 v27, v27
    v_exp_f32 v28, v28
    v_exp_f32 v29, v29
    v_exp_f32 v30, v30
    v_exp_f32 v31, v31
    v_smfmac_f32_32x32x32_bf16 v[80:95], v[136:139], v[16:23], v152
    ds_read_b128 v[144:147], v156 offset:4032
    v_exp_f32 v32, v32
    v_exp_f32 v33, v33
    v_smfmac_f32_32x32x32_bf16 v[80:95], v[140:143], v[24:31], v152
    ds_read_b128 v[148:151], v156 offset:4704
    v_exp_f32 v34, v34
    v_exp_f32 v35, v35
    v_mfma_f32_32x32x16_bf16 v[64:79], v[130:133], v[118:121], 0
    v_exp_f32 v36, v36
    v_exp_f32 v37, v37
    v_exp_f32 v38, v38
    v_mfma_f32_32x32x8_bf16 v[64:79], v[134:135], v[122:123], v[64:79]
    v_exp_f32 v39, v39
    v_exp_f32 v40, v40
    v_exp_f32 v41, v41
    v_exp_f32 v42, v42
    v_exp_f32 v43, v43
    v_exp_f32 v44, v44
    v_exp_f32 v45, v45
    v_exp_f32 v46, v46
    v_exp_f32 v47, v47
    v_smfmac_f32_32x32x32_bf16 v[96:111], v[136:139], v[32:39], v152
    ds_read2st64_b64 v[130:133], v154 offset0:10 offset1:11
    v_exp_f32 v48, v48
    v_exp_f32 v49, v49
    v_smfmac_f32_32x32x32_bf16 v[96:111], v[140:143], v[40:47], v152
    ds_read_b32 v134, v155 offset:5376
    s_waitcnt lgkmcnt(2)
    v_exp_f32 v50, v50
    v_exp_f32 v51, v51
    v_mfma_f32_32x32x16_bf16 v[16:31], v[124:127], v[112:115], 0
    v_exp_f32 v52, v52
    v_exp_f32 v53, v53
    v_exp_f32 v54, v54
    v_mfma_f32_32x32x8_bf16 v[16:31], v[128:129], v[116:117], v[16:31]
    v_exp_f32 v55, v55
    v_exp_f32 v56, v56
    v_exp_f32 v57, v57
    v_exp_f32 v58, v58
    v_exp_f32 v59, v59
    v_exp_f32 v60, v60
    v_exp_f32 v61, v61
    v_exp_f32 v62, v62
    v_exp_f32 v63, v63
    v_smfmac_f32_32x32x32_bf16 v[80:95], v[144:147], v[48:55], v152
    ds_read_b128 v[136:139], v156 offset:5376
    v_exp_f32 v64, v64
    v_exp_f32 v65, v65
    v_smfmac_f32_32x32x32_bf16 v[80:95], v[148:151], v[56:63], v152
    ds_read_b128 v[140:143], v156 offset:6048
    v_exp_f32 v66, v66
    v_exp_f32 v67, v67
    v_mfma_f32_32x32x16_bf16 v[32:47], v[124:127], v[118:121], 0
    v_exp_f32 v68, v68
    v_exp_f32 v69, v69
    v_exp_f32 v70, v70
    v_mfma_f32_32x32x8_bf16 v[32:47], v[128:129], v[122:123], v[32:47]
    v_exp_f32 v71, v71
    v_exp_f32 v72, v72
    v_exp_f32 v73, v73
    v_exp_f32 v74, v74
    v_exp_f32 v75, v75
    v_exp_f32 v76, v76
    v_exp_f32 v77, v77
    v_exp_f32 v78, v78
    v_exp_f32 v79, v79
    v_smfmac_f32_32x32x32_bf16 v[96:111], v[144:147], v[64:71], v152
    ds_read2st64_b64 v[124:127], v153 offset0:15 offset1:16
    v_exp_f32 v16, v16
    v_exp_f32 v17, v17
    v_smfmac_f32_32x32x32_bf16 v[96:111], v[148:151], v[72:79], v152
    ds_read_b32 v128, v155 offset:7680
    s_waitcnt lgkmcnt(2)
    v_exp_f32 v18, v18
    v_exp_f32 v19, v19
    v_mfma_f32_32x32x16_bf16 v[48:63], v[130:133], v[112:115], 0
    v_exp_f32 v20, v20
    v_exp_f32 v21, v21
    v_exp_f32 v22, v22
    v_mfma_f32_32x32x8_bf16 v[48:63], v[134:135], v[116:117], v[48:63]
    v_exp_f32 v23, v23
    v_exp_f32 v24, v24
    v_exp_f32 v25, v25
    v_exp_f32 v26, v26
    v_exp_f32 v27, v27
    v_exp_f32 v28, v28
    v_exp_f32 v29, v29
    v_exp_f32 v30, v30
    v_exp_f32 v31, v31
    v_smfmac_f32_32x32x32_bf16 v[80:95], v[136:139], v[16:23], v152
    ds_read_b128 v[144:147], v156 offset:6720
    v_exp_f32 v32, v32
    v_exp_f32 v33, v33
    v_smfmac_f32_32x32x32_bf16 v[80:95], v[140:143], v[24:31], v152
    ds_read_b128 v[148:151], v156 offset:7392
    v_exp_f32 v34, v34
    v_exp_f32 v35, v35
    v_mfma_f32_32x32x16_bf16 v[64:79], v[130:133], v[118:121], 0
    v_exp_f32 v36, v36
    v_exp_f32 v37, v37
    v_exp_f32 v38, v38
    v_mfma_f32_32x32x8_bf16 v[64:79], v[134:135], v[122:123], v[64:79]
    v_exp_f32 v39, v39
    v_exp_f32 v40, v40
    v_exp_f32 v41, v41
    v_exp_f32 v42, v42
    v_exp_f32 v43, v43
    v_exp_f32 v44, v44
    v_exp_f32 v45, v45
    v_exp_f32 v46, v46
    v_exp_f32 v47, v47
    v_smfmac_f32_32x32x32_bf16 v[96:111], v[136:139], v[32:39], v152
    ds_read2st64_b64 v[130:133], v154 offset0:15 offset1:16
    v_exp_f32 v48, v48
    v_exp_f32 v49, v49
    v_smfmac_f32_32x32x32_bf16 v[96:111], v[140:143], v[40:47], v152
    ds_read_b32 v134, v155 offset:7936
    s_waitcnt lgkmcnt(2)
    v_exp_f32 v50, v50
    v_exp_f32 v51, v51
    v_mfma_f32_32x32x16_bf16 v[16:31], v[124:127], v[112:115], 0
    v_exp_f32 v52, v52
    v_exp_f32 v53, v53
    v_exp_f32 v54, v54
    v_mfma_f32_32x32x8_bf16 v[16:31], v[128:129], v[116:117], v[16:31]
    v_exp_f32 v55, v55
    v_exp_f32 v56, v56
    v_exp_f32 v57, v57
    v_exp_f32 v58, v58
    v_exp_f32 v59, v59
    v_exp_f32 v60, v60
    v_exp_f32 v61, v61
    v_exp_f32 v62, v62
    v_exp_f32 v63, v63
    v_smfmac_f32_32x32x32_bf16 v[80:95], v[144:147], v[48:55], v152
    ds_read_b128 v[136:139], v156 offset:8064
    v_exp_f32 v64, v64
    v_exp_f32 v65, v65
    v_smfmac_f32_32x32x32_bf16 v[80:95], v[148:151], v[56:63], v152
    ds_read_b128 v[140:143], v156 offset:8736
    v_exp_f32 v66, v66
    v_exp_f32 v67, v67
    v_mfma_f32_32x32x16_bf16 v[32:47], v[124:127], v[118:121], 0
    v_exp_f32 v68, v68
    v_exp_f32 v69, v69
    v_exp_f32 v70, v70
    v_mfma_f32_32x32x8_bf16 v[32:47], v[128:129], v[122:123], v[32:47]
    v_exp_f32 v71, v71
    v_exp_f32 v72, v72
    v_exp_f32 v73, v73
    v_exp_f32 v74, v74
    v_exp_f32 v75, v75
    v_exp_f32 v76, v76
    v_exp_f32 v77, v77
    v_exp_f32 v78, v78
    v_exp_f32 v79, v79
    v_smfmac_f32_32x32x32_bf16 v[96:111], v[144:147], v[64:71], v152
    s_waitcnt vmcnt(0)
    buffer_store_dwordx2 v[160:161], v162, s[16:19], s68 offen sc1
    ds_read2st64_b64 v[124:127], v153 offset0:20 offset1:21
    v_exp_f32 v16, v16
    v_exp_f32 v17, v17
    v_smfmac_f32_32x32x32_bf16 v[96:111], v[148:151], v[72:79], v152
    ds_read_b32 v128, v155 offset:10240
    s_waitcnt lgkmcnt(2)
    v_exp_f32 v18, v18
    v_exp_f32 v19, v19
    v_mfma_f32_32x32x16_bf16 v[48:63], v[130:133], v[112:115], 0
    v_exp_f32 v20, v20
    v_exp_f32 v21, v21
    v_exp_f32 v22, v22
    v_mfma_f32_32x32x8_bf16 v[48:63], v[134:135], v[116:117], v[48:63]
    v_exp_f32 v23, v23
    v_exp_f32 v24, v24
    v_exp_f32 v25, v25
    v_exp_f32 v26, v26
    v_exp_f32 v27, v27
    v_exp_f32 v28, v28
    v_exp_f32 v29, v29
    v_exp_f32 v30, v30
    v_exp_f32 v31, v31
    v_smfmac_f32_32x32x32_bf16 v[80:95], v[136:139], v[16:23], v152
    ds_read_b128 v[144:147], v156 offset:9408
    v_exp_f32 v32, v32
    v_exp_f32 v33, v33
    v_smfmac_f32_32x32x32_bf16 v[80:95], v[140:143], v[24:31], v152
    ds_read_b128 v[148:151], v156 offset:10080
    v_exp_f32 v34, v34
    v_exp_f32 v35, v35
    v_mfma_f32_32x32x16_bf16 v[64:79], v[130:133], v[118:121], 0
    v_exp_f32 v36, v36
    v_exp_f32 v37, v37
    v_exp_f32 v38, v38
    v_mfma_f32_32x32x8_bf16 v[64:79], v[134:135], v[122:123], v[64:79]
    v_exp_f32 v39, v39
    v_exp_f32 v40, v40
    v_exp_f32 v41, v41
    v_exp_f32 v42, v42
    v_exp_f32 v43, v43
    v_exp_f32 v44, v44
    v_exp_f32 v45, v45
    v_exp_f32 v46, v46
    v_exp_f32 v47, v47
    v_smfmac_f32_32x32x32_bf16 v[96:111], v[136:139], v[32:39], v152
    ds_read2st64_b64 v[130:133], v154 offset0:20 offset1:21
    v_exp_f32 v48, v48
    v_exp_f32 v49, v49
    v_smfmac_f32_32x32x32_bf16 v[96:111], v[140:143], v[40:47], v152
    ds_read_b32 v134, v155 offset:10496
    s_waitcnt lgkmcnt(2)
    v_exp_f32 v50, v50
    v_exp_f32 v51, v51
    v_mfma_f32_32x32x16_bf16 v[16:31], v[124:127], v[112:115], 0
    v_exp_f32 v52, v52
    v_exp_f32 v53, v53
    v_exp_f32 v54, v54
    v_mfma_f32_32x32x8_bf16 v[16:31], v[128:129], v[116:117], v[16:31]
    v_exp_f32 v55, v55
    v_exp_f32 v56, v56
    v_exp_f32 v57, v57
    v_exp_f32 v58, v58
    v_exp_f32 v59, v59
    v_exp_f32 v60, v60
    v_exp_f32 v61, v61
    v_exp_f32 v62, v62
    v_exp_f32 v63, v63
    v_smfmac_f32_32x32x32_bf16 v[80:95], v[144:147], v[48:55], v152
    ds_read_b128 v[136:139], v156 offset:10752
    v_exp_f32 v64, v64
    v_exp_f32 v65, v65
    v_smfmac_f32_32x32x32_bf16 v[80:95], v[148:151], v[56:63], v152
    ds_read_b128 v[140:143], v156 offset:11424
    v_exp_f32 v66, v66
    v_exp_f32 v67, v67
    v_mfma_f32_32x32x16_bf16 v[32:47], v[124:127], v[118:121], 0
    v_exp_f32 v68, v68
    v_exp_f32 v69, v69
    v_exp_f32 v70, v70
    v_mfma_f32_32x32x8_bf16 v[32:47], v[128:129], v[122:123], v[32:47]
    v_exp_f32 v71, v71
    v_exp_f32 v72, v72
    v_exp_f32 v73, v73
    v_exp_f32 v74, v74
    v_exp_f32 v75, v75
    v_exp_f32 v76, v76
    v_exp_f32 v77, v77
    v_exp_f32 v78, v78
    v_exp_f32 v79, v79
    v_smfmac_f32_32x32x32_bf16 v[96:111], v[144:147], v[64:71], v152
    ds_read2st64_b64 v[124:127], v153 offset0:25 offset1:26
    v_exp_f32 v16, v16
    v_exp_f32 v17, v17
    v_smfmac_f32_32x32x32_bf16 v[96:111], v[148:151], v[72:79], v152
    ds_read_b32 v128, v155 offset:12800
    s_waitcnt lgkmcnt(2)
    v_exp_f32 v18, v18
    v_exp_f32 v19, v19
    v_mfma_f32_32x32x16_bf16 v[48:63], v[130:133], v[112:115], 0
    v_exp_f32 v20, v20
    v_exp_f32 v21, v21
    v_exp_f32 v22, v22
    v_mfma_f32_32x32x8_bf16 v[48:63], v[134:135], v[116:117], v[48:63]
    v_exp_f32 v23, v23
    v_exp_f32 v24, v24
    v_exp_f32 v25, v25
    v_exp_f32 v26, v26
    v_exp_f32 v27, v27
    v_exp_f32 v28, v28
    v_exp_f32 v29, v29
    v_exp_f32 v30, v30
    v_exp_f32 v31, v31
    v_smfmac_f32_32x32x32_bf16 v[80:95], v[136:139], v[16:23], v152
    ds_read_b128 v[144:147], v156 offset:12096
    v_exp_f32 v32, v32
    v_exp_f32 v33, v33
    v_smfmac_f32_32x32x32_bf16 v[80:95], v[140:143], v[24:31], v152
    ds_read_b128 v[148:151], v156 offset:12768
    v_exp_f32 v34, v34
    v_exp_f32 v35, v35
    v_mfma_f32_32x32x16_bf16 v[64:79], v[130:133], v[118:121], 0
    v_exp_f32 v36, v36
    v_exp_f32 v37, v37
    v_exp_f32 v38, v38
    v_mfma_f32_32x32x8_bf16 v[64:79], v[134:135], v[122:123], v[64:79]
    v_exp_f32 v39, v39
    v_exp_f32 v40, v40
    v_exp_f32 v41, v41
    v_exp_f32 v42, v42
    v_exp_f32 v43, v43
    v_exp_f32 v44, v44
    v_exp_f32 v45, v45
    v_exp_f32 v46, v46
    v_exp_f32 v47, v47
    v_smfmac_f32_32x32x32_bf16 v[96:111], v[136:139], v[32:39], v152
    ds_read2st64_b64 v[130:133], v154 offset0:25 offset1:26
    v_exp_f32 v48, v48
    v_exp_f32 v49, v49
    v_smfmac_f32_32x32x32_bf16 v[96:111], v[140:143], v[40:47], v152
    ds_read_b32 v134, v155 offset:13056
    s_waitcnt lgkmcnt(2)
    v_exp_f32 v50, v50
    v_exp_f32 v51, v51
    v_mfma_f32_32x32x16_bf16 v[16:31], v[124:127], v[112:115], 0
    v_exp_f32 v52, v52
    v_exp_f32 v53, v53
    v_exp_f32 v54, v54
    v_mfma_f32_32x32x8_bf16 v[16:31], v[128:129], v[116:117], v[16:31]
    v_exp_f32 v55, v55
    v_exp_f32 v56, v56
    v_exp_f32 v57, v57
    v_exp_f32 v58, v58
    v_exp_f32 v59, v59
    v_exp_f32 v60, v60
    v_exp_f32 v61, v61
    v_exp_f32 v62, v62
    v_exp_f32 v63, v63
    v_smfmac_f32_32x32x32_bf16 v[80:95], v[144:147], v[48:55], v152
    ds_read_b128 v[136:139], v156 offset:13440
    v_exp_f32 v64, v64
    v_exp_f32 v65, v65
    v_smfmac_f32_32x32x32_bf16 v[80:95], v[148:151], v[56:63], v152
    ds_read_b128 v[140:143], v156 offset:14112
    v_exp_f32 v66, v66
    v_exp_f32 v67, v67
    v_mfma_f32_32x32x16_bf16 v[32:47], v[124:127], v[118:121], 0
    v_exp_f32 v68, v68
    v_exp_f32 v69, v69
    v_exp_f32 v70, v70
    v_mfma_f32_32x32x8_bf16 v[32:47], v[128:129], v[122:123], v[32:47]
    v_exp_f32 v71, v71
    v_exp_f32 v72, v72
    v_exp_f32 v73, v73
    v_exp_f32 v74, v74
    v_exp_f32 v75, v75
    v_exp_f32 v76, v76
    v_exp_f32 v77, v77
    v_exp_f32 v78, v78
    v_exp_f32 v79, v79
    v_smfmac_f32_32x32x32_bf16 v[96:111], v[144:147], v[64:71], v152
    ds_read2st64_b64 v[124:127], v153 offset0:30 offset1:31
    v_exp_f32 v16, v16
    v_exp_f32 v17, v17
    v_smfmac_f32_32x32x32_bf16 v[96:111], v[148:151], v[72:79], v152
    ds_read_b32 v128, v155 offset:15360
    s_waitcnt lgkmcnt(2)
    v_exp_f32 v18, v18
    v_exp_f32 v19, v19
    v_mfma_f32_32x32x16_bf16 v[48:63], v[130:133], v[112:115], 0
    v_exp_f32 v20, v20
    v_exp_f32 v21, v21
    v_exp_f32 v22, v22
    v_mfma_f32_32x32x8_bf16 v[48:63], v[134:135], v[116:117], v[48:63]
    v_exp_f32 v23, v23
    v_exp_f32 v24, v24
    v_exp_f32 v25, v25
    v_exp_f32 v26, v26
    v_exp_f32 v27, v27
    v_exp_f32 v28, v28
    v_exp_f32 v29, v29
    v_exp_f32 v30, v30
    v_exp_f32 v31, v31
    v_smfmac_f32_32x32x32_bf16 v[80:95], v[136:139], v[16:23], v152
    ds_read_b128 v[144:147], v156 offset:14784
    v_exp_f32 v32, v32
    v_exp_f32 v33, v33
    v_smfmac_f32_32x32x32_bf16 v[80:95], v[140:143], v[24:31], v152
    ds_read_b128 v[148:151], v156 offset:15456
    v_exp_f32 v34, v34
    v_exp_f32 v35, v35
    v_mfma_f32_32x32x16_bf16 v[64:79], v[130:133], v[118:121], 0
    v_exp_f32 v36, v36
    v_exp_f32 v37, v37
    v_exp_f32 v38, v38
    v_mfma_f32_32x32x8_bf16 v[64:79], v[134:135], v[122:123], v[64:79]
    v_exp_f32 v39, v39
    v_exp_f32 v40, v40
    v_exp_f32 v41, v41
    v_exp_f32 v42, v42
    v_exp_f32 v43, v43
    v_exp_f32 v44, v44
    v_exp_f32 v45, v45
    v_exp_f32 v46, v46
    v_exp_f32 v47, v47
    v_smfmac_f32_32x32x32_bf16 v[96:111], v[136:139], v[32:39], v152
    ds_read2st64_b64 v[130:133], v154 offset0:30 offset1:31
    v_exp_f32 v48, v48
    v_exp_f32 v49, v49
    v_smfmac_f32_32x32x32_bf16 v[96:111], v[140:143], v[40:47], v152
    ds_read_b32 v134, v155 offset:15616
    s_waitcnt lgkmcnt(2)
    v_exp_f32 v50, v50
    v_exp_f32 v51, v51
    v_mfma_f32_32x32x16_bf16 v[16:31], v[124:127], v[112:115], 0
    v_exp_f32 v52, v52
    v_exp_f32 v53, v53
    v_exp_f32 v54, v54
    v_mfma_f32_32x32x8_bf16 v[16:31], v[128:129], v[116:117], v[16:31]
    v_exp_f32 v55, v55
    v_exp_f32 v56, v56
    v_exp_f32 v57, v57
    v_exp_f32 v58, v58
    v_exp_f32 v59, v59
    v_exp_f32 v60, v60
    v_exp_f32 v61, v61
    v_exp_f32 v62, v62
    v_exp_f32 v63, v63
    v_smfmac_f32_32x32x32_bf16 v[80:95], v[144:147], v[48:55], v152
    ds_read_b128 v[136:139], v156 offset:16128
    v_exp_f32 v64, v64
    v_exp_f32 v65, v65
    v_smfmac_f32_32x32x32_bf16 v[80:95], v[148:151], v[56:63], v152
    ds_read_b128 v[140:143], v156 offset:16800
    v_exp_f32 v66, v66
    v_exp_f32 v67, v67
    v_mfma_f32_32x32x16_bf16 v[32:47], v[124:127], v[118:121], 0
    v_exp_f32 v68, v68
    v_exp_f32 v69, v69
    v_exp_f32 v70, v70
    v_mfma_f32_32x32x8_bf16 v[32:47], v[128:129], v[122:123], v[32:47]
    v_exp_f32 v71, v71
    v_exp_f32 v72, v72
    v_exp_f32 v73, v73
    v_exp_f32 v74, v74
    v_exp_f32 v75, v75
    v_exp_f32 v76, v76
    v_exp_f32 v77, v77
    v_exp_f32 v78, v78
    v_exp_f32 v79, v79
    v_smfmac_f32_32x32x32_bf16 v[96:111], v[144:147], v[64:71], v152
    ds_read2st64_b64 v[124:127], v153 offset0:35 offset1:36
    v_exp_f32 v16, v16
    v_exp_f32 v17, v17
    v_smfmac_f32_32x32x32_bf16 v[96:111], v[148:151], v[72:79], v152
    ds_read_b32 v128, v155 offset:17920
    s_waitcnt lgkmcnt(2)
    v_exp_f32 v18, v18
    v_exp_f32 v19, v19
    v_mfma_f32_32x32x16_bf16 v[48:63], v[130:133], v[112:115], 0
    v_exp_f32 v20, v20
    v_exp_f32 v21, v21
    v_exp_f32 v22, v22
    v_mfma_f32_32x32x8_bf16 v[48:63], v[134:135], v[116:117], v[48:63]
    v_exp_f32 v23, v23
    v_exp_f32 v24, v24
    v_exp_f32 v25, v25
    v_exp_f32 v26, v26
    v_exp_f32 v27, v27
    v_exp_f32 v28, v28
    v_exp_f32 v29, v29
    v_exp_f32 v30, v30
    v_exp_f32 v31, v31
    v_smfmac_f32_32x32x32_bf16 v[80:95], v[136:139], v[16:23], v152
    ds_read_b128 v[144:147], v156 offset:17472
    v_exp_f32 v32, v32
    v_exp_f32 v33, v33
    v_smfmac_f32_32x32x32_bf16 v[80:95], v[140:143], v[24:31], v152
    ds_read_b128 v[148:151], v156 offset:18144
    v_exp_f32 v34, v34
    v_exp_f32 v35, v35
    v_mfma_f32_32x32x16_bf16 v[64:79], v[130:133], v[118:121], 0
    v_exp_f32 v36, v36
    v_exp_f32 v37, v37
    v_exp_f32 v38, v38
    v_mfma_f32_32x32x8_bf16 v[64:79], v[134:135], v[122:123], v[64:79]
    v_exp_f32 v39, v39
    v_exp_f32 v40, v40
    v_exp_f32 v41, v41
    v_exp_f32 v42, v42
    v_exp_f32 v43, v43
    v_exp_f32 v44, v44
    v_exp_f32 v45, v45
    v_exp_f32 v46, v46
    v_exp_f32 v47, v47
    v_smfmac_f32_32x32x32_bf16 v[96:111], v[136:139], v[32:39], v152
    ds_read2st64_b64 v[130:133], v154 offset0:35 offset1:36
    v_exp_f32 v48, v48
    v_exp_f32 v49, v49
    v_smfmac_f32_32x32x32_bf16 v[96:111], v[140:143], v[40:47], v152
    ds_read_b32 v134, v155 offset:18176
    s_waitcnt lgkmcnt(2)
    v_exp_f32 v50, v50
    v_exp_f32 v51, v51
    v_mfma_f32_32x32x16_bf16 v[16:31], v[124:127], v[112:115], 0
    v_exp_f32 v52, v52
    v_exp_f32 v53, v53
    v_exp_f32 v54, v54
    v_mfma_f32_32x32x8_bf16 v[16:31], v[128:129], v[116:117], v[16:31]
    v_exp_f32 v55, v55
    v_exp_f32 v56, v56
    v_exp_f32 v57, v57
    v_exp_f32 v58, v58
    v_exp_f32 v59, v59
    v_exp_f32 v60, v60
    v_exp_f32 v61, v61
    v_exp_f32 v62, v62
    v_exp_f32 v63, v63
    v_smfmac_f32_32x32x32_bf16 v[80:95], v[144:147], v[48:55], v152
    ds_read_b128 v[136:139], v156 offset:18816
    v_exp_f32 v64, v64
    v_exp_f32 v65, v65
    v_smfmac_f32_32x32x32_bf16 v[80:95], v[148:151], v[56:63], v152
    ds_read_b128 v[140:143], v156 offset:19488
    v_exp_f32 v66, v66
    v_exp_f32 v67, v67
    v_mfma_f32_32x32x16_bf16 v[32:47], v[124:127], v[118:121], 0
    v_exp_f32 v68, v68
    v_exp_f32 v69, v69
    v_exp_f32 v70, v70
    v_mfma_f32_32x32x8_bf16 v[32:47], v[128:129], v[122:123], v[32:47]
    v_exp_f32 v71, v71
    v_exp_f32 v72, v72
    v_exp_f32 v73, v73
    v_exp_f32 v74, v74
    v_exp_f32 v75, v75
    v_exp_f32 v76, v76
    v_exp_f32 v77, v77
    v_exp_f32 v78, v78
    v_exp_f32 v79, v79
    v_smfmac_f32_32x32x32_bf16 v[96:111], v[144:147], v[64:71], v152
    v_add_u32 v153, s64, v153
    v_add_u32 v154, s64, v154
    v_add_u32 v155, s64, v155
    s_waitcnt lgkmcnt(2)
    s_barrier
    ds_read2st64_b64 v[124:127], v153 offset0:0 offset1:1
    v_exp_f32 v16, v16
    v_exp_f32 v17, v17
    v_smfmac_f32_32x32x32_bf16 v[96:111], v[148:151], v[72:79], v152
    ds_read_b32 v128, v155 offset:0
    s_waitcnt lgkmcnt(2)
    v_exp_f32 v18, v18
    v_exp_f32 v19, v19
    v_mfma_f32_32x32x16_bf16 v[48:63], v[130:133], v[112:115], 0
    v_exp_f32 v20, v20
    v_exp_f32 v21, v21
    v_exp_f32 v22, v22
    v_mfma_f32_32x32x8_bf16 v[48:63], v[134:135], v[116:117], v[48:63]
    v_exp_f32 v23, v23
    v_exp_f32 v24, v24
    v_exp_f32 v25, v25
    v_exp_f32 v26, v26
    v_exp_f32 v27, v27
    v_exp_f32 v28, v28
    v_exp_f32 v29, v29
    v_exp_f32 v30, v30
    v_exp_f32 v31, v31
    v_smfmac_f32_32x32x32_bf16 v[80:95], v[136:139], v[16:23], v152
    ds_read_b128 v[144:147], v156 offset:20160
    v_exp_f32 v32, v32
    v_exp_f32 v33, v33
    v_smfmac_f32_32x32x32_bf16 v[80:95], v[140:143], v[24:31], v152
    ds_read_b128 v[148:151], v156 offset:20832
    v_exp_f32 v34, v34
    v_exp_f32 v35, v35
    v_mfma_f32_32x32x16_bf16 v[64:79], v[130:133], v[118:121], 0
    v_exp_f32 v36, v36
    v_exp_f32 v37, v37
    v_exp_f32 v38, v38
    v_mfma_f32_32x32x8_bf16 v[64:79], v[134:135], v[122:123], v[64:79]
    v_exp_f32 v39, v39
    v_exp_f32 v40, v40
    v_exp_f32 v41, v41
    v_exp_f32 v42, v42
    v_exp_f32 v43, v43
    v_exp_f32 v44, v44
    v_exp_f32 v45, v45
    v_exp_f32 v46, v46
    v_exp_f32 v47, v47
    v_smfmac_f32_32x32x32_bf16 v[96:111], v[136:139], v[32:39], v152
    ds_read2st64_b64 v[130:133], v154 offset0:0 offset1:1
    v_exp_f32 v48, v48
    v_exp_f32 v49, v49
    v_smfmac_f32_32x32x32_bf16 v[96:111], v[140:143], v[40:47], v152
    ds_read_b32 v134, v155 offset:256
    s_waitcnt lgkmcnt(2)
    v_exp_f32 v50, v50
    v_exp_f32 v51, v51
    v_mfma_f32_32x32x16_bf16 v[16:31], v[124:127], v[112:115], 0
    v_exp_f32 v52, v52
    v_exp_f32 v53, v53
    v_exp_f32 v54, v54
    v_mfma_f32_32x32x8_bf16 v[16:31], v[128:129], v[116:117], v[16:31]
    v_exp_f32 v55, v55
    v_exp_f32 v56, v56
    v_exp_f32 v57, v57
    v_exp_f32 v58, v58
    v_exp_f32 v59, v59
    v_exp_f32 v60, v60
    v_exp_f32 v61, v61
    v_exp_f32 v62, v62
    v_exp_f32 v63, v63
    v_smfmac_f32_32x32x32_bf16 v[80:95], v[144:147], v[48:55], v152
    v_mad_i32_i24 v156, v157, s65, v156
    ds_read_b128 v[136:139], v156 offset:0
    v_exp_f32 v64, v64
    v_exp_f32 v65, v65
    v_smfmac_f32_32x32x32_bf16 v[80:95], v[148:151], v[56:63], v152
    ds_read_b128 v[140:143], v156 offset:672
    v_exp_f32 v66, v66
    v_exp_f32 v67, v67
    v_mfma_f32_32x32x16_bf16 v[32:47], v[124:127], v[118:121], 0
    v_exp_f32 v68, v68
    v_exp_f32 v69, v69
    v_exp_f32 v70, v70
    v_mfma_f32_32x32x8_bf16 v[32:47], v[128:129], v[122:123], v[32:47]
    v_exp_f32 v71, v71
    v_exp_f32 v72, v72
    v_exp_f32 v73, v73
    v_exp_f32 v74, v74
    v_exp_f32 v75, v75
    v_exp_f32 v76, v76
    v_exp_f32 v77, v77
    v_exp_f32 v78, v78
    v_exp_f32 v79, v79
    s_add_u32 s60, s60, 1
    s_cmp_eq_u32 s60, 1
    s_cselect_b32 s64, 0xfffec000, 0
    s_cselect_b32 s65, 0, 82432
    s_add_u32 s64, s64, 20480
    s_add_u32 s65, s65, 21504
    s_cmp_lt_u32 s60, 4
    s_cbranch_scc1 LA_loop
    buffer_store_dword v160, v162, s[16:19], s67 offen sc1
    s_waitcnt lgkmcnt(0)
    v_smfmac_f32_32x32x32_bf16 v[96:111], v[144:147], v[64:71], v152
    v_smfmac_f32_32x32x32_bf16 v[96:111], v[148:151], v[72:79], v152
    s_barrier
LA_fin:
    v_cmp_eq_u32 vcc, 0, v14
    s_nop 1
    v_cndmask_b32 v2, v88, v92, vcc
    v_rcp_f32 v6, v2
    s_nop 0
    v_mul_f32 v16, v6, v80
    v_mul_f32 v17, v6, v81
    v_mul_f32 v18, v6, v82
    v_mul_f32 v19, v6, v83
    v_mul_f32 v20, v6, v84
    v_mul_f32 v21, v6, v85
    v_mul_f32 v22, v6, v86
    v_mul_f32 v23, v6, v87
    v_mul_f32 v24, v6, v88
    v_mul_f32 v25, v6, v89
    v_mul_f32 v26, v6, v90
    v_mul_f32 v27, v6, v91
    v_cvt_pk_bf16_f32 v48, v16, v17
    v_cvt_pk_bf16_f32 v49, v18, v19
    v_cvt_pk_bf16_f32 v50, v20, v21
    v_cvt_pk_bf16_f32 v51, v22, v23
    v_cvt_pk_bf16_f32 v56, v24, v25
    v_cvt_pk_bf16_f32 v57, v26, v27
    v_and_b32 v16, 0x7f807f80, v48
    v_and_b32 v17, 0x7f807f80, v49
    v_and_b32 v18, 0x7f807f80, v50
    v_and_b32 v19, 0x7f807f80, v51
    v_and_b32 v20, 0x7f807f80, v56
    v_and_b32 v21, 0x7f807f80, v57
    v_pk_max_u16 v16, v16, v17
    v_pk_max_u16 v16, v16, v18
    v_pk_max_u16 v16, v16, v19
    v_pk_max_u16 v16, v16, v20
    v_pk_max_u16 v16, v16, v21
    v_cndmask_b32 v3, v104, v108, vcc
    v_rcp_f32 v6, v3
    s_nop 0
    v_mul_f32 v28, v6, v96
    v_mul_f32 v29, v6, v97
    v_mul_f32 v30, v6, v98
    v_mul_f32 v31, v6, v99
    v_mul_f32 v32, v6, v100
    v_mul_f32 v33, v6, v101
    v_mul_f32 v34, v6, v102
    v_mul_f32 v35, v6, v103
    v_mul_f32 v36, v6, v104
    v_mul_f32 v37, v6, v105
    v_mul_f32 v38, v6, v106
    v_mul_f32 v39, v6, v107
    v_cvt_pk_bf16_f32 v52, v28, v29
    v_cvt_pk_bf16_f32 v53, v30, v31
    v_cvt_pk_bf16_f32 v54, v32, v33
    v_cvt_pk_bf16_f32 v55, v34, v35
    v_cvt_pk_bf16_f32 v58, v36, v37
    v_cvt_pk_bf16_f32 v59, v38, v39
    v_and_b32 v28, 0x7f807f80, v52
    v_and_b32 v29, 0x7f807f80, v53
    v_and_b32 v30, 0x7f807f80, v54
    v_and_b32 v31, 0x7f807f80, v55
    v_and_b32 v32, 0x7f807f80, v58
    v_and_b32 v33, 0x7f807f80, v59
    v_pk_max_u16 v28, v28, v29
    v_pk_max_u16 v28, v28, v30
    v_pk_max_u16 v28, v28, v31
    v_pk_max_u16 v28, v28, v32
    v_pk_max_u16 v28, v28, v33
    v_permlane16_swap_b32 v56, v58
    v_permlane16_swap_b32 v57, v59
    v_pk_max_u16 v16, v16, v28
    v_add_u32 v16, 0x00800080, v16
    v_and_b32 v16, 0x80008000, v16
    v_min_f32 v5, v2, v3
    v_add_f32 v2, v2, v3
    v_cmp_eq_u32 s[64:65], 0, v16
    v_cmp_gt_f32 vcc, 0x7b800000, v2
    s_nop 0
    s_and_b64 s[62:63], vcc, s[64:65]
    v_cmp_lt_f32 vcc, 0x35800000, v5
    s_nop 0
    s_and_b64 vcc, vcc, s[62:63]
    s_cmp_eq_u64 vcc, exec
    s_cselect_b32 s61, 5, s60
    s_cmp_eq_u32 s61, 4
    s_cbranch_scc1 LA_slow
    buffer_store_dwordx4 v[48:51], v13, s[16:19], s52 offen sc1
    buffer_store_dwordx4 v[52:55], v13, s[16:19], s43 offen sc1
    buffer_store_dwordx4 v[56:59], v159, s[16:19], s51 offen sc1
    s_setprio 0
    s_and_b32 s58, s56, 1
    s_and_b32 s45, s57, 1
    s_lshl1_add_u32 s47, s58, s45
    s_lshl_b32 s45, s45, 2
    s_sub_u32 s45, 4, s45
    v_lshl_add_u32 v12, s47, 10, v13
    s_mul_i32 s58, s57, 40
    s_add_u32 s58, s58, s4
    s_mul_i32 s58, s58, 5120
    s_add_u32 s58, s58, 0x012a8000
    s_mul_i32 s59, s4, 5120
    s_add_u32 s58, s58, s59
    buffer_load_dwordx4 v[188:191], v12, s[16:19], s58 offen offset:0 sc1
    buffer_load_dwordx4 v[196:199], v12, s[16:19], s58 offen offset:1024 sc1
    s_add_u32 s58, s58, 5120
    buffer_load_dwordx4 v[192:195], v12, s[16:19], s58 offen offset:0 sc1
    buffer_load_dwordx4 v[200:203], v12, s[16:19], s58 offen offset:1024 sc1
    v_lshrrev_b32 v244, 8, v13
    v_lshl_add_u32 v244, s3, 2, v244
    v_lshrrev_b32 v245, 1, v13
    v_and_b32 v245, 0x80, v245
    v_xor_b32 v245, v245, v13
    v_bfe_u32 v245, v245, 4, 4
    v_and_b32 v246, 7, v244
    v_xor_b32 v246, v246, v245
    v_mul_u32_u24 v250, 640, v244
    v_lshl_add_u32 v252, v245, 2, v250
    v_lshl_add_u32 v250, v246, 4, v250
    v_add_u32 v251, 122880, v250
    v_lshlrev_b32 v252, 1, v252
    v_lshrrev_b32 v245, 3, v245
    v_lshl_add_u32 v253, v245, 30, v252
    s_mul_i32 s58, s57, 320
    s_mul_i32 s42, s56, 40960
    s_add_u32 s42, s42, s58
    s_lshl_b32 s59, s47, 6
    s_add_u32 s49, s42, s59
    s_lshl_b32 s48, s45, 6
    s_add_u32 s42, s42, s48
    s_add_u32 s58, s58, s59
    s_xor_b32 s48, s56, 1
    s_mul_i32 s48, s48, 40960
    s_add_u32 s48, s48, s58
    buffer_load_dwordx2 v[244:245], v252, s[8:11], s48 offen
    buffer_load_dwordx2 v[246:247], v252, s[8:11], s49 offen
    buffer_load_dwordx2 v[248:249], v253, s[8:11], s42 offen
    s_xor_b32 s62, s56, 1
    s_mul_i32 s62, s62, 40
    s_add_u32 s62, s62, s4
    s_add_u32 s63, s62, s4
    s_lshl_b32 s62, s62, 10
    s_add_u32 s62, s62, 0x01400000
    s_lshl_b32 s63, s63, 10
    s_add_u32 s63, s63, 0x01408000
    s_mov_b32 s64, 100000
    v_and_b32 v5, 7, v15
    v_xor_b32 v5, v5, v14
    v_mul_u32_u24 v4, 640, v15
    v_lshl_add_u32 v4, v5, 4, v4
    s_mov_b32 s58, 20480
    s_cmp_eq_u32 s4, 1
    s_cselect_b32 s58, 64000, s58
    s_cmp_eq_u32 s4, 2
    s_cselect_b32 s58, 122880, s58
    s_cmp_eq_u32 s4, 3
    s_cselect_b32 s58, 143360, s58
    v_add_u32 v4, s58, v4
    v_xor_b32 v5, 32, v4
    v_xor_b32 v6, 64, v4
    v_xor_b32 v7, 96, v4
    s_mov_b32 s58, 0
    s_cmp_eq_u32 s4, 1
    s_cselect_b32 s58, 43520, s58
    s_cmp_eq_u32 s4, 2
    s_cselect_b32 s58, 84480, s58
    s_cmp_eq_u32 s4, 3
    s_cselect_b32 s58, 100864, s58
    v_add_u32 v8, s58, v13
    v_lshlrev_b32 v2, 7, v15
    s_lshr_b32 s61, s56, 1
    s_lshl_b32 s61, s61, 12
    s_add_u32 s61, s61, 0x01c80000
    ds_read_b128 v[124:127], v8 offset:0
    ds_read_b128 v[128:131], v8 offset:2048
    ds_read_b128 v[132:135], v8 offset:4096
    ds_read_b128 v[136:139], v8 offset:6144
    ds_read_b128 v[140:143], v8 offset:8192
    ds_read_b128 v[144:147], v8 offset:10240
    ds_read_b128 v[148:151], v8 offset:12288
    ds_read_b128 v[152:155], v8 offset:14336
    ds_read_b128 v[156:159], v8 offset:1024
    ds_read_b128 v[160:163], v8 offset:3072
    ds_read_b128 v[164:167], v8 offset:5120
    ds_read_b128 v[168:171], v8 offset:7168
    ds_read_b128 v[172:175], v8 offset:9216
    ds_read_b128 v[176:179], v8 offset:11264
    ds_read_b128 v[180:183], v8 offset:13312
    ds_read_b128 v[184:187], v8 offset:15360
    s_barrier
    ds_read_b128 v[16:19], v250 offset:20480
    ds_read_b128 v[20:23], v250 offset:64000
    ds_read_b128 v[24:27], v251 offset:0
    ds_read_b128 v[28:31], v251 offset:20480
    ds_read_b128 v[32:35], v250 offset:20736
    ds_read_b128 v[36:39], v250 offset:64256
    ds_read_b128 v[40:43], v251 offset:256
    ds_read_b128 v[44:47], v251 offset:20736
    ds_read_b128 v[48:51], v250 offset:20992
    ds_read_b128 v[52:55], v250 offset:64512
    ds_read_b128 v[56:59], v251 offset:512
    ds_read_b128 v[60:63], v251 offset:20992
    s_waitcnt lgkmcnt(10)
    v_pk_add_f32 v[16:17], v[16:17], v[20:21]
    v_pk_add_f32 v[18:19], v[18:19], v[22:23]
    s_waitcnt lgkmcnt(8)
    v_pk_add_f32 v[24:25], v[24:25], v[28:29]
    v_pk_add_f32 v[26:27], v[26:27], v[30:31]
    v_pk_add_f32 v[104:105], v[16:17], v[24:25]
    v_pk_add_f32 v[106:107], v[18:19], v[26:27]
    s_waitcnt lgkmcnt(6)
    v_pk_add_f32 v[32:33], v[32:33], v[36:37]
    v_pk_add_f32 v[34:35], v[34:35], v[38:39]
    s_waitcnt lgkmcnt(4)
    v_pk_add_f32 v[40:41], v[40:41], v[44:45]
    v_pk_add_f32 v[42:43], v[42:43], v[46:47]
    v_pk_add_f32 v[108:109], v[32:33], v[40:41]
    v_pk_add_f32 v[110:111], v[34:35], v[42:43]
    s_waitcnt lgkmcnt(2)
    v_pk_add_f32 v[48:49], v[48:49], v[52:53]
    v_pk_add_f32 v[50:51], v[50:51], v[54:55]
    s_waitcnt lgkmcnt(0)
    v_pk_add_f32 v[56:57], v[56:57], v[60:61]
    v_pk_add_f32 v[58:59], v[58:59], v[62:63]
    v_pk_add_f32 v[112:113], v[48:49], v[56:57]
    v_pk_add_f32 v[114:115], v[50:51], v[58:59]
    s_barrier
    s_add_u32 s58, s62, 0
    buffer_load_dwordx4 v[64:67], v13, s[16:19], s58 offen sc1
    s_add_u32 s58, s62, 4096
    buffer_load_dwordx4 v[68:71], v13, s[16:19], s58 offen sc1
    s_add_u32 s58, s62, 8192
    buffer_load_dwordx4 v[72:75], v13, s[16:19], s58 offen sc1
    s_add_u32 s58, s62, 12288
    buffer_load_dwordx4 v[76:79], v13, s[16:19], s58 offen sc1
    s_add_u32 s58, s62, 16384
    buffer_load_dwordx4 v[80:83], v13, s[16:19], s58 offen sc1
    s_add_u32 s58, s62, 20480
    buffer_load_dwordx4 v[84:87], v13, s[16:19], s58 offen sc1
    s_add_u32 s58, s62, 24576
    buffer_load_dwordx4 v[88:91], v13, s[16:19], s58 offen sc1
    s_add_u32 s58, s62, 28672
    buffer_load_dwordx4 v[92:95], v13, s[16:19], s58 offen sc1
    buffer_load_dwordx4 v[96:99], v13, s[16:19], s63 offen offset:0 sc1
    buffer_load_dwordx4 v[100:103], v13, s[16:19], s63 offen offset:1024 sc1
    v_mul_f32 v118, 0xbfb8aa3b, v104
    v_mul_f32 v119, 0xbfb8aa3b, v105
    v_mul_f32 v120, 0xbfb8aa3b, v106
    v_mul_f32 v121, 0xbfb8aa3b, v107
    v_mul_f32 v122, 0xbfb8aa3b, v108
    v_mul_f32 v123, 0xbfb8aa3b, v109
    v_exp_f32 v118, v118
    v_exp_f32 v119, v119
    v_exp_f32 v120, v120
    v_exp_f32 v121, v121
    v_exp_f32 v122, v122
    v_exp_f32 v123, v123
    v_add_f32 v118, 1.0, v118
    v_add_f32 v119, 1.0, v119
    v_add_f32 v120, 1.0, v120
    v_add_f32 v121, 1.0, v121
    v_add_f32 v122, 1.0, v122
    v_add_f32 v123, 1.0, v123
    v_rcp_f32 v118, v118
    v_rcp_f32 v119, v119
    v_rcp_f32 v120, v120
    v_rcp_f32 v121, v121
    v_rcp_f32 v122, v122
    v_rcp_f32 v123, v123
    v_mul_f32 v104, v104, v118
    v_mul_f32 v105, v105, v119
    v_mul_f32 v106, v106, v120
    v_mul_f32 v107, v107, v121
    v_mul_f32 v108, v108, v122
    v_mul_f32 v109, v109, v123
    v_mul_f32 v118, 0xbfb8aa3b, v110
    v_mul_f32 v119, 0xbfb8aa3b, v111
    v_mul_f32 v120, 0xbfb8aa3b, v112
    v_mul_f32 v121, 0xbfb8aa3b, v113
    v_mul_f32 v122, 0xbfb8aa3b, v114
    v_mul_f32 v123, 0xbfb8aa3b, v115
    v_exp_f32 v118, v118
    v_exp_f32 v119, v119
    v_exp_f32 v120, v120
    v_exp_f32 v121, v121
    v_exp_f32 v122, v122
    v_exp_f32 v123, v123
    v_add_f32 v118, 1.0, v118
    v_add_f32 v119, 1.0, v119
    v_add_f32 v120, 1.0, v120
    v_add_f32 v121, 1.0, v121
    v_add_f32 v122, 1.0, v122
    v_add_f32 v123, 1.0, v123
    v_rcp_f32 v118, v118
    v_rcp_f32 v119, v119
    v_rcp_f32 v120, v120
    v_rcp_f32 v121, v121
    v_rcp_f32 v122, v122
    v_rcp_f32 v123, v123
    v_mul_f32 v110, v110, v118
    v_mul_f32 v111, v111, v119
    v_mul_f32 v112, v112, v120
    v_mul_f32 v113, v113, v121
    v_mul_f32 v114, v114, v122
    v_mul_f32 v115, v115, v123
    s_waitcnt lgkmcnt(0)
    s_branch L_p3a_g
L_p3a:
    s_add_u32 s58, s62, 0
    buffer_load_dwordx4 v[64:67], v13, s[16:19], s58 offen sc1
    s_add_u32 s58, s62, 4096
    buffer_load_dwordx4 v[68:71], v13, s[16:19], s58 offen sc1
    s_add_u32 s58, s62, 8192
    buffer_load_dwordx4 v[72:75], v13, s[16:19], s58 offen sc1
    s_add_u32 s58, s62, 12288
    buffer_load_dwordx4 v[76:79], v13, s[16:19], s58 offen sc1
    s_add_u32 s58, s62, 16384
    buffer_load_dwordx4 v[80:83], v13, s[16:19], s58 offen sc1
    s_add_u32 s58, s62, 20480
    buffer_load_dwordx4 v[84:87], v13, s[16:19], s58 offen sc1
    s_add_u32 s58, s62, 24576
    buffer_load_dwordx4 v[88:91], v13, s[16:19], s58 offen sc1
    s_add_u32 s58, s62, 28672
    buffer_load_dwordx4 v[92:95], v13, s[16:19], s58 offen sc1
    buffer_load_dwordx4 v[96:99], v13, s[16:19], s63 offen offset:0 sc1
    buffer_load_dwordx4 v[100:103], v13, s[16:19], s63 offen offset:1024 sc1
    s_waitcnt vmcnt(0)
L_p3a_g:
    s_waitcnt vmcnt(9)
    v_mfma_f32_32x32x16_bf16 v[16:31], v[124:127], v[64:67], 0
    v_max3_u32 v116, v64, v65, 0
    v_max3_u32 v116, v66, v67, v116
    s_waitcnt vmcnt(8)
    v_mfma_f32_32x32x16_bf16 v[16:31], v[128:131], v[68:71], v[16:31]
    v_max3_u32 v116, v68, v69, v116
    v_max3_u32 v116, v70, v71, v116
    s_waitcnt vmcnt(7)
    v_mfma_f32_32x32x16_bf16 v[16:31], v[132:135], v[72:75], v[16:31]
    v_max3_u32 v116, v72, v73, v116
    v_max3_u32 v116, v74, v75, v116
    s_waitcnt vmcnt(6)
    v_mfma_f32_32x32x16_bf16 v[16:31], v[136:139], v[76:79], v[16:31]
    v_max3_u32 v116, v76, v77, v116
    v_max3_u32 v116, v78, v79, v116
    s_waitcnt vmcnt(5)
    v_mfma_f32_32x32x16_bf16 v[16:31], v[140:143], v[80:83], v[16:31]
    v_max3_u32 v116, v80, v81, v116
    v_max3_u32 v116, v82, v83, v116
    s_waitcnt vmcnt(4)
    v_mfma_f32_32x32x16_bf16 v[16:31], v[144:147], v[84:87], v[16:31]
    v_max3_u32 v116, v84, v85, v116
    v_max3_u32 v116, v86, v87, v116
    s_waitcnt vmcnt(3)
    v_mfma_f32_32x32x16_bf16 v[16:31], v[148:151], v[88:91], v[16:31]
    v_max3_u32 v116, v88, v89, v116
    v_max3_u32 v116, v90, v91, v116
    s_waitcnt vmcnt(2)
    v_mfma_f32_32x32x16_bf16 v[16:31], v[152:155], v[92:95], v[16:31]
    v_max3_u32 v116, v92, v93, v116
    v_max3_u32 v116, v94, v95, v116
    s_waitcnt vmcnt(1)
    v_permlane16_swap_b32 v96, v98
    v_permlane16_swap_b32 v97, v99
    s_nop 1
    v_mfma_f32_32x32x16_bf16 v[16:31], v[188:191], v[96:99], v[16:31]
    v_max3_u32 v116, v96, v97, v116
    v_max3_u32 v116, v98, v99, v116
    s_waitcnt vmcnt(0)
    v_permlane16_swap_b32 v100, v102
    v_permlane16_swap_b32 v101, v103
    s_nop 1
    v_mfma_f32_32x32x16_bf16 v[16:31], v[192:195], v[100:103], v[16:31]
    v_max3_u32 v116, v100, v101, v116
    v_max3_u32 v116, v102, v103, v116
    v_mfma_f32_32x32x16_bf16 v[32:47], v[156:159], v[64:67], 0
    v_cmp_eq_u32 vcc, -1, v116
    s_sub_u32 s64, s64, 1
    s_cselect_b64 vcc, 0, vcc
    s_cmp_lg_u64 vcc, 0
    s_cbranch_scc1 L_p3a
    v_mfma_f32_32x32x16_bf16 v[32:47], v[160:163], v[68:71], v[32:47]
    v_mfma_f32_32x32x16_bf16 v[32:47], v[164:167], v[72:75], v[32:47]
    v_mfma_f32_32x32x16_bf16 v[32:47], v[168:171], v[76:79], v[32:47]
    v_mfma_f32_32x32x16_bf16 v[32:47], v[172:175], v[80:83], v[32:47]
    v_mfma_f32_32x32x16_bf16 v[32:47], v[176:179], v[84:87], v[32:47]
    ds_write_b128 v4, v[16:19] offset:0
    v_mfma_f32_32x32x16_bf16 v[32:47], v[180:183], v[88:91], v[32:47]
    ds_write_b128 v5, v[20:23] offset:0
    v_mfma_f32_32x32x16_bf16 v[32:47], v[184:187], v[92:95], v[32:47]
    ds_write_b128 v6, v[24:27] offset:0
    v_mfma_f32_32x32x16_bf16 v[32:47], v[196:199], v[96:99], v[32:47]
    ds_write_b128 v7, v[28:31] offset:0
    v_mfma_f32_32x32x16_bf16 v[32:47], v[200:203], v[100:103], v[32:47]
    s_nop 11
    ds_write_b128 v4, v[32:35] offset:128
    ds_write_b128 v5, v[36:39] offset:128
    ds_write_b128 v6, v[40:43] offset:128
    ds_write_b128 v7, v[44:47] offset:128
    s_branch L_p3j
LA_slow:
    s_mul_i32 s62, s54, 81920
    s_add_u32 s62, s62, 0x00280000
    s_mul_i32 s63, s54, 320
    s_add_u32 s63, s63, 0x00500000
    v_mul_u32_u24 v158, 9728, v14
    v_add_u32 v158, v158, v13
    v_cmp_gt_u32 vcc, 20, v15
    v_mov_b32 v156, 0x40000000
    s_nop 0
    v_cndmask_b32 v158, v156, v158, vcc
    v_mov_b32 v156, 0x3f803f80
    v_cndmask_b32 v156, v156, 0, vcc
    v_subrev_u32 v153, 84480, v153
    v_subrev_u32 v155, 84480, v155
    v_mov_b32 v117, 0
    v_mov_b32 v123, 0
    v_mov_b32 v2, 0xff800000
    v_mov_b32 v4, 0xff800000
    s_mov_b32 s64, 0
LA_s1:
    s_lshr_b32 s58, s64, 1
    s_mul_i32 s58, s58, 2560
    s_and_b32 s59, s64, 1
    s_lshl_b32 s59, s59, 8
    s_add_u32 s58, s58, s59
    s_add_u32 s58, s58, s62
    buffer_load_dwordx2 v[124:125], v153, s[16:19], s58 offen sc1
    buffer_load_dwordx2 v[126:127], v153, s[16:19], s58 offen offset:512 sc1
    buffer_load_dword v128, v155, s[16:19], s58 offen sc1
    s_waitcnt vmcnt(1)
    v_mfma_f32_32x32x16_bf16 v[16:31], v[124:127], v[112:115], 0
    s_waitcnt vmcnt(0)
    v_mfma_f32_32x32x8_bf16 v[16:31], v[128:129], v[116:117], v[16:31]
    v_mfma_f32_32x32x16_bf16 v[32:47], v[124:127], v[118:121], 0
    v_mfma_f32_32x32x8_bf16 v[32:47], v[128:129], v[122:123], v[32:47]
    s_nop 9
    v_max3_f32 v2, v16, v17, v2
    v_max3_f32 v2, v18, v19, v2
    v_max3_f32 v2, v20, v21, v2
    v_max3_f32 v2, v22, v23, v2
    v_max3_f32 v2, v24, v25, v2
    v_max3_f32 v2, v26, v27, v2
    v_max3_f32 v2, v28, v29, v2
    v_max3_f32 v2, v30, v31, v2
    v_max3_f32 v4, v32, v33, v4
    v_max3_f32 v4, v34, v35, v4
    v_max3_f32 v4, v36, v37, v4
    v_max3_f32 v4, v38, v39, v4
    v_max3_f32 v4, v40, v41, v4
    v_max3_f32 v4, v42, v43, v4
    v_max3_f32 v4, v44, v45, v4
    v_max3_f32 v4, v46, v47, v4
    s_add_u32 s64, s64, 1
    s_cmp_lt_u32 s64, 64
    s_cbranch_scc1 LA_s1
    v_mov_b32 v3, v2
    s_nop 1
    v_permlane32_swap_b32 v2, v3
    v_max_f32 v2, v2, v3
    v_sub_f32 v2, 0, v2
    v_cvt_pk_bf16_f32 v8, v2, v2
    v_and_b32 v8, 0xffff0000, v8
    v_sub_f32 v8, v2, v8
    v_cvt_pk_bf16_f32 v9, v2, v8
    v_and_b32 v10, 0xffff0000, v9
    v_sub_f32 v8, v8, v10
    v_cvt_pk_bf16_f32 v8, v8, 0
    v_cmp_eq_u32 vcc, 0, v14
    s_nop 1
    v_cndmask_b32 v117, v8, v9, vcc
    v_mov_b32 v5, v4
    s_nop 1
    v_permlane32_swap_b32 v4, v5
    v_max_f32 v4, v4, v5
    v_sub_f32 v4, 0, v4
    v_cvt_pk_bf16_f32 v8, v4, v4
    v_and_b32 v8, 0xffff0000, v8
    v_sub_f32 v8, v4, v8
    v_cvt_pk_bf16_f32 v9, v4, v8
    v_and_b32 v10, 0xffff0000, v9
    v_sub_f32 v8, v8, v10
    v_cvt_pk_bf16_f32 v8, v8, 0
    v_cmp_eq_u32 vcc, 0, v14
    s_nop 1
    v_cndmask_b32 v123, v8, v9, vcc
    v_mov_b32 v80, 0
    v_mov_b32 v81, 0
    v_mov_b32 v82, 0
    v_mov_b32 v83, 0
    v_mov_b32 v84, 0
    v_mov_b32 v85, 0
    v_mov_b32 v86, 0
    v_mov_b32 v87, 0
    v_mov_b32 v88, 0
    v_mov_b32 v89, 0
    v_mov_b32 v90, 0
    v_mov_b32 v91, 0
    v_mov_b32 v92, 0
    v_mov_b32 v93, 0
    v_mov_b32 v94, 0
    v_mov_b32 v95, 0
    v_mov_b32 v96, 0
    v_mov_b32 v97, 0
    v_mov_b32 v98, 0
    v_mov_b32 v99, 0
    v_mov_b32 v100, 0
    v_mov_b32 v101, 0
    v_mov_b32 v102, 0
    v_mov_b32 v103, 0
    v_mov_b32 v104, 0
    v_mov_b32 v105, 0
    v_mov_b32 v106, 0
    v_mov_b32 v107, 0
    v_mov_b32 v108, 0
    v_mov_b32 v109, 0
    v_mov_b32 v110, 0
    v_mov_b32 v111, 0
    s_mov_b32 s64, 0
LA_s2:
    s_lshr_b32 s58, s64, 1
    s_mul_i32 s58, s58, 2560
    s_and_b32 s59, s64, 1
    s_lshl_b32 s59, s59, 8
    s_add_u32 s58, s58, s59
    s_add_u32 s58, s58, s62
    buffer_load_dwordx2 v[124:125], v153, s[16:19], s58 offen sc1
    buffer_load_dwordx2 v[126:127], v153, s[16:19], s58 offen offset:512 sc1
    buffer_load_dword v128, v155, s[16:19], s58 offen sc1
    s_mul_i32 s58, s64, 40960
    s_add_u32 s58, s58, s63
    s_add_u32 s59, s58, 20480
    buffer_load_dwordx4 v[136:139], v158, s[16:19], s58 offen sc1
    buffer_load_dwordx4 v[140:143], v158, s[16:19], s59 offen sc1
    s_waitcnt vmcnt(1)
    v_or_b32 v136, v156, v136
    v_or_b32 v137, v156, v137
    v_or_b32 v138, v156, v138
    v_or_b32 v139, v156, v139
    s_waitcnt vmcnt(0)
    v_or_b32 v140, v156, v140
    v_or_b32 v141, v156, v141
    v_or_b32 v142, v156, v142
    v_or_b32 v143, v156, v143
    v_mfma_f32_32x32x16_bf16 v[16:31], v[124:127], v[112:115], 0
    v_mfma_f32_32x32x8_bf16 v[16:31], v[128:129], v[116:117], v[16:31]
    v_mfma_f32_32x32x16_bf16 v[32:47], v[124:127], v[118:121], 0
    v_mfma_f32_32x32x8_bf16 v[32:47], v[128:129], v[122:123], v[32:47]
    s_nop 9
    v_exp_f32 v16, v16
    v_exp_f32 v17, v17
    v_exp_f32 v18, v18
    v_exp_f32 v19, v19
    v_exp_f32 v20, v20
    v_exp_f32 v21, v21
    v_exp_f32 v22, v22
    v_exp_f32 v23, v23
    v_exp_f32 v24, v24
    v_exp_f32 v25, v25
    v_exp_f32 v26, v26
    v_exp_f32 v27, v27
    v_exp_f32 v28, v28
    v_exp_f32 v29, v29
    v_exp_f32 v30, v30
    v_exp_f32 v31, v31
    v_smfmac_f32_32x32x32_bf16 v[80:95], v[136:139], v[16:23], v152
    s_nop 0
    v_smfmac_f32_32x32x32_bf16 v[80:95], v[140:143], v[24:31], v152
    v_exp_f32 v32, v32
    v_exp_f32 v33, v33
    v_exp_f32 v34, v34
    v_exp_f32 v35, v35
    v_exp_f32 v36, v36
    v_exp_f32 v37, v37
    v_exp_f32 v38, v38
    v_exp_f32 v39, v39
    v_exp_f32 v40, v40
    v_exp_f32 v41, v41
    v_exp_f32 v42, v42
    v_exp_f32 v43, v43
    v_exp_f32 v44, v44
    v_exp_f32 v45, v45
    v_exp_f32 v46, v46
    v_exp_f32 v47, v47
    v_smfmac_f32_32x32x32_bf16 v[96:111], v[136:139], v[32:39], v152
    s_nop 0
    v_smfmac_f32_32x32x32_bf16 v[96:111], v[140:143], v[40:47], v152
    s_add_u32 s64, s64, 1
    s_cmp_lt_u32 s64, 64
    s_cbranch_scc1 LA_s2
    s_mov_b32 s60, 5
    s_nop 15
    s_branch LA_fin
L_last:

.section .rodata,"a"
.p2align 6
.amdhsa_kernel recurrent_scan__mha_block__mixer_channel_mlp__prompt_kernel
  .amdhsa_next_free_vgpr 256
  .amdhsa_next_free_sgpr 102
  .amdhsa_accum_offset 256
  .amdhsa_group_segment_fixed_size 0
  .amdhsa_kernarg_size 88
  .amdhsa_user_sgpr_count 2
  .amdhsa_user_sgpr_kernarg_segment_ptr 1
  .amdhsa_system_sgpr_workgroup_id_x 1
.end_amdhsa_kernel
```
